```python
import torch

def _softmax(x, axis=-1):
    return torch.softmax(x, dim=axis)
def _gelu(x):
    return torch.nn.functional.gelu(x, approximate="tanh")
def _silu(x):
    return torch.nn.functional.silu(x)
def _sigmoid(x):
    return torch.sigmoid(x)
def _layernorm(x, axis=-1, eps=1e-5):
    m = x.mean(dim=axis, keepdim=True)
    v = x.var(dim=axis, keepdim=True, unbiased=False)
    return (x - m) / torch.sqrt(v + eps)
def _scatter_add(tgt, idx, src, axis=0):
    return tgt.clone().index_add_(axis, idx, src)
def _segment_sum(src, seg, n):
    out = torch.zeros((n,) + src.shape[1:], dtype=src.dtype)
    return out.index_add_(0, seg, src)
def _pad(x, pw):
    flat = tuple(v for pair in reversed(pw) for v in pair)
    return torch.nn.functional.pad(x, flat)

kernel_name = 'parallel_sum__ssm_conv_h3__glu_gated_geglu__prompt'

def setup_inputs():

    _w = (lambda a: (lambda t: t.to(torch.bfloat16) if t.is_floating_point() else t)(torch.as_tensor(a)))
    def _A_setup():
        B, S, D = 1, 2048, 512
        ks = 4
        return {
            "q": _w((lambda *s: torch.randn(*s, dtype=torch.bfloat16) * 0.05)(B, S, D)),
            "k": _w((lambda *s: torch.randn(*s, dtype=torch.bfloat16) * 0.2)(B, S, D)),
            "v": _w((lambda *s: torch.randn(*s, dtype=torch.bfloat16) * 0.2)(B, S, D)),
            "shift_k": _w((lambda *s: torch.randn(*s, dtype=torch.bfloat16) * 0.2)(D, ks) * 0.5),
            "ssm_k": _w((lambda *s: torch.randn(*s, dtype=torch.bfloat16) * 0.4)(D, S) * (1.0 / S ** 0.5)),
            "ssm_D": _w((lambda *s: torch.randn(*s, dtype=torch.bfloat16) * 0.2)(D)),
        }
    _A_in = _A_setup()

    def _B_setup():
        B, S, Dm, Df = 1, 2048, 512, 1792
        return {
            "x": _w((lambda *s: torch.randn(*s, dtype=torch.bfloat16) * 0.05)(B, S, Dm)),
            "w_gate": _w((lambda *s: torch.randn(*s, dtype=torch.bfloat16) * 0.4)(Dm, Df) * (Dm ** -0.5)),
            "w_up": _w((lambda *s: torch.randn(*s, dtype=torch.bfloat16) * 0.4)(Dm, Df) * (Dm ** -0.5)),
            "w_down": _w((lambda *s: torch.randn(*s, dtype=torch.bfloat16) * 0.4)(Df, Dm) * (Df ** -0.5)),
        }
    _B_in = _B_setup()

    return {
        "A_q": _A_in["q"],
        "A_k": _A_in["k"],
        "A_v": _A_in["v"],
        "A_shift_k": _A_in["shift_k"],
        "A_ssm_k": _A_in["ssm_k"],
        "A_ssm_D": _A_in["ssm_D"],
        "B_x": _B_in["x"],
        "B_w_gate": _B_in["w_gate"],
        "B_w_up": _B_in["w_up"],
        "B_w_down": _B_in["w_down"],
    }

def reference(A_q, A_k, A_v, A_shift_k, A_ssm_k, A_ssm_D, B_x, B_w_gate, B_w_up, B_w_down):
    def _A_ref(q, k, v, shift_k, ssm_k, ssm_D):
        B, S, D = q.shape
        ks = shift_k.shape[-1]
        k_pad = _pad(k, ((0, 0), (ks - 1, 0), (0, 0)))
        k_shift = torch.zeros_like(k)
        for t in range(ks):
            k_shift = k_shift + k_pad[:, t:t + S, :] * shift_k[:, ks - 1 - t][None, None, :]
        kv = k_shift * v
        L = 2 * S
        kv_pad = _pad(kv, ((0, 0), (0, S), (0, 0)))
        kf_pad = _pad(ssm_k, ((0, 0), (0, S)))
        kv_f = (lambda x, axes=(-2,-1): torch.fft.rfft2(x.float(), dim=axes))(kv_pad[:, None, :, :], axes=(1, 2))
        kf_f = (lambda x, axes=(-2,-1): torch.fft.rfft2(x.float(), dim=axes))(kf_pad[:, None, :], axes=(1, 2))
        kf_f = (lambda x, *d: x.permute(*d))(kf_f, 1, 2, 0)
        y_f = kv_f * kf_f[None, :, :, :]
        y = (lambda x, s, axes=(-2,-1): torch.fft.irfft2(x, s=s, dim=axes).to(torch.bfloat16))(y_f, (1, L), axes=(1, 2))[:, 0, :S, :]
        y = y + kv * ssm_D[None, None, :]
        return q * y

    def _B_ref(x, w_gate, w_up, w_down):
        g = torch.einsum("bsd,df->bsf", x, w_gate)
        u = torch.einsum("bsd,df->bsf", x, w_up)
        h = _gelu(g) * u
        return torch.einsum("bsf,fd->bsd", h, w_down)

    x = A_q
    xn = _layernorm(x, axis=-1)
    return x + _A_ref(xn, A_k, A_v, A_shift_k, A_ssm_k, A_ssm_D) + _B_ref(xn, B_w_gate, B_w_up, B_w_down)
```

```asm
; @launch grid=(256,1,1) block=(512,1,1) lds=163840
.amdgcn_target "amdgcn-amd-amdhsa--gfx950"
.text
.globl parallel_sum__ssm_conv_h3__glu_gated_geglu__prompt_kernel
.p2align 12
Lbase:
.p2align 8
.type parallel_sum__ssm_conv_h3__glu_gated_geglu__prompt_kernel,@function
parallel_sum__ssm_conv_h3__glu_gated_geglu__prompt_kernel:
    s_cmp_ge_u32 s2, 256
    s_cbranch_scc1 Lexit
    s_load_dwordx16 s[4:19], s[0:1], 0
    s_load_dwordx8 s[20:27], s[0:1], 64
    s_load_dwordx2 s[28:29], s[0:1], 96
    v_lshrrev_b32 v2, 6, v0
    v_and_b32 v1, 63, v0
    s_and_b32 s38, s2, 7
    v_readfirstlane_b32 s30, v2
    s_lshr_b32 s39, s2, 3
    s_getpc_b64 s[80:81]
Lpc0:
    s_sub_u32 s80, s80, Lpc0-parallel_sum__ssm_conv_h3__glu_gated_geglu__prompt_kernel
    s_subb_u32 s81, s81, 0
    s_lshl_b32 s40, s39, 3
    s_add_u32 s40, s40, s30
    s_lshl_b32 s40, s40, 1
    v_and_b32 v10, 1, v1
    v_add_u32 v10, s40, v10
    v_min_u32 v10, (Lexit-parallel_sum__ssm_conv_h3__glu_gated_geglu__prompt_kernel)/128, v10
    v_lshlrev_b32 v10, 7, v10
    global_load_dword v0, v10, s[80:81]
    s_and_b32 s79, s39, 3
    s_lshr_b32 s34, s39, 2
    s_lshr_b32 s41, s38, 1
    s_lshl_b32 s31, s41, 2
    s_add_u32 s31, s31, s79
    s_and_b32 s32, s38, 1
    s_mul_i32 s32, s32, 7
    s_add_u32 s32, s32, s34
    s_lshl_b32 s33, s38, 2
    s_add_u32 s33, s33, s79
    s_and_b32 s41, s41, 3
    s_mul_i32 s70, s41, 458752
    s_lshl_b32 s71, s41, 8
    s_and_b32 s74, s30, 3
    s_cmp_lt_u32 s39, 28
    s_cselect_b32 s35, -1, 0
    s_cbranch_scc0 Lspare
    s_cmp_lt_u32 s30, 4
    s_cbranch_scc1 Lcw
    s_add_u32 s38, s74, s79
    s_bfe_u32 s41, s38, 0x10001
    s_and_b32 s38, s38, 1
    s_lshl_b32 s39, s38, 2
    v_lshrrev_b32 v4, 4, v1
    v_lshlrev_b32 v5, 1, v4
    v_and_b32 v6, 15, v1
    v_xor_b32 v5, v5, v6
    v_lshlrev_b32 v5, 4, v5
    v_add_u32 v6, s39, v4
    v_mul_u32_u24 v6, 3584, v6
    s_lshl_b32 s40, s32, 8
    v_add3_u32 v3, v5, v6, s40
    v_xor_b32 v66, 128, v3
    v_and_b32 v6, 7, v1
    v_xor_b32 v5, v4, v6
    v_lshlrev_b32 v5, 4, v5
    v_lshrrev_b32 v6, 3, v1
    v_lshl_add_u32 v2, v6, 10, v5
    v_xor_b32 v14, 64, v2
    s_mul_i32 s77, s41, 40960
    s_lshl_b32 s40, s38, 10
    s_add_u32 s77, s77, s40
    s_lshl_b32 s75, s31, 17
    s_lshl_b32 s38, s74, 1
    s_add_u32 s38, s38, s34
    s_lshl_b32 s38, s38, 11
    s_add_u32 s84, s38, 0
    s_and_b32 s84, s84, 0x3fff
    s_lshl_b32 s88, s84, 3
    s_add_u32 s88, s88, s75
    s_add_u32 s85, s38, 2048
    s_and_b32 s85, s85, 0x3fff
    s_lshl_b32 s89, s85, 3
    s_add_u32 s89, s89, s75
    s_mov_b32 s54, 1835008
    s_mov_b32 s55, 0x20000
    s_mov_b32 s50, 2097152
    s_mov_b32 s51, 0x20000
    s_cmp_eq_u32 s41, 0
    s_waitcnt lgkmcnt(0)
    s_cselect_b32 s52, s18, s20
    s_cselect_b32 s53, s19, s21
    s_mov_b32 s48, s4
    s_mov_b32 s49, s5
    s_add_u32 m0, s77, 0
    s_add_u32 s43, s70, 0
    buffer_load_dwordx4 v3, s[52:55], s43 offen  lds
    s_add_u32 m0, s77, 2048
    s_add_u32 s43, s70, 28672
    buffer_load_dwordx4 v66, s[52:55], s43 offen  lds
    s_add_u32 m0, s77, 4096
    s_add_u32 s43, s70, 57344
    buffer_load_dwordx4 v3, s[52:55], s43 offen  lds
    s_add_u32 m0, s77, 6144
    s_add_u32 s43, s70, 86016
    buffer_load_dwordx4 v66, s[52:55], s43 offen  lds
    s_add_u32 s70, s70, 114688
    s_add_u32 s38, s71, 0
    s_and_b32 s38, s38, 1023
    s_add_u32 s39, s38, 8192
    s_add_u32 m0, s84, 114688
    s_add_u32 s43, s88, s38
    buffer_load_dwordx4 v2, s[48:51], s43 offen  lds
    s_add_u32 m0, s84, 115712
    s_add_u32 s43, s88, s39
    buffer_load_dwordx4 v14, s[48:51], s43 offen  lds
    s_add_u32 m0, s85, 114688
    s_add_u32 s43, s89, s38
    buffer_load_dwordx4 v2, s[48:51], s43 offen  lds
    s_add_u32 m0, s85, 115712
    s_add_u32 s43, s89, s39
    buffer_load_dwordx4 v14, s[48:51], s43 offen  lds
    s_add_u32 m0, s77, 8192
    s_add_u32 s43, s70, 0
    buffer_load_dwordx4 v3, s[52:55], s43 offen  lds
    s_add_u32 m0, s77, 10240
    s_add_u32 s43, s70, 28672
    buffer_load_dwordx4 v66, s[52:55], s43 offen  lds
    s_add_u32 m0, s77, 12288
    s_add_u32 s43, s70, 57344
    buffer_load_dwordx4 v3, s[52:55], s43 offen  lds
    s_add_u32 m0, s77, 14336
    s_add_u32 s43, s70, 86016
    buffer_load_dwordx4 v66, s[52:55], s43 offen  lds
    s_add_u32 s70, s70, 114688
    s_mov_b32 s44, s28
    s_mov_b32 s45, s29
    s_mov_b32 s46, 20971520
    s_mov_b32 s47, 0x20000
    s_cmp_eq_u32 s74, 1
    s_cbranch_scc1 Lh1
    s_cmp_eq_u32 s74, 2
    s_cbranch_scc1 Lh2
    s_cmp_eq_u32 s74, 3
    s_cbranch_scc1 Lh3
    s_add_u32 m0, s77, 16384
    s_add_u32 s43, s70, 0
    buffer_load_dwordx4 v3, s[52:55], s43 offen  lds
    s_add_u32 m0, s77, 18432
    s_add_u32 s43, s70, 28672
    buffer_load_dwordx4 v66, s[52:55], s43 offen  lds
    s_add_u32 m0, s77, 20480
    s_add_u32 s43, s70, 57344
    buffer_load_dwordx4 v3, s[52:55], s43 offen  lds
    s_add_u32 m0, s77, 22528
    s_add_u32 s43, s70, 86016
    buffer_load_dwordx4 v66, s[52:55], s43 offen  lds
    s_add_u32 s70, s70, 114688
    s_add_u32 s38, s71, 128
    s_and_b32 s38, s38, 1023
    s_add_u32 s39, s38, 8192
    s_add_u32 m0, s84, 131072
    s_add_u32 s43, s88, s38
    buffer_load_dwordx4 v2, s[48:51], s43 offen  lds
    s_add_u32 m0, s84, 132096
    s_add_u32 s43, s88, s39
    buffer_load_dwordx4 v14, s[48:51], s43 offen  lds
    s_and_b32 s38, s79, 1
    v_lshrrev_b32 v4, 4, v1
    v_lshlrev_b32 v5, 1, v4
    v_and_b32 v6, 15, v1
    v_xor_b32 v5, v5, v6
    v_lshlrev_b32 v5, 4, v5
    v_lshl_add_u32 v5, v4, 8, v5
    s_mul_i32 s39, s38, 40960
    v_add_u32 v8, s39, v5
    v_xor_b32 v9, 128, v8
    v_lshlrev_b32 v5, 3, v1
    v_add_u32 v5, 155648, v5
    s_and_b32 s38, s34, 3
    s_cmp_eq_u32 s38, 3
    s_cselect_b32 s38, 4, 0
    s_xor_b32 s34, s34, s38
    s_mov_b32 s92, s22
    s_mov_b32 s93, s23
    s_mov_b32 s94, 1835008
    s_mov_b32 s95, 0x20000
    s_lshr_b32 s38, s34, 2
    s_add_u32 s38, s38, s79
    s_and_b32 s38, s38, 1
    s_lshl_b32 s66, s38, 10
    s_xor_b32 s67, s66, 1024
    s_lshl_b32 s64, s66, 1
    s_lshl_b32 s65, s67, 1
    v_bfe_u32 v188, v1, 4, 1
    v_lshlrev_b32 v188, 2, v188
    v_and_b32 v12, 7, v1
    v_xor_b32 v188, v188, v12
    v_lshlrev_b32 v188, 4, v188
    v_lshrrev_b32 v12, 3, v1
    v_lshl_add_u32 v188, v12, 10, v188
    s_mul_i32 s38, s74, 458752
    s_lshl_b32 s39, s34, 7
    s_add_u32 s38, s38, s39
    v_add_u32 v188, s38, v188
    s_lshl_b32 s78, s74, 11
    s_waitcnt vmcnt(10)
    s_barrier
Ls0_0:
    s_bitcmp1_b32 s79, 1
    s_cbranch_scc1 Lcs_7
    ds_read_b128 v[192:195], v8 offset:0
    ds_read_b128 v[196:199], v8 offset:1024
    ds_read_b128 v[200:203], v9 offset:2048
    ds_read_b128 v[204:207], v9 offset:3072
    ds_read_b128 v[208:211], v8 offset:4096
    ds_read_b128 v[212:215], v8 offset:5120
    ds_read_b128 v[216:219], v9 offset:6144
    ds_read_b128 v[220:223], v9 offset:7168
Lcs_7:
    s_add_u32 m0, s77, 24576
    s_add_u32 s43, s70, 0
    buffer_load_dwordx4 v3, s[52:55], s43 offen  lds
    s_add_u32 m0, s77, 26624
    s_add_u32 s43, s70, 28672
    buffer_load_dwordx4 v66, s[52:55], s43 offen  lds
    s_add_u32 m0, s77, 28672
    s_add_u32 s43, s70, 57344
    buffer_load_dwordx4 v3, s[52:55], s43 offen  lds
    s_add_u32 m0, s77, 30720
    s_add_u32 s43, s70, 86016
    buffer_load_dwordx4 v66, s[52:55], s43 offen  lds
    s_add_u32 s70, s70, 114688
    s_cmp_eq_u32 s70, 1835008
    s_cselect_b32 s70, 0, s70
    s_add_u32 s38, s71, 256
    s_and_b32 s38, s38, 1023
    s_add_u32 s39, s38, 8192
    s_add_u32 m0, s84, 81920
    s_add_u32 s43, s88, s38
    buffer_load_dwordx4 v2, s[48:51], s43 offen  lds
    s_add_u32 m0, s84, 82944
    s_add_u32 s43, s88, s39
    buffer_load_dwordx4 v14, s[48:51], s43 offen  lds
    s_add_u32 m0, s77, 32768
    s_add_u32 s43, s70, 0
    buffer_load_dwordx4 v3, s[52:55], s43 offen  lds
    s_add_u32 m0, s77, 34816
    s_add_u32 s43, s70, 28672
    buffer_load_dwordx4 v66, s[52:55], s43 offen  lds
    s_add_u32 m0, s77, 36864
    s_add_u32 s43, s70, 57344
    buffer_load_dwordx4 v3, s[52:55], s43 offen  lds
    s_add_u32 m0, s77, 38912
    s_add_u32 s43, s70, 86016
    buffer_load_dwordx4 v66, s[52:55], s43 offen  lds
    s_add_u32 s70, s70, 114688
    s_waitcnt lgkmcnt(0)
    s_waitcnt vmcnt(16)
    s_barrier
Ls0_1:
    s_add_u32 s38, s71, 384
    s_and_b32 s38, s38, 1023
    s_add_u32 s39, s38, 8192
    s_add_u32 m0, s84, 98304
    s_add_u32 s43, s88, s38
    buffer_load_dwordx4 v2, s[48:51], s43 offen  lds
    s_add_u32 m0, s84, 99328
    s_add_u32 s43, s88, s39
    buffer_load_dwordx4 v14, s[48:51], s43 offen  lds
    s_add_u32 m0, s77, 0
    s_add_u32 s43, s70, 0
    buffer_load_dwordx4 v3, s[52:55], s43 offen  lds
    s_add_u32 m0, s77, 2048
    s_add_u32 s43, s70, 28672
    buffer_load_dwordx4 v66, s[52:55], s43 offen  lds
    s_add_u32 m0, s77, 4096
    s_add_u32 s43, s70, 57344
    buffer_load_dwordx4 v3, s[52:55], s43 offen  lds
    s_add_u32 m0, s77, 6144
    s_add_u32 s43, s70, 86016
    buffer_load_dwordx4 v66, s[52:55], s43 offen  lds
    s_add_u32 s70, s70, 114688
    s_lshl_b32 s38, s64, 5
    s_add_u32 s43, s38, 0
    buffer_load_dwordx4 v[72:75], v188, s[92:95], s43 offen
    s_add_u32 s43, s38, 8192
    buffer_load_dwordx4 v[76:79], v188, s[92:95], s43 offen
    s_waitcnt vmcnt(18)
    s_barrier
Ls0_2:
    s_bitcmp0_b32 s79, 1
    s_cbranch_scc1 Lcs_8
    ds_read_b128 v[192:195], v8 offset:16384
    ds_read_b128 v[196:199], v8 offset:17408
    ds_read_b128 v[200:203], v9 offset:18432
    ds_read_b128 v[204:207], v9 offset:19456
    ds_read_b128 v[208:211], v8 offset:20480
    ds_read_b128 v[212:215], v8 offset:21504
    ds_read_b128 v[216:219], v9 offset:22528
    ds_read_b128 v[220:223], v9 offset:23552
Lcs_8:
    s_add_u32 m0, s77, 8192
    s_add_u32 s43, s70, 0
    buffer_load_dwordx4 v3, s[52:55], s43 offen  lds
    s_add_u32 m0, s77, 10240
    s_add_u32 s43, s70, 28672
    buffer_load_dwordx4 v66, s[52:55], s43 offen  lds
    s_add_u32 m0, s77, 12288
    s_add_u32 s43, s70, 57344
    buffer_load_dwordx4 v3, s[52:55], s43 offen  lds
    s_add_u32 m0, s77, 14336
    s_add_u32 s43, s70, 86016
    buffer_load_dwordx4 v66, s[52:55], s43 offen  lds
    s_add_u32 s70, s70, 114688
    s_add_u32 s38, s71, 512
    s_and_b32 s38, s38, 1023
    s_add_u32 s39, s38, 8192
    s_add_u32 m0, s84, 114688
    s_add_u32 s43, s88, s38
    buffer_load_dwordx4 v2, s[48:51], s43 offen  lds
    s_add_u32 m0, s84, 115712
    s_add_u32 s43, s88, s39
    buffer_load_dwordx4 v14, s[48:51], s43 offen  lds
    s_waitcnt lgkmcnt(0)
    s_lshl_b32 s38, s64, 5
    s_add_u32 s43, s38, 16384
    buffer_load_dwordx4 v[80:83], v188, s[92:95], s43 offen
    s_add_u32 s43, s38, 24576
    buffer_load_dwordx4 v[84:87], v188, s[92:95], s43 offen
    v_lshlrev_b32 v16, 16, v192
    v_and_b32 v17, 0xffff0000, v192
    v_lshlrev_b32 v18, 16, v193
    v_and_b32 v19, 0xffff0000, v193
    v_lshlrev_b32 v20, 16, v194
    v_and_b32 v21, 0xffff0000, v194
    v_lshlrev_b32 v22, 16, v195
    v_and_b32 v23, 0xffff0000, v195
    v_lshlrev_b32 v24, 16, v196
    v_and_b32 v25, 0xffff0000, v196
    v_lshlrev_b32 v26, 16, v197
    v_and_b32 v27, 0xffff0000, v197
    v_lshlrev_b32 v28, 16, v198
    v_and_b32 v29, 0xffff0000, v198
    v_lshlrev_b32 v30, 16, v199
    v_and_b32 v31, 0xffff0000, v199
    v_add_f32 v16, v16, v24
    v_add_f32 v17, v17, v25
    v_add_f32 v18, v18, v26
    v_add_f32 v19, v19, v27
    v_add_f32 v20, v20, v28
    v_add_f32 v21, v21, v29
    v_add_f32 v22, v22, v30
    v_add_f32 v23, v23, v31
    v_lshlrev_b32 v24, 16, v200
    v_and_b32 v25, 0xffff0000, v200
    v_lshlrev_b32 v26, 16, v201
    s_waitcnt vmcnt(22)
    s_barrier
Ls0_3:
    s_add_u32 m0, s77, 16384
    s_add_u32 s43, s70, 0
    buffer_load_dwordx4 v3, s[52:55], s43 offen  lds
    s_add_u32 m0, s77, 18432
    s_add_u32 s43, s70, 28672
    buffer_load_dwordx4 v66, s[52:55], s43 offen  lds
    s_add_u32 m0, s77, 20480
    s_add_u32 s43, s70, 57344
    buffer_load_dwordx4 v3, s[52:55], s43 offen  lds
    s_add_u32 m0, s77, 22528
    s_add_u32 s43, s70, 86016
    buffer_load_dwordx4 v66, s[52:55], s43 offen  lds
    s_add_u32 s70, s70, 114688
    s_cmp_eq_u32 s70, 1835008
    s_cselect_b32 s70, 0, s70
    s_lshl_b32 s38, s65, 5
    s_add_u32 s43, s38, 0
    buffer_load_dwordx4 v[88:91], v188, s[92:95], s43 offen
    s_add_u32 s43, s38, 8192
    buffer_load_dwordx4 v[92:95], v188, s[92:95], s43 offen
    v_and_b32 v27, 0xffff0000, v201
    v_lshlrev_b32 v28, 16, v202
    v_and_b32 v29, 0xffff0000, v202
    v_lshlrev_b32 v30, 16, v203
    v_and_b32 v31, 0xffff0000, v203
    v_add_f32 v16, v16, v24
    v_add_f32 v17, v17, v25
    v_add_f32 v18, v18, v26
    v_add_f32 v19, v19, v27
    v_add_f32 v20, v20, v28
    v_add_f32 v21, v21, v29
    v_add_f32 v22, v22, v30
    v_add_f32 v23, v23, v31
    v_lshlrev_b32 v24, 16, v204
    v_and_b32 v25, 0xffff0000, v204
    v_lshlrev_b32 v26, 16, v205
    v_and_b32 v27, 0xffff0000, v205
    v_lshlrev_b32 v28, 16, v206
    v_and_b32 v29, 0xffff0000, v206
    v_lshlrev_b32 v30, 16, v207
    v_and_b32 v31, 0xffff0000, v207
    v_add_f32 v16, v16, v24
    v_add_f32 v17, v17, v25
    v_add_f32 v18, v18, v26
    v_add_f32 v19, v19, v27
    v_add_f32 v20, v20, v28
    v_add_f32 v21, v21, v29
    s_waitcnt vmcnt(26)
    s_waitcnt vmcnt(22)
    s_barrier
Ls0_4:
    s_add_u32 m0, s77, 24576
    s_add_u32 s43, s70, 0
    buffer_load_dwordx4 v3, s[52:55], s43 offen  lds
    s_add_u32 m0, s77, 26624
    s_add_u32 s43, s70, 28672
    buffer_load_dwordx4 v66, s[52:55], s43 offen  lds
    s_add_u32 m0, s77, 28672
    s_add_u32 s43, s70, 57344
    buffer_load_dwordx4 v3, s[52:55], s43 offen  lds
    s_add_u32 m0, s77, 30720
    s_add_u32 s43, s70, 86016
    buffer_load_dwordx4 v66, s[52:55], s43 offen  lds
    s_add_u32 s70, s70, 114688
    s_add_u32 s38, s71, 640
    s_and_b32 s38, s38, 1023
    s_add_u32 s39, s38, 8192
    s_add_u32 m0, s84, 131072
    s_add_u32 s43, s88, s38
    buffer_load_dwordx4 v2, s[48:51], s43 offen  lds
    s_add_u32 m0, s84, 132096
    s_add_u32 s43, s88, s39
    buffer_load_dwordx4 v14, s[48:51], s43 offen  lds
    s_lshl_b32 s38, s65, 5
    s_add_u32 s43, s38, 16384
    buffer_load_dwordx4 v[96:99], v188, s[92:95], s43 offen
    s_add_u32 s43, s38, 24576
    buffer_load_dwordx4 v[100:103], v188, s[92:95], s43 offen
    v_add_f32 v22, v22, v30
    v_add_f32 v23, v23, v31
    v_lshlrev_b32 v24, 16, v208
    v_and_b32 v25, 0xffff0000, v208
    v_lshlrev_b32 v26, 16, v209
    v_and_b32 v27, 0xffff0000, v209
    v_lshlrev_b32 v28, 16, v210
    v_and_b32 v29, 0xffff0000, v210
    v_lshlrev_b32 v30, 16, v211
    v_and_b32 v31, 0xffff0000, v211
    v_add_f32 v16, v16, v24
    v_add_f32 v17, v17, v25
    v_add_f32 v18, v18, v26
    v_add_f32 v19, v19, v27
    v_add_f32 v20, v20, v28
    v_add_f32 v21, v21, v29
    v_add_f32 v22, v22, v30
    v_add_f32 v23, v23, v31
    v_lshlrev_b32 v24, 16, v212
    v_and_b32 v25, 0xffff0000, v212
    v_lshlrev_b32 v26, 16, v213
    v_and_b32 v27, 0xffff0000, v213
    v_lshlrev_b32 v28, 16, v214
    v_and_b32 v29, 0xffff0000, v214
    v_lshlrev_b32 v30, 16, v215
    v_and_b32 v31, 0xffff0000, v215
    v_add_f32 v16, v16, v24
    s_waitcnt vmcnt(24)
    s_barrier
Ls0_5:
    s_add_u32 m0, s77, 32768
    s_add_u32 s43, s70, 0
    buffer_load_dwordx4 v3, s[52:55], s43 offen  lds
    s_add_u32 m0, s77, 34816
    s_add_u32 s43, s70, 28672
    buffer_load_dwordx4 v66, s[52:55], s43 offen  lds
    s_add_u32 m0, s77, 36864
    s_add_u32 s43, s70, 57344
    buffer_load_dwordx4 v3, s[52:55], s43 offen  lds
    s_add_u32 m0, s77, 38912
    s_add_u32 s43, s70, 86016
    buffer_load_dwordx4 v66, s[52:55], s43 offen  lds
    s_add_u32 s70, s70, 114688
    v_add_f32 v17, v17, v25
    v_add_f32 v18, v18, v26
    v_add_f32 v19, v19, v27
    v_add_f32 v20, v20, v28
    v_add_f32 v21, v21, v29
    v_add_f32 v22, v22, v30
    v_add_f32 v23, v23, v31
    v_lshlrev_b32 v24, 16, v216
    v_and_b32 v25, 0xffff0000, v216
    v_lshlrev_b32 v26, 16, v217
    v_and_b32 v27, 0xffff0000, v217
    v_lshlrev_b32 v28, 16, v218
    v_and_b32 v29, 0xffff0000, v218
    v_lshlrev_b32 v30, 16, v219
    v_and_b32 v31, 0xffff0000, v219
    v_add_f32 v16, v16, v24
    v_add_f32 v17, v17, v25
    v_add_f32 v18, v18, v26
    v_add_f32 v19, v19, v27
    v_add_f32 v20, v20, v28
    v_add_f32 v21, v21, v29
    v_add_f32 v22, v22, v30
    v_add_f32 v23, v23, v31
    v_lshlrev_b32 v24, 16, v220
    v_and_b32 v25, 0xffff0000, v220
    v_lshlrev_b32 v26, 16, v221
    v_and_b32 v27, 0xffff0000, v221
    s_waitcnt vmcnt(22)
    s_barrier
Ls0_6:
    s_add_u32 m0, s77, 0
    s_add_u32 s43, s70, 0
    buffer_load_dwordx4 v3, s[52:55], s43 offen  lds
    s_add_u32 m0, s77, 2048
    s_add_u32 s43, s70, 28672
    buffer_load_dwordx4 v66, s[52:55], s43 offen  lds
    s_add_u32 m0, s77, 4096
    s_add_u32 s43, s70, 57344
    buffer_load_dwordx4 v3, s[52:55], s43 offen  lds
    s_add_u32 m0, s77, 6144
    s_add_u32 s43, s70, 86016
    buffer_load_dwordx4 v66, s[52:55], s43 offen  lds
    s_add_u32 s70, s70, 114688
    s_add_u32 s38, s71, 768
    s_and_b32 s38, s38, 1023
    s_add_u32 s39, s38, 8192
    s_add_u32 m0, s84, 81920
    s_add_u32 s43, s88, s38
    buffer_load_dwordx4 v2, s[48:51], s43 offen  lds
    s_add_u32 m0, s84, 82944
    s_add_u32 s43, s88, s39
    buffer_load_dwordx4 v14, s[48:51], s43 offen  lds
    v_lshlrev_b32 v28, 16, v222
    v_and_b32 v29, 0xffff0000, v222
    v_lshlrev_b32 v30, 16, v223
    v_and_b32 v31, 0xffff0000, v223
    v_add_f32 v16, v16, v24
    v_add_f32 v17, v17, v25
    v_add_f32 v18, v18, v26
    v_add_f32 v19, v19, v27
    v_add_f32 v20, v20, v28
    v_add_f32 v21, v21, v29
    v_add_f32 v22, v22, v30
    v_add_f32 v23, v23, v31
    s_nop 1
    v_permlane32_swap_b32 v16, v20
    v_permlane32_swap_b32 v17, v21
    v_permlane32_swap_b32 v18, v22
    v_permlane32_swap_b32 v19, v23
    v_add_f32 v16, v16, v20
    v_add_f32 v17, v17, v21
    v_add_f32 v18, v18, v22
    v_add_f32 v19, v19, v23
    s_nop 1
    v_permlane16_swap_b32 v16, v18
    v_permlane16_swap_b32 v17, v19
    v_add_f32 v16, v16, v18
    v_add_f32 v17, v17, v19
    ds_write_b64 v5, v[16:17]
    s_waitcnt lgkmcnt(0)
    s_waitcnt vmcnt(20)
    s_barrier
Ls0_7:
    s_add_u32 m0, s77, 8192
    s_add_u32 s43, s70, 0
    buffer_load_dwordx4 v3, s[52:55], s43 offen  lds
    s_add_u32 m0, s77, 10240
    s_add_u32 s43, s70, 28672
    buffer_load_dwordx4 v66, s[52:55], s43 offen  lds
    s_add_u32 m0, s77, 12288
    s_add_u32 s43, s70, 57344
    buffer_load_dwordx4 v3, s[52:55], s43 offen  lds
    s_add_u32 m0, s77, 14336
    s_add_u32 s43, s70, 86016
    buffer_load_dwordx4 v66, s[52:55], s43 offen  lds
    s_add_u32 s70, s70, 114688
    s_cmp_eq_u32 s70, 1835008
    s_cselect_b32 s70, 0, s70
    s_mov_b32 s56, s12
    s_mov_b32 s57, s13
    s_mov_b32 s58, 2097152
    s_mov_b32 s59, 0x20000
    v_lshlrev_b32 v48, 4, v1
    s_lshl_b32 s80, s2, 13
    v_bfe_u32 v40, v1, 4, 1
    v_lshlrev_b32 v40, 12, v40
    buffer_load_ushort v49, v40, s[56:59], s80 offen
    s_mov_b32 m0, 156768
    s_add_u32 s43, s80, 4098
    buffer_load_dwordx4 v48, s[56:59], s43 offen  lds
    s_mov_b32 m0, 157792
    s_add_u32 s43, s80, 5122
    buffer_load_dwordx4 v48, s[56:59], s43 offen  lds
    s_mov_b32 m0, 158816
    s_add_u32 s43, s80, 6146
    buffer_load_dwordx4 v48, s[56:59], s43 offen  lds
    s_mov_b32 m0, 159840
    s_add_u32 s43, s80, 7170
    buffer_load_dwordx4 v48, s[56:59], s43 offen  lds
    s_waitcnt vmcnt(23)
    s_barrier
Ls0_8:
    s_add_u32 m0, s77, 16384
    s_add_u32 s43, s70, 0
    buffer_load_dwordx4 v3, s[52:55], s43 offen  lds
    s_add_u32 m0, s77, 18432
    s_add_u32 s43, s70, 28672
    buffer_load_dwordx4 v66, s[52:55], s43 offen  lds
    s_add_u32 m0, s77, 20480
    s_add_u32 s43, s70, 57344
    buffer_load_dwordx4 v3, s[52:55], s43 offen  lds
    s_add_u32 m0, s77, 22528
    s_add_u32 s43, s70, 86016
    buffer_load_dwordx4 v66, s[52:55], s43 offen  lds
    s_add_u32 s70, s70, 114688
    s_add_u32 s38, s71, 896
    s_and_b32 s38, s38, 1023
    s_add_u32 s39, s38, 8192
    s_add_u32 m0, s84, 98304
    s_add_u32 s43, s88, s38
    buffer_load_dwordx4 v2, s[48:51], s43 offen  lds
    s_add_u32 m0, s84, 99328
    s_add_u32 s43, s88, s39
    buffer_load_dwordx4 v14, s[48:51], s43 offen  lds
    v_mov_b32 v10, 156672
    ds_read_b64 v[10:11], v10
    s_waitcnt vmcnt(21)
    s_barrier
Ls0_9:
    s_add_u32 m0, s77, 24576
    s_add_u32 s43, s70, 0
    buffer_load_dwordx4 v3, s[52:55], s43 offen  lds
    s_add_u32 m0, s77, 26624
    s_add_u32 s43, s70, 28672
    buffer_load_dwordx4 v66, s[52:55], s43 offen  lds
    s_add_u32 m0, s77, 28672
    s_add_u32 s43, s70, 57344
    buffer_load_dwordx4 v3, s[52:55], s43 offen  lds
    s_add_u32 m0, s77, 30720
    s_add_u32 s43, s70, 86016
    buffer_load_dwordx4 v66, s[52:55], s43 offen  lds
    s_add_u32 s70, s70, 114688
    v_lshrrev_b32 v12, 2, v1
    v_lshlrev_b32 v12, 7, v12
    v_bfe_u32 v13, v1, 3, 1
    v_lshl_add_u32 v12, v13, 6, v12
    v_and_b32 v13, 3, v1
    v_lshl_add_u32 v12, v13, 4, v12
    v_add_u32 v184, s78, v12
    v_xor_b32 v185, 64, v184
    v_add_u32 v186, 0x10000, v184
    v_add_u32 v187, 0x10000, v185
    v_add_u32 v68, 98304, v184
    v_add_u32 v69, 98304, v185
    s_add_u32 s38, s78, 98304
    v_lshl_add_u32 v70, v1, 4, s38
    s_mul_i32 s38, s33, 233472
    s_mul_i32 s39, s74, 14336
    s_add_u32 s38, s38, s39
    v_lshl_add_u32 v190, v1, 4, s38
    s_and_b32 s76, s34, 3
    s_xor_b32 s76, s76, s74
    s_mul_i32 s100, s76, 58368
    s_xor_b32 s38, s76, 1
    s_mul_i32 s98, s38, 58368
    s_xor_b32 s38, s76, 2
    s_mul_i32 s97, s38, 58368
    s_xor_b32 s38, s76, 3
    s_mul_i32 s96, s38, 58368
    s_mul_i32 s38, s33, 28
    s_mul_i32 s39, s74, 7
    s_add_u32 s38, s38, s39
    s_lshl_b32 s38, s38, 7
    s_add_u32 s38, s38, 7864320
    v_min_u32 v12, 6, v1
    v_lshl_add_u32 v12, v12, 7, s38
    s_lshl_b32 s41, s33, 10
    s_add_u32 s41, s41, 7733248
    v_and_b32 v13, 7, v1
    v_cmp_gt_u32 vcc, 8, v1
    v_lshl_add_u32 v13, v13, 7, s41
    s_nop 0
    v_cndmask_b32 v189, v13, v12, vcc
    s_lshl_b32 s38, s74, 2
    s_add_u32 s38, s38, 156704
    v_mov_b32 v71, s38
    s_waitcnt lgkmcnt(0)
    v_readfirstlane_b32 s36, v10
    v_readfirstlane_b32 s37, v11
    s_nop 1
    s_waitcnt vmcnt(21)
    s_barrier
Ls0_10:
    s_add_u32 m0, s77, 32768
    s_add_u32 s43, s70, 0
    buffer_load_dwordx4 v3, s[52:55], s43 offen  lds
    s_add_u32 m0, s77, 34816
    s_add_u32 s43, s70, 28672
    buffer_load_dwordx4 v66, s[52:55], s43 offen  lds
    s_add_u32 m0, s77, 36864
    s_add_u32 s43, s70, 57344
    buffer_load_dwordx4 v3, s[52:55], s43 offen  lds
    s_add_u32 m0, s77, 38912
    s_add_u32 s43, s70, 86016
    buffer_load_dwordx4 v66, s[52:55], s43 offen  lds
    s_add_u32 s70, s70, 114688
    s_mov_b32 m0, 123040
    s_add_u32 s43, s80, 4096
    buffer_load_dwordx4 v48, s[56:59], s43 offen  lds
    s_mov_b32 m0, 124064
    s_add_u32 s43, s80, 5120
    buffer_load_dwordx4 v48, s[56:59], s43 offen  lds
    s_mov_b32 m0, 125088
    s_add_u32 s43, s80, 6144
    buffer_load_dwordx4 v48, s[56:59], s43 offen  lds
    s_mov_b32 m0, 126112
    s_add_u32 s43, s80, 7168
    buffer_load_dwordx4 v48, s[56:59], s43 offen  lds
    s_waitcnt vmcnt(23)
    s_barrier
Ls0_11:
    s_add_u32 m0, s77, 0
    s_add_u32 s43, s70, 0
    buffer_load_dwordx4 v3, s[52:55], s43 offen  lds
    s_add_u32 m0, s77, 2048
    s_add_u32 s43, s70, 28672
    buffer_load_dwordx4 v66, s[52:55], s43 offen  lds
    s_add_u32 m0, s77, 4096
    s_add_u32 s43, s70, 57344
    buffer_load_dwordx4 v3, s[52:55], s43 offen  lds
    s_add_u32 m0, s77, 6144
    s_add_u32 s43, s70, 86016
    buffer_load_dwordx4 v66, s[52:55], s43 offen  lds
    s_add_u32 s70, s70, 114688
    s_cmp_eq_u32 s70, 1835008
    s_cselect_b32 s70, 0, s70
    s_mov_b32 m0, 118880
    s_add_u32 s43, s80, 2
    buffer_load_dwordx4 v48, s[56:59], s43 offen  lds
    s_mov_b32 m0, 119904
    s_add_u32 s43, s80, 1026
    buffer_load_dwordx4 v48, s[56:59], s43 offen  lds
    s_mov_b32 m0, 120928
    s_add_u32 s43, s80, 2050
    buffer_load_dwordx4 v48, s[56:59], s43 offen  lds
    s_mov_b32 m0, 121952
    s_add_u32 s43, s80, 3074
    buffer_load_dwordx4 v48, s[56:59], s43 offen  lds
    s_waitcnt vmcnt(22)
    s_barrier
Ls0_12:
    s_lshl_b32 s38, s31, 11
    s_add_u32 s38, s38, 7733248
    s_lshl_b32 s39, s32, 11
    s_add_u32 s39, s39, 7763968
    v_mov_b32 v4, s38
    v_mov_b32 v5, s39
    v_cmp_gt_u32 vcc, 16, v1
    v_min_u32 v6, 31, v1
    v_lshlrev_b32 v7, 4, v1
    v_cndmask_b32 v4, v5, v4, vcc
    v_lshl_add_u32 v4, v6, 7, v4
    buffer_load_dwordx2 v[8:9], v4, s[44:47], 0 offen sc1
    v_lshrrev_b32 v10, 4, v1
    v_lshlrev_b32 v5, 1, v10
    v_and_b32 v6, 15, v1
    v_xor_b32 v5, v5, v6
    v_lshlrev_b32 v5, 4, v5
    v_mul_u32_u24 v6, 3584, v10
    s_lshl_b32 s40, s32, 8
    v_add3_u32 v6, v5, v6, s40
    v_xor_b32 v5, 128, v6
    s_mov_b32 m0, 114720
    s_add_u32 s43, s80, 0
    buffer_load_dwordx4 v48, s[56:59], s43 offen  lds
    s_mov_b32 m0, 115744
    s_add_u32 s43, s80, 1024
    buffer_load_dwordx4 v48, s[56:59], s43 offen  lds
    s_mov_b32 m0, 116768
    s_add_u32 s43, s80, 2048
    buffer_load_dwordx4 v48, s[56:59], s43 offen  lds
    s_mov_b32 m0, 117792
    s_add_u32 s43, s80, 3072
    buffer_load_dwordx4 v48, s[56:59], s43 offen  lds
    v_bfe_u32 v40, v1, 3, 2
    v_mul_u32_u24 v41, 4160, v40
    v_cmp_eq_u32 vcc, 3, v40
    v_mov_b32 v42, 42048
    v_and_b32 v40, 7, v1
    v_cndmask_b32 v41, v41, v42, vcc
    v_lshl_add_u32 v41, v40, 2, v41
    v_and_b32 v40, 15, v1
    v_cmp_eq_u32 vcc, 15, v40
    v_add_u32 v41, 114688, v41
    v_lshlrev_b32 v42, 3, v1
    v_add_u32 v42, 131264, v42
    v_mov_b32 v44, 0
    v_mov_b32 v45, 0
    v_lshlrev_b32 v49, 16, v49
    v_cndmask_b32 v49, 0, v49, vcc
    ds_write_b32 v41, v49
    ds_write_b64 v42, v[44:45]
    ds_write_b64 v42, v[44:45] offset:4608
    s_lshl_b32 s38, s64, 5
    s_add_u32 m0, s78, 8192
    s_add_u32 s43, s38, 131072
    buffer_load_dwordx4 v188, s[92:95], s43 offen lds
    s_add_u32 m0, s78, 9216
    s_add_u32 s43, s38, 139264
    buffer_load_dwordx4 v188, s[92:95], s43 offen lds
    s_waitcnt vmcnt(23)
    s_barrier
Ls0_13:
    s_mov_b32 s42, 65536
    s_waitcnt vmcnt(6)
    s_branch Lpollc_11
Lpoll_9:
    buffer_load_dwordx2 v[8:9], v4, s[44:47], 0 offen sc1
    s_waitcnt vmcnt(0)
Lpollc_11:
    v_cmp_ne_u64 s[68:69], s[36:37], v[8:9]
    s_cmp_eq_u64 s[68:69], 0
    s_cbranch_scc1 Lpolld_10
    s_sleep 0
    s_sub_u32 s42, s42, 1
    s_cmp_lg_u32 s42, 0
    s_cbranch_scc1 Lpoll_9
Lpolld_10:
    s_mov_b32 m0, 155648
    s_lshl_b32 s43, s31, 10
    s_add_u32 s43, s43, 7602176
    buffer_load_dwordx4 v7, s[44:47], s43 offen sc1 lds
    s_mov_b32 m0, 147456
    s_mov_b32 s43, 7618560
    buffer_load_dwordx4 v6, s[44:47], s43 offen sc1 lds
    s_mov_b32 m0, 148480
    s_mov_b32 s43, 7632896
    buffer_load_dwordx4 v6, s[44:47], s43 offen sc1 lds
    s_mov_b32 m0, 149504
    s_mov_b32 s43, 7647232
    buffer_load_dwordx4 v5, s[44:47], s43 offen sc1 lds
    s_mov_b32 m0, 150528
    s_mov_b32 s43, 7661568
    buffer_load_dwordx4 v5, s[44:47], s43 offen sc1 lds
    s_mov_b32 m0, 151552
    s_mov_b32 s43, 7675904
    buffer_load_dwordx4 v6, s[44:47], s43 offen sc1 lds
    s_mov_b32 m0, 152576
    s_mov_b32 s43, 7690240
    buffer_load_dwordx4 v6, s[44:47], s43 offen sc1 lds
    s_mov_b32 m0, 153600
    s_mov_b32 s43, 7704576
    buffer_load_dwordx4 v5, s[44:47], s43 offen sc1 lds
    s_mov_b32 m0, 154624
    s_mov_b32 s43, 7718912
    buffer_load_dwordx4 v5, s[44:47], s43 offen sc1 lds
    s_barrier
Ls0_14:
    s_lshl_b32 s38, s64, 5
    s_add_u32 m0, s78, 49152
    s_add_u32 s43, s38, 147456
    buffer_load_dwordx4 v188, s[92:95], s43 offen lds
    s_add_u32 m0, s78, 50176
    s_add_u32 s43, s38, 155648
    buffer_load_dwordx4 v188, s[92:95], s43 offen lds
    s_lshl_b32 s38, s65, 5
    s_add_u32 m0, s78, 16384
    s_add_u32 s43, s38, 131072
    buffer_load_dwordx4 v188, s[92:95], s43 offen lds
    s_add_u32 m0, s78, 17408
    s_add_u32 s43, s38, 139264
    buffer_load_dwordx4 v188, s[92:95], s43 offen lds
    s_lshl_b32 s38, s65, 5
    s_add_u32 m0, s78, 57344
    s_add_u32 s43, s38, 147456
    buffer_load_dwordx4 v188, s[92:95], s43 offen lds
    s_add_u32 m0, s78, 58368
    s_add_u32 s43, s38, 155648
    buffer_load_dwordx4 v188, s[92:95], s43 offen lds
    s_lshl_b32 s38, s64, 5
    s_add_u32 m0, s78, 24576
    s_add_u32 s43, s38, 262144
    buffer_load_dwordx4 v188, s[92:95], s43 offen lds
    s_add_u32 m0, s78, 25600
    s_add_u32 s43, s38, 270336
    buffer_load_dwordx4 v188, s[92:95], s43 offen lds
    s_lshl_b32 s38, s64, 5
    s_add_u32 m0, s78, 65536
    s_add_u32 s43, s38, 278528
    buffer_load_dwordx4 v188, s[92:95], s43 offen lds
    s_add_u32 m0, s78, 66560
    s_add_u32 s43, s38, 286720
    buffer_load_dwordx4 v188, s[92:95], s43 offen lds
    s_barrier
Ls0_15:
    s_waitcnt vmcnt(21)
    s_waitcnt lgkmcnt(0)
    s_lshl_b32 s38, s65, 5
    s_add_u32 m0, s78, 81920
    s_add_u32 s43, s38, 262144
    buffer_load_dwordx4 v188, s[92:95], s43 offen lds
    s_add_u32 m0, s78, 82944
    s_add_u32 s43, s38, 270336
    buffer_load_dwordx4 v188, s[92:95], s43 offen lds
    s_lshl_b32 s38, s65, 5
    s_add_u32 m0, s78, 90112
    s_add_u32 s43, s38, 278528
    buffer_load_dwordx4 v188, s[92:95], s43 offen lds
    s_add_u32 m0, s78, 91136
    s_add_u32 s43, s38, 286720
    buffer_load_dwordx4 v188, s[92:95], s43 offen lds
    s_lshl_b32 s38, s66, 5
    s_add_u32 m0, s78, 32768
    s_add_u32 s43, s38, 393216
    buffer_load_dwordx4 v188, s[92:95], s43 offen lds
    s_add_u32 m0, s78, 33792
    s_add_u32 s43, s38, 401408
    buffer_load_dwordx4 v188, s[92:95], s43 offen lds
    s_lshl_b32 s38, s66, 5
    s_add_u32 m0, s78, 73728
    s_add_u32 s43, s38, 409600
    buffer_load_dwordx4 v188, s[92:95], s43 offen lds
    s_add_u32 m0, s78, 74752
    s_add_u32 s43, s38, 417792
    buffer_load_dwordx4 v188, s[92:95], s43 offen lds
    s_waitcnt vmcnt(18)
    s_barrier
Ls0_16:
    s_mov_b32 s75, 0
    s_branch Lg2
    .fill ((Lbase - .) & 4095) / 4, 4, 0xBF800000
Lh1:
    s_and_b32 s38, s79, 1
    v_lshrrev_b32 v4, 4, v1
    v_lshlrev_b32 v5, 1, v4
    v_and_b32 v6, 15, v1
    v_xor_b32 v5, v5, v6
    v_lshlrev_b32 v5, 4, v5
    v_lshl_add_u32 v5, v4, 8, v5
    s_mul_i32 s39, s38, 40960
    v_add_u32 v8, s39, v5
    v_xor_b32 v9, 128, v8
    v_lshlrev_b32 v5, 3, v1
    v_add_u32 v5, 155648, v5
    s_and_b32 s38, s34, 3
    s_cmp_eq_u32 s38, 3
    s_cselect_b32 s38, 4, 0
    s_xor_b32 s34, s34, s38
    s_mov_b32 s92, s22
    s_mov_b32 s93, s23
    s_mov_b32 s94, 1835008
    s_mov_b32 s95, 0x20000
    s_lshr_b32 s38, s34, 2
    s_add_u32 s38, s38, s79
    s_and_b32 s38, s38, 1
    s_lshl_b32 s66, s38, 10
    s_xor_b32 s67, s66, 1024
    s_lshl_b32 s64, s66, 1
    s_lshl_b32 s65, s67, 1
    v_bfe_u32 v188, v1, 4, 1
    v_lshlrev_b32 v188, 2, v188
    v_and_b32 v12, 7, v1
    v_xor_b32 v188, v188, v12
    v_lshlrev_b32 v188, 4, v188
    v_lshrrev_b32 v12, 3, v1
    v_lshl_add_u32 v188, v12, 10, v188
    s_mul_i32 s38, s74, 458752
    s_lshl_b32 s39, s34, 7
    s_add_u32 s38, s38, s39
    v_add_u32 v188, s38, v188
    s_lshl_b32 s78, s74, 11
    v_lshrrev_b32 v12, 2, v1
    v_lshlrev_b32 v12, 7, v12
    v_bfe_u32 v13, v1, 3, 1
    v_lshl_add_u32 v12, v13, 6, v12
    v_and_b32 v13, 3, v1
    v_lshl_add_u32 v12, v13, 4, v12
    v_add_u32 v184, s78, v12
    v_xor_b32 v185, 64, v184
    v_add_u32 v186, 0x10000, v184
    v_add_u32 v187, 0x10000, v185
    v_add_u32 v68, 98304, v184
    v_add_u32 v69, 98304, v185
    s_add_u32 s38, s78, 98304
    v_lshl_add_u32 v70, v1, 4, s38
    s_mul_i32 s38, s33, 233472
    s_mul_i32 s39, s74, 14336
    s_add_u32 s38, s38, s39
    v_lshl_add_u32 v190, v1, 4, s38
    s_and_b32 s76, s34, 3
    s_xor_b32 s76, s76, s74
    s_mul_i32 s100, s76, 58368
    s_xor_b32 s38, s76, 1
    s_mul_i32 s98, s38, 58368
    s_xor_b32 s38, s76, 2
    s_mul_i32 s97, s38, 58368
    s_xor_b32 s38, s76, 3
    s_mul_i32 s96, s38, 58368
    s_mul_i32 s38, s33, 28
    s_mul_i32 s39, s74, 7
    s_add_u32 s38, s38, s39
    s_lshl_b32 s38, s38, 7
    s_add_u32 s38, s38, 7864320
    v_min_u32 v12, 6, v1
    v_lshl_add_u32 v12, v12, 7, s38
    s_lshl_b32 s41, s33, 10
    s_add_u32 s41, s41, 7733248
    v_and_b32 v13, 7, v1
    v_cmp_gt_u32 vcc, 8, v1
    v_lshl_add_u32 v13, v13, 7, s41
    s_nop 0
    v_cndmask_b32 v189, v13, v12, vcc
    s_lshl_b32 s38, s74, 2
    s_add_u32 s38, s38, 156704
    v_mov_b32 v71, s38
    s_waitcnt vmcnt(4)
    s_barrier
Ls1_0:
    s_add_u32 m0, s77, 16384
    s_add_u32 s43, s70, 0
    buffer_load_dwordx4 v3, s[52:55], s43 offen  lds
    s_add_u32 m0, s77, 18432
    s_add_u32 s43, s70, 28672
    buffer_load_dwordx4 v66, s[52:55], s43 offen  lds
    s_add_u32 m0, s77, 20480
    s_add_u32 s43, s70, 57344
    buffer_load_dwordx4 v3, s[52:55], s43 offen  lds
    s_add_u32 m0, s77, 22528
    s_add_u32 s43, s70, 86016
    buffer_load_dwordx4 v66, s[52:55], s43 offen  lds
    s_add_u32 s70, s70, 114688
    s_waitcnt vmcnt(4)
    s_barrier
Ls1_1:
    s_bitcmp1_b32 s79, 1
    s_cbranch_scc1 Lcs_12
    ds_read_b128 v[192:195], v8 offset:8192
    ds_read_b128 v[196:199], v8 offset:9216
    ds_read_b128 v[200:203], v9 offset:10240
    ds_read_b128 v[204:207], v9 offset:11264
    ds_read_b128 v[208:211], v8 offset:12288
    ds_read_b128 v[212:215], v8 offset:13312
    ds_read_b128 v[216:219], v9 offset:14336
    ds_read_b128 v[220:223], v9 offset:15360
Lcs_12:
    s_add_u32 m0, s77, 24576
    s_add_u32 s43, s70, 0
    buffer_load_dwordx4 v3, s[52:55], s43 offen  lds
    s_add_u32 m0, s77, 26624
    s_add_u32 s43, s70, 28672
    buffer_load_dwordx4 v66, s[52:55], s43 offen  lds
    s_add_u32 m0, s77, 28672
    s_add_u32 s43, s70, 57344
    buffer_load_dwordx4 v3, s[52:55], s43 offen  lds
    s_add_u32 m0, s77, 30720
    s_add_u32 s43, s70, 86016
    buffer_load_dwordx4 v66, s[52:55], s43 offen  lds
    s_add_u32 s70, s70, 114688
    s_cmp_eq_u32 s70, 1835008
    s_cselect_b32 s70, 0, s70
    s_waitcnt lgkmcnt(0)
    s_lshl_b32 s38, s64, 5
    s_add_u32 s43, s38, 0
    buffer_load_dwordx4 v[72:75], v188, s[92:95], s43 offen
    s_add_u32 s43, s38, 8192
    buffer_load_dwordx4 v[76:79], v188, s[92:95], s43 offen
    s_waitcnt vmcnt(6)
    s_barrier
Ls1_2:
    s_add_u32 m0, s77, 32768
    s_add_u32 s43, s70, 0
    buffer_load_dwordx4 v3, s[52:55], s43 offen  lds
    s_add_u32 m0, s77, 34816
    s_add_u32 s43, s70, 28672
    buffer_load_dwordx4 v66, s[52:55], s43 offen  lds
    s_add_u32 m0, s77, 36864
    s_add_u32 s43, s70, 57344
    buffer_load_dwordx4 v3, s[52:55], s43 offen  lds
    s_add_u32 m0, s77, 38912
    s_add_u32 s43, s70, 86016
    buffer_load_dwordx4 v66, s[52:55], s43 offen  lds
    s_add_u32 s70, s70, 114688
    s_lshl_b32 s38, s64, 5
    s_add_u32 s43, s38, 16384
    buffer_load_dwordx4 v[80:83], v188, s[92:95], s43 offen
    s_add_u32 s43, s38, 24576
    buffer_load_dwordx4 v[84:87], v188, s[92:95], s43 offen
    s_and_b32 s38, s79, 1
    s_mul_i32 s38, s38, 57344
    s_and_b32 s40, s31, 14
    s_mul_i32 s40, s40, 3584
    s_add_u32 s38, s38, s40
    s_lshl_b32 s40, s32, 8
    s_add_u32 s38, s38, s40
    s_add_u32 s80, s38, 7618560
    v_lshlrev_b32 v7, 2, v4
    v_lshl_add_u32 v7, v6, 4, v7
    s_lshl_b32 s38, s32, 4
    s_add_u32 s38, s38, s31
    s_lshl_b32 s38, s38, 7
    s_add_u32 s81, s38, 7766016
    s_waitcnt vmcnt(8)
    s_barrier
Ls1_3:
    s_bitcmp0_b32 s79, 1
    s_cbranch_scc1 Lcs_13
    ds_read_b128 v[192:195], v8 offset:24576
    ds_read_b128 v[196:199], v8 offset:25600
    ds_read_b128 v[200:203], v9 offset:26624
    ds_read_b128 v[204:207], v9 offset:27648
    ds_read_b128 v[208:211], v8 offset:28672
    ds_read_b128 v[212:215], v8 offset:29696
    ds_read_b128 v[216:219], v9 offset:30720
    ds_read_b128 v[220:223], v9 offset:31744
Lcs_13:
    s_add_u32 m0, s77, 0
    s_add_u32 s43, s70, 0
    buffer_load_dwordx4 v3, s[52:55], s43 offen  lds
    s_add_u32 m0, s77, 2048
    s_add_u32 s43, s70, 28672
    buffer_load_dwordx4 v66, s[52:55], s43 offen  lds
    s_add_u32 m0, s77, 4096
    s_add_u32 s43, s70, 57344
    buffer_load_dwordx4 v3, s[52:55], s43 offen  lds
    s_add_u32 m0, s77, 6144
    s_add_u32 s43, s70, 86016
    buffer_load_dwordx4 v66, s[52:55], s43 offen  lds
    s_add_u32 s70, s70, 114688
    s_waitcnt lgkmcnt(0)
    s_lshl_b32 s38, s65, 5
    s_add_u32 s43, s38, 0
    buffer_load_dwordx4 v[88:91], v188, s[92:95], s43 offen
    s_add_u32 s43, s38, 8192
    buffer_load_dwordx4 v[92:95], v188, s[92:95], s43 offen
    v_lshlrev_b32 v16, 16, v192
    v_and_b32 v17, 0xffff0000, v192
    v_lshlrev_b32 v18, 16, v193
    v_and_b32 v19, 0xffff0000, v193
    v_lshlrev_b32 v20, 16, v194
    v_and_b32 v21, 0xffff0000, v194
    v_lshlrev_b32 v22, 16, v195
    v_and_b32 v23, 0xffff0000, v195
    v_lshlrev_b32 v24, 16, v196
    v_and_b32 v25, 0xffff0000, v196
    v_lshlrev_b32 v26, 16, v197
    v_and_b32 v27, 0xffff0000, v197
    v_lshlrev_b32 v28, 16, v198
    v_and_b32 v29, 0xffff0000, v198
    v_lshlrev_b32 v30, 16, v199
    v_and_b32 v31, 0xffff0000, v199
    v_add_f32 v16, v16, v24
    v_add_f32 v17, v17, v25
    v_add_f32 v18, v18, v26
    v_add_f32 v19, v19, v27
    v_add_f32 v20, v20, v28
    v_add_f32 v21, v21, v29
    v_add_f32 v22, v22, v30
    v_add_f32 v23, v23, v31
    v_lshlrev_b32 v24, 16, v200
    v_and_b32 v25, 0xffff0000, v200
    v_lshlrev_b32 v26, 16, v201
    s_waitcnt vmcnt(8)
    s_barrier
Ls1_4:
    s_add_u32 m0, s77, 8192
    s_add_u32 s43, s70, 0
    buffer_load_dwordx4 v3, s[52:55], s43 offen  lds
    s_add_u32 m0, s77, 10240
    s_add_u32 s43, s70, 28672
    buffer_load_dwordx4 v66, s[52:55], s43 offen  lds
    s_add_u32 m0, s77, 12288
    s_add_u32 s43, s70, 57344
    buffer_load_dwordx4 v3, s[52:55], s43 offen  lds
    s_add_u32 m0, s77, 14336
    s_add_u32 s43, s70, 86016
    buffer_load_dwordx4 v66, s[52:55], s43 offen  lds
    s_add_u32 s70, s70, 114688
    s_lshl_b32 s38, s65, 5
    s_add_u32 s43, s38, 16384
    buffer_load_dwordx4 v[96:99], v188, s[92:95], s43 offen
    s_add_u32 s43, s38, 24576
    buffer_load_dwordx4 v[100:103], v188, s[92:95], s43 offen
    v_and_b32 v27, 0xffff0000, v201
    v_lshlrev_b32 v28, 16, v202
    v_and_b32 v29, 0xffff0000, v202
    v_lshlrev_b32 v30, 16, v203
    v_and_b32 v31, 0xffff0000, v203
    v_add_f32 v16, v16, v24
    v_add_f32 v17, v17, v25
    v_add_f32 v18, v18, v26
    v_add_f32 v19, v19, v27
    v_add_f32 v20, v20, v28
    v_add_f32 v21, v21, v29
    v_add_f32 v22, v22, v30
    v_add_f32 v23, v23, v31
    v_lshlrev_b32 v24, 16, v204
    v_and_b32 v25, 0xffff0000, v204
    v_lshlrev_b32 v26, 16, v205
    v_and_b32 v27, 0xffff0000, v205
    v_lshlrev_b32 v28, 16, v206
    v_and_b32 v29, 0xffff0000, v206
    v_lshlrev_b32 v30, 16, v207
    v_and_b32 v31, 0xffff0000, v207
    v_add_f32 v16, v16, v24
    v_add_f32 v17, v17, v25
    v_add_f32 v18, v18, v26
    v_add_f32 v19, v19, v27
    v_add_f32 v20, v20, v28
    v_add_f32 v21, v21, v29
    s_waitcnt vmcnt(8)
    s_barrier
Ls1_5:
    s_add_u32 m0, s77, 16384
    s_add_u32 s43, s70, 0
    buffer_load_dwordx4 v3, s[52:55], s43 offen  lds
    s_add_u32 m0, s77, 18432
    s_add_u32 s43, s70, 28672
    buffer_load_dwordx4 v66, s[52:55], s43 offen  lds
    s_add_u32 m0, s77, 20480
    s_add_u32 s43, s70, 57344
    buffer_load_dwordx4 v3, s[52:55], s43 offen  lds
    s_add_u32 m0, s77, 22528
    s_add_u32 s43, s70, 86016
    buffer_load_dwordx4 v66, s[52:55], s43 offen  lds
    s_add_u32 s70, s70, 114688
    s_cmp_eq_u32 s70, 1835008
    s_cselect_b32 s70, 0, s70
    v_add_f32 v22, v22, v30
    v_add_f32 v23, v23, v31
    v_lshlrev_b32 v24, 16, v208
    v_and_b32 v25, 0xffff0000, v208
    v_lshlrev_b32 v26, 16, v209
    v_and_b32 v27, 0xffff0000, v209
    v_lshlrev_b32 v28, 16, v210
    v_and_b32 v29, 0xffff0000, v210
    v_lshlrev_b32 v30, 16, v211
    v_and_b32 v31, 0xffff0000, v211
    v_add_f32 v16, v16, v24
    v_add_f32 v17, v17, v25
    v_add_f32 v18, v18, v26
    v_add_f32 v19, v19, v27
    v_add_f32 v20, v20, v28
    v_add_f32 v21, v21, v29
    v_add_f32 v22, v22, v30
    v_add_f32 v23, v23, v31
    v_lshlrev_b32 v24, 16, v212
    v_and_b32 v25, 0xffff0000, v212
    v_lshlrev_b32 v26, 16, v213
    v_and_b32 v27, 0xffff0000, v213
    v_lshlrev_b32 v28, 16, v214
    v_and_b32 v29, 0xffff0000, v214
    v_lshlrev_b32 v30, 16, v215
    v_and_b32 v31, 0xffff0000, v215
    v_add_f32 v16, v16, v24
    s_waitcnt vmcnt(6)
    s_barrier
Ls1_6:
    s_add_u32 m0, s77, 24576
    s_add_u32 s43, s70, 0
    buffer_load_dwordx4 v3, s[52:55], s43 offen  lds
    s_add_u32 m0, s77, 26624
    s_add_u32 s43, s70, 28672
    buffer_load_dwordx4 v66, s[52:55], s43 offen  lds
    s_add_u32 m0, s77, 28672
    s_add_u32 s43, s70, 57344
    buffer_load_dwordx4 v3, s[52:55], s43 offen  lds
    s_add_u32 m0, s77, 30720
    s_add_u32 s43, s70, 86016
    buffer_load_dwordx4 v66, s[52:55], s43 offen  lds
    s_add_u32 s70, s70, 114688
    v_add_f32 v17, v17, v25
    v_add_f32 v18, v18, v26
    v_add_f32 v19, v19, v27
    v_add_f32 v20, v20, v28
    v_add_f32 v21, v21, v29
    v_add_f32 v22, v22, v30
    v_add_f32 v23, v23, v31
    v_lshlrev_b32 v24, 16, v216
    v_and_b32 v25, 0xffff0000, v216
    v_lshlrev_b32 v26, 16, v217
    v_and_b32 v27, 0xffff0000, v217
    v_lshlrev_b32 v28, 16, v218
    v_and_b32 v29, 0xffff0000, v218
    v_lshlrev_b32 v30, 16, v219
    v_and_b32 v31, 0xffff0000, v219
    v_add_f32 v16, v16, v24
    v_add_f32 v17, v17, v25
    v_add_f32 v18, v18, v26
    v_add_f32 v19, v19, v27
    v_add_f32 v20, v20, v28
    v_add_f32 v21, v21, v29
    v_add_f32 v22, v22, v30
    v_add_f32 v23, v23, v31
    v_lshlrev_b32 v24, 16, v220
    v_and_b32 v25, 0xffff0000, v220
    v_lshlrev_b32 v26, 16, v221
    v_and_b32 v27, 0xffff0000, v221
    s_waitcnt vmcnt(4)
    s_barrier
Ls1_7:
    ds_read_b64 v[34:35], v5
    s_add_u32 m0, s77, 32768
    s_add_u32 s43, s70, 0
    buffer_load_dwordx4 v3, s[52:55], s43 offen  lds
    s_add_u32 m0, s77, 34816
    s_add_u32 s43, s70, 28672
    buffer_load_dwordx4 v66, s[52:55], s43 offen  lds
    s_add_u32 m0, s77, 36864
    s_add_u32 s43, s70, 57344
    buffer_load_dwordx4 v3, s[52:55], s43 offen  lds
    s_add_u32 m0, s77, 38912
    s_add_u32 s43, s70, 86016
    buffer_load_dwordx4 v66, s[52:55], s43 offen  lds
    s_add_u32 s70, s70, 114688
    v_lshlrev_b32 v28, 16, v222
    v_and_b32 v29, 0xffff0000, v222
    v_lshlrev_b32 v30, 16, v223
    v_and_b32 v31, 0xffff0000, v223
    v_add_f32 v16, v16, v24
    v_add_f32 v17, v17, v25
    v_add_f32 v18, v18, v26
    v_add_f32 v19, v19, v27
    v_add_f32 v20, v20, v28
    v_add_f32 v21, v21, v29
    v_add_f32 v22, v22, v30
    v_add_f32 v23, v23, v31
    s_nop 1
    v_permlane32_swap_b32 v16, v20
    v_permlane32_swap_b32 v17, v21
    v_permlane32_swap_b32 v18, v22
    v_permlane32_swap_b32 v19, v23
    v_add_f32 v16, v16, v20
    v_add_f32 v17, v17, v21
    v_add_f32 v18, v18, v22
    v_add_f32 v19, v19, v23
    s_nop 1
    v_permlane16_swap_b32 v16, v18
    v_permlane16_swap_b32 v17, v19
    v_add_f32 v16, v16, v18
    v_add_f32 v17, v17, v19
    s_waitcnt lgkmcnt(0)
    v_add_f32 v16, v16, v34
    v_add_f32 v17, v17, v35
    v_cvt_pk_bf16_f32 v32, v16, v17
    v_lshlrev_b32 v24, 16, v32
    v_and_b32 v25, 0xffff0000, v32
    v_sub_f32 v16, v16, v24
    v_sub_f32 v17, v17, v25
    v_cvt_pk_bf16_f32 v33, v16, v17
    buffer_store_dword v32, v7, s[44:47], s80 offen sc1
    buffer_store_dword v33, v7, s[44:47], s80 offen offset:3584 sc1
    s_waitcnt vmcnt(6)
    s_barrier
Ls1_8:
    s_add_u32 m0, s77, 0
    s_add_u32 s43, s70, 0
    buffer_load_dwordx4 v3, s[52:55], s43 offen  lds
    s_add_u32 m0, s77, 2048
    s_add_u32 s43, s70, 28672
    buffer_load_dwordx4 v66, s[52:55], s43 offen  lds
    s_add_u32 m0, s77, 4096
    s_add_u32 s43, s70, 57344
    buffer_load_dwordx4 v3, s[52:55], s43 offen  lds
    s_add_u32 m0, s77, 6144
    s_add_u32 s43, s70, 86016
    buffer_load_dwordx4 v66, s[52:55], s43 offen  lds
    s_add_u32 s70, s70, 114688
    v_mov_b32 v10, 156672
    ds_read_b64 v[10:11], v10
    s_waitcnt vmcnt(6)
    s_barrier
Ls1_9:
    s_add_u32 m0, s77, 8192
    s_add_u32 s43, s70, 0
    buffer_load_dwordx4 v3, s[52:55], s43 offen  lds
    s_add_u32 m0, s77, 10240
    s_add_u32 s43, s70, 28672
    buffer_load_dwordx4 v66, s[52:55], s43 offen  lds
    s_add_u32 m0, s77, 12288
    s_add_u32 s43, s70, 57344
    buffer_load_dwordx4 v3, s[52:55], s43 offen  lds
    s_add_u32 m0, s77, 14336
    s_add_u32 s43, s70, 86016
    buffer_load_dwordx4 v66, s[52:55], s43 offen  lds
    s_add_u32 s70, s70, 114688
    s_cmp_eq_u32 s70, 1835008
    s_cselect_b32 s70, 0, s70
    s_waitcnt vmcnt(8)
    s_waitcnt lgkmcnt(0)
    v_readfirstlane_b32 s36, v10
    v_readfirstlane_b32 s37, v11
    s_nop 1
    v_mov_b32 v10, s36
    v_mov_b32 v11, s37
    s_mov_b64 exec, 1
    buffer_store_dwordx2 v[10:11], off, s[44:47], s81 sc1
    s_mov_b64 exec, -1
    s_waitcnt vmcnt(5)
    s_barrier
Ls1_10:
    s_add_u32 m0, s77, 16384
    s_add_u32 s43, s70, 0
    buffer_load_dwordx4 v3, s[52:55], s43 offen  lds
    s_add_u32 m0, s77, 18432
    s_add_u32 s43, s70, 28672
    buffer_load_dwordx4 v66, s[52:55], s43 offen  lds
    s_add_u32 m0, s77, 20480
    s_add_u32 s43, s70, 57344
    buffer_load_dwordx4 v3, s[52:55], s43 offen  lds
    s_add_u32 m0, s77, 22528
    s_add_u32 s43, s70, 86016
    buffer_load_dwordx4 v66, s[52:55], s43 offen  lds
    s_add_u32 s70, s70, 114688
    s_add_u32 m0, s77, 24576
    s_add_u32 s43, s70, 0
    buffer_load_dwordx4 v3, s[52:55], s43 offen  lds
    s_add_u32 m0, s77, 26624
    s_add_u32 s43, s70, 28672
    buffer_load_dwordx4 v66, s[52:55], s43 offen  lds
    s_add_u32 m0, s77, 28672
    s_add_u32 s43, s70, 57344
    buffer_load_dwordx4 v3, s[52:55], s43 offen  lds
    s_add_u32 m0, s77, 30720
    s_add_u32 s43, s70, 86016
    buffer_load_dwordx4 v66, s[52:55], s43 offen  lds
    s_add_u32 s70, s70, 114688
    s_waitcnt vmcnt(9)
    s_barrier
Ls1_11:
    s_add_u32 m0, s77, 32768
    s_add_u32 s43, s70, 0
    buffer_load_dwordx4 v3, s[52:55], s43 offen  lds
    s_add_u32 m0, s77, 34816
    s_add_u32 s43, s70, 28672
    buffer_load_dwordx4 v66, s[52:55], s43 offen  lds
    s_add_u32 m0, s77, 36864
    s_add_u32 s43, s70, 57344
    buffer_load_dwordx4 v3, s[52:55], s43 offen  lds
    s_add_u32 m0, s77, 38912
    s_add_u32 s43, s70, 86016
    buffer_load_dwordx4 v66, s[52:55], s43 offen  lds
    s_add_u32 s70, s70, 114688
    s_branch Lw1
Lw1r:
    s_waitcnt vmcnt(8)
    s_barrier
Ls1_12:
    s_add_u32 m0, s77, 0
    s_add_u32 s43, s70, 0
    buffer_load_dwordx4 v3, s[52:55], s43 offen  lds
    s_add_u32 m0, s77, 2048
    s_add_u32 s43, s70, 28672
    buffer_load_dwordx4 v66, s[52:55], s43 offen  lds
    s_add_u32 m0, s77, 4096
    s_add_u32 s43, s70, 57344
    buffer_load_dwordx4 v3, s[52:55], s43 offen  lds
    s_add_u32 m0, s77, 6144
    s_add_u32 s43, s70, 86016
    buffer_load_dwordx4 v66, s[52:55], s43 offen  lds
    s_add_u32 s70, s70, 114688
    s_cmp_eq_u32 s70, 1835008
    s_cselect_b32 s70, 0, s70
    s_branch Lw2
Lw2r:
    s_waitcnt vmcnt(8)
    s_barrier
Ls1_13:
    s_lshl_b32 s38, s64, 5
    s_add_u32 m0, s78, 8192
    s_add_u32 s43, s38, 131072
    buffer_load_dwordx4 v188, s[92:95], s43 offen lds
    s_add_u32 m0, s78, 9216
    s_add_u32 s43, s38, 139264
    buffer_load_dwordx4 v188, s[92:95], s43 offen lds
    s_lshl_b32 s38, s64, 5
    s_add_u32 m0, s78, 49152
    s_add_u32 s43, s38, 147456
    buffer_load_dwordx4 v188, s[92:95], s43 offen lds
    s_add_u32 m0, s78, 50176
    s_add_u32 s43, s38, 155648
    buffer_load_dwordx4 v188, s[92:95], s43 offen lds
    s_lshl_b32 s38, s65, 5
    s_add_u32 m0, s78, 16384
    s_add_u32 s43, s38, 131072
    buffer_load_dwordx4 v188, s[92:95], s43 offen lds
    s_add_u32 m0, s78, 17408
    s_add_u32 s43, s38, 139264
    buffer_load_dwordx4 v188, s[92:95], s43 offen lds
    s_waitcnt vmcnt(10)
    s_barrier
Ls1_14:
    s_lshl_b32 s38, s65, 5
    s_add_u32 m0, s78, 57344
    s_add_u32 s43, s38, 147456
    buffer_load_dwordx4 v188, s[92:95], s43 offen lds
    s_add_u32 m0, s78, 58368
    s_add_u32 s43, s38, 155648
    buffer_load_dwordx4 v188, s[92:95], s43 offen lds
    s_lshl_b32 s38, s64, 5
    s_add_u32 m0, s78, 24576
    s_add_u32 s43, s38, 262144
    buffer_load_dwordx4 v188, s[92:95], s43 offen lds
    s_add_u32 m0, s78, 25600
    s_add_u32 s43, s38, 270336
    buffer_load_dwordx4 v188, s[92:95], s43 offen lds
    s_lshl_b32 s38, s64, 5
    s_add_u32 m0, s78, 65536
    s_add_u32 s43, s38, 278528
    buffer_load_dwordx4 v188, s[92:95], s43 offen lds
    s_add_u32 m0, s78, 66560
    s_add_u32 s43, s38, 286720
    buffer_load_dwordx4 v188, s[92:95], s43 offen lds
    s_lshl_b32 s38, s65, 5
    s_add_u32 m0, s78, 81920
    s_add_u32 s43, s38, 262144
    buffer_load_dwordx4 v188, s[92:95], s43 offen lds
    s_add_u32 m0, s78, 82944
    s_add_u32 s43, s38, 270336
    buffer_load_dwordx4 v188, s[92:95], s43 offen lds
    s_waitcnt vmcnt(14)
    s_barrier
Ls1_15:
    v_lshlrev_b32 v7, 4, v1
    s_lshl_b32 s80, s2, 13
    s_lshr_b32 s40, s2, 5
    s_lshl_b32 s40, s40, 12
    s_add_u32 s40, s40, 7798784
    v_and_b32 v4, 31, v1
    v_lshl_add_u32 v4, v4, 7, s40
    buffer_load_dwordx2 v[8:9], v4, s[44:47], 0 offen sc1
    s_lshl_b32 s38, s65, 5
    s_add_u32 m0, s78, 90112
    s_add_u32 s43, s38, 278528
    buffer_load_dwordx4 v188, s[92:95], s43 offen lds
    s_add_u32 m0, s78, 91136
    s_add_u32 s43, s38, 286720
    buffer_load_dwordx4 v188, s[92:95], s43 offen lds
    s_lshl_b32 s38, s66, 5
    s_add_u32 m0, s78, 32768
    s_add_u32 s43, s38, 393216
    buffer_load_dwordx4 v188, s[92:95], s43 offen lds
    s_add_u32 m0, s78, 33792
    s_add_u32 s43, s38, 401408
    buffer_load_dwordx4 v188, s[92:95], s43 offen lds
    s_lshl_b32 s38, s66, 5
    s_add_u32 m0, s78, 73728
    s_add_u32 s43, s38, 409600
    buffer_load_dwordx4 v188, s[92:95], s43 offen lds
    s_add_u32 m0, s78, 74752
    s_add_u32 s43, s38, 417792
    buffer_load_dwordx4 v188, s[92:95], s43 offen lds
    s_barrier
Ls1_16:
    s_waitcnt vmcnt(6)
    v_cmp_ne_u64 s[68:69], s[36:37], v[8:9]
    s_mov_b32 s75, 1
    s_cmp_eq_u64 s[68:69], 0
    s_cbranch_scc0 Lkv_14
    s_mov_b32 s75, 0
    s_mov_b32 m0, 127168
    s_add_u32 s43, s80, 8392704
    buffer_load_dwordx4 v7, s[44:47], s43 offen sc1 lds
    s_mov_b32 m0, 128192
    s_add_u32 s43, s80, 8393728
    buffer_load_dwordx4 v7, s[44:47], s43 offen sc1 lds
    s_mov_b32 m0, 129216
    s_add_u32 s43, s80, 8394752
    buffer_load_dwordx4 v7, s[44:47], s43 offen sc1 lds
    s_mov_b32 m0, 130240
    s_add_u32 s43, s80, 8395776
    buffer_load_dwordx4 v7, s[44:47], s43 offen sc1 lds
    s_mov_b32 m0, 131776
    s_add_u32 s43, s80, 8396800
    buffer_load_dwordx4 v7, s[44:47], s43 offen sc1 lds
    s_mov_b32 m0, 132800
    s_add_u32 s43, s80, 8397824
    buffer_load_dwordx4 v7, s[44:47], s43 offen sc1 lds
    s_mov_b32 m0, 133824
    s_add_u32 s43, s80, 8398848
    buffer_load_dwordx4 v7, s[44:47], s43 offen sc1 lds
    s_mov_b32 m0, 134848
    s_add_u32 s43, s80, 8399872
    buffer_load_dwordx4 v7, s[44:47], s43 offen sc1 lds
    s_branch Lkv_14d
Lkv_14:
    buffer_load_dwordx2 v[8:9], v4, s[44:47], 0 offen sc1
Lkv_14d:
    s_branch Lg2
    .fill ((Lbase - .) & 4095) / 4, 4, 0xBF800000
Lh2:
    s_add_u32 s38, s34, 1
    s_lshl_b32 s38, s38, 11
    s_add_u32 s84, s38, 0
    s_and_b32 s84, s84, 0x3fff
    s_lshl_b32 s88, s84, 3
    s_add_u32 s88, s88, s75
    s_add_u32 s85, s38, 2048
    s_and_b32 s85, s85, 0x3fff
    s_lshl_b32 s89, s85, 3
    s_add_u32 s89, s89, s75
    s_add_u32 s86, s38, 4096
    s_and_b32 s86, s86, 0x3fff
    s_lshl_b32 s90, s86, 3
    s_add_u32 s90, s90, s75
    s_add_u32 s87, s38, 6144
    s_and_b32 s87, s87, 0x3fff
    s_lshl_b32 s91, s87, 3
    s_add_u32 s91, s91, s75
    s_add_u32 s38, s71, 128
    s_and_b32 s38, s38, 1023
    s_add_u32 s39, s38, 8192
    s_add_u32 m0, s84, 131072
    s_add_u32 s43, s88, s38
    buffer_load_dwordx4 v2, s[48:51], s43 offen  lds
    s_add_u32 m0, s84, 132096
    s_add_u32 s43, s88, s39
    buffer_load_dwordx4 v14, s[48:51], s43 offen  lds
    s_add_u32 m0, s85, 131072
    s_add_u32 s43, s89, s38
    buffer_load_dwordx4 v2, s[48:51], s43 offen  lds
    s_add_u32 m0, s85, 132096
    s_add_u32 s43, s89, s39
    buffer_load_dwordx4 v14, s[48:51], s43 offen  lds
    s_cmp_lg_u32 s2, 2
    s_cbranch_scc1 Lnononce
    s_memrealtime s[40:41]
    s_waitcnt lgkmcnt(0)
    s_or_b32 s40, s40, 1
    v_mov_b32 v4, s40
    v_mov_b32 v5, s41
    v_mov_b32 v6, 0
    v_mov_b32 v7, 0
    s_mov_b64 exec, 1
    global_atomic_cmpswap_x2 v6, v[4:7], s[26:27] sc1
    s_mov_b64 exec, -1
    s_nop 1
Lnononce:
    v_lshlrev_b32 v7, 4, v1
    s_waitcnt vmcnt(8)
    s_barrier
Ls2_0:
    s_add_u32 m0, s77, 16384
    s_add_u32 s43, s70, 0
    buffer_load_dwordx4 v3, s[52:55], s43 offen  lds
    s_add_u32 m0, s77, 18432
    s_add_u32 s43, s70, 28672
    buffer_load_dwordx4 v66, s[52:55], s43 offen  lds
    s_add_u32 m0, s77, 20480
    s_add_u32 s43, s70, 57344
    buffer_load_dwordx4 v3, s[52:55], s43 offen  lds
    s_add_u32 m0, s77, 22528
    s_add_u32 s43, s70, 86016
    buffer_load_dwordx4 v66, s[52:55], s43 offen  lds
    s_add_u32 s70, s70, 114688
    s_add_u32 s38, s71, 128
    s_and_b32 s38, s38, 1023
    s_add_u32 s39, s38, 8192
    s_add_u32 m0, s86, 131072
    s_add_u32 s43, s90, s38
    buffer_load_dwordx4 v2, s[48:51], s43 offen  lds
    s_add_u32 m0, s86, 132096
    s_add_u32 s43, s90, s39
    buffer_load_dwordx4 v14, s[48:51], s43 offen  lds
    s_add_u32 m0, s87, 131072
    s_add_u32 s43, s91, s38
    buffer_load_dwordx4 v2, s[48:51], s43 offen  lds
    s_and_b32 s38, s34, 3
    s_cmp_eq_u32 s38, 3
    s_cselect_b32 s38, 4, 0
    s_xor_b32 s34, s34, s38
    s_mov_b32 s92, s22
    s_mov_b32 s93, s23
    s_mov_b32 s94, 1835008
    s_mov_b32 s95, 0x20000
    s_lshr_b32 s38, s34, 2
    s_add_u32 s38, s38, s79
    s_and_b32 s38, s38, 1
    s_lshl_b32 s66, s38, 10
    s_xor_b32 s67, s66, 1024
    s_lshl_b32 s64, s66, 1
    s_lshl_b32 s65, s67, 1
    v_bfe_u32 v188, v1, 4, 1
    v_lshlrev_b32 v188, 2, v188
    v_and_b32 v12, 7, v1
    v_xor_b32 v188, v188, v12
    v_lshlrev_b32 v188, 4, v188
    v_lshrrev_b32 v12, 3, v1
    v_lshl_add_u32 v188, v12, 10, v188
    s_mul_i32 s38, s74, 458752
    s_lshl_b32 s39, s34, 7
    s_add_u32 s38, s38, s39
    v_add_u32 v188, s38, v188
    s_lshl_b32 s78, s74, 11
    s_waitcnt vmcnt(11)
    s_barrier
Ls2_1:
    s_add_u32 m0, s77, 24576
    s_add_u32 s43, s70, 0
    buffer_load_dwordx4 v3, s[52:55], s43 offen  lds
    s_add_u32 m0, s77, 26624
    s_add_u32 s43, s70, 28672
    buffer_load_dwordx4 v66, s[52:55], s43 offen  lds
    s_add_u32 m0, s77, 28672
    s_add_u32 s43, s70, 57344
    buffer_load_dwordx4 v3, s[52:55], s43 offen  lds
    s_add_u32 m0, s77, 30720
    s_add_u32 s43, s70, 86016
    buffer_load_dwordx4 v66, s[52:55], s43 offen  lds
    s_add_u32 s70, s70, 114688
    s_cmp_eq_u32 s70, 1835008
    s_cselect_b32 s70, 0, s70
    s_add_u32 s38, s71, 256
    s_and_b32 s38, s38, 1023
    s_add_u32 s39, s38, 8192
    s_add_u32 m0, s84, 81920
    s_add_u32 s43, s88, s38
    buffer_load_dwordx4 v2, s[48:51], s43 offen  lds
    s_add_u32 m0, s84, 82944
    s_add_u32 s43, s88, s39
    buffer_load_dwordx4 v14, s[48:51], s43 offen  lds
    s_add_u32 m0, s85, 81920
    s_add_u32 s43, s89, s38
    buffer_load_dwordx4 v2, s[48:51], s43 offen  lds
    s_add_u32 m0, s85, 82944
    s_add_u32 s43, s89, s39
    buffer_load_dwordx4 v14, s[48:51], s43 offen  lds
    s_lshl_b32 s38, s64, 5
    s_add_u32 s43, s38, 0
    buffer_load_dwordx4 v[72:75], v188, s[92:95], s43 offen
    s_add_u32 s43, s38, 8192
    buffer_load_dwordx4 v[76:79], v188, s[92:95], s43 offen
    s_waitcnt vmcnt(10)
    s_barrier
Ls2_2:
    s_add_u32 m0, s77, 32768
    s_add_u32 s43, s70, 0
    buffer_load_dwordx4 v3, s[52:55], s43 offen  lds
    s_add_u32 m0, s77, 34816
    s_add_u32 s43, s70, 28672
    buffer_load_dwordx4 v66, s[52:55], s43 offen  lds
    s_add_u32 m0, s77, 36864
    s_add_u32 s43, s70, 57344
    buffer_load_dwordx4 v3, s[52:55], s43 offen  lds
    s_add_u32 m0, s77, 38912
    s_add_u32 s43, s70, 86016
    buffer_load_dwordx4 v66, s[52:55], s43 offen  lds
    s_add_u32 s70, s70, 114688
    s_add_u32 s38, s71, 256
    s_and_b32 s38, s38, 1023
    s_add_u32 s39, s38, 8192
    s_add_u32 m0, s86, 81920
    s_add_u32 s43, s90, s38
    buffer_load_dwordx4 v2, s[48:51], s43 offen  lds
    s_add_u32 m0, s86, 82944
    s_add_u32 s43, s90, s39
    buffer_load_dwordx4 v14, s[48:51], s43 offen  lds
    s_add_u32 m0, s87, 81920
    s_add_u32 s43, s91, s38
    buffer_load_dwordx4 v2, s[48:51], s43 offen  lds
    s_lshl_b32 s38, s64, 5
    s_add_u32 s43, s38, 16384
    buffer_load_dwordx4 v[80:83], v188, s[92:95], s43 offen
    s_add_u32 s43, s38, 24576
    buffer_load_dwordx4 v[84:87], v188, s[92:95], s43 offen
    s_waitcnt vmcnt(15)
    s_barrier
Ls2_3:
    s_add_u32 m0, s77, 0
    s_add_u32 s43, s70, 0
    buffer_load_dwordx4 v3, s[52:55], s43 offen  lds
    s_add_u32 m0, s77, 2048
    s_add_u32 s43, s70, 28672
    buffer_load_dwordx4 v66, s[52:55], s43 offen  lds
    s_add_u32 m0, s77, 4096
    s_add_u32 s43, s70, 57344
    buffer_load_dwordx4 v3, s[52:55], s43 offen  lds
    s_add_u32 m0, s77, 6144
    s_add_u32 s43, s70, 86016
    buffer_load_dwordx4 v66, s[52:55], s43 offen  lds
    s_add_u32 s70, s70, 114688
    s_add_u32 s38, s71, 384
    s_and_b32 s38, s38, 1023
    s_add_u32 s39, s38, 8192
    s_add_u32 m0, s84, 98304
    s_add_u32 s43, s88, s38
    buffer_load_dwordx4 v2, s[48:51], s43 offen  lds
    s_add_u32 m0, s84, 99328
    s_add_u32 s43, s88, s39
    buffer_load_dwordx4 v14, s[48:51], s43 offen  lds
    s_add_u32 m0, s85, 98304
    s_add_u32 s43, s89, s38
    buffer_load_dwordx4 v2, s[48:51], s43 offen  lds
    s_add_u32 m0, s85, 99328
    s_add_u32 s43, s89, s39
    buffer_load_dwordx4 v14, s[48:51], s43 offen  lds
    s_lshl_b32 s38, s65, 5
    s_add_u32 s43, s38, 0
    buffer_load_dwordx4 v[88:91], v188, s[92:95], s43 offen
    s_add_u32 s43, s38, 8192
    buffer_load_dwordx4 v[92:95], v188, s[92:95], s43 offen
    v_mov_b32 v6, 0
    global_load_dwordx2 v[8:9], v6, s[26:27] sc1
    s_waitcnt vmcnt(13)
    s_barrier
Ls2_4:
    s_add_u32 m0, s77, 8192
    s_add_u32 s43, s70, 0
    buffer_load_dwordx4 v3, s[52:55], s43 offen  lds
    s_add_u32 m0, s77, 10240
    s_add_u32 s43, s70, 28672
    buffer_load_dwordx4 v66, s[52:55], s43 offen  lds
    s_add_u32 m0, s77, 12288
    s_add_u32 s43, s70, 57344
    buffer_load_dwordx4 v3, s[52:55], s43 offen  lds
    s_add_u32 m0, s77, 14336
    s_add_u32 s43, s70, 86016
    buffer_load_dwordx4 v66, s[52:55], s43 offen  lds
    s_add_u32 s70, s70, 114688
    s_add_u32 s38, s71, 384
    s_and_b32 s38, s38, 1023
    s_add_u32 s39, s38, 8192
    s_add_u32 m0, s86, 98304
    s_add_u32 s43, s90, s38
    buffer_load_dwordx4 v2, s[48:51], s43 offen  lds
    s_add_u32 m0, s86, 99328
    s_add_u32 s43, s90, s39
    buffer_load_dwordx4 v14, s[48:51], s43 offen  lds
    s_add_u32 m0, s87, 98304
    s_add_u32 s43, s91, s38
    buffer_load_dwordx4 v2, s[48:51], s43 offen  lds
    s_lshl_b32 s38, s65, 5
    s_add_u32 s43, s38, 16384
    buffer_load_dwordx4 v[96:99], v188, s[92:95], s43 offen
    s_add_u32 s43, s38, 24576
    buffer_load_dwordx4 v[100:103], v188, s[92:95], s43 offen
    s_waitcnt vmcnt(16)
    s_barrier
Ls2_5:
    s_add_u32 m0, s77, 16384
    s_add_u32 s43, s70, 0
    buffer_load_dwordx4 v3, s[52:55], s43 offen  lds
    s_add_u32 m0, s77, 18432
    s_add_u32 s43, s70, 28672
    buffer_load_dwordx4 v66, s[52:55], s43 offen  lds
    s_add_u32 m0, s77, 20480
    s_add_u32 s43, s70, 57344
    buffer_load_dwordx4 v3, s[52:55], s43 offen  lds
    s_add_u32 m0, s77, 22528
    s_add_u32 s43, s70, 86016
    buffer_load_dwordx4 v66, s[52:55], s43 offen  lds
    s_add_u32 s70, s70, 114688
    s_cmp_eq_u32 s70, 1835008
    s_cselect_b32 s70, 0, s70
    s_add_u32 s38, s71, 512
    s_and_b32 s38, s38, 1023
    s_add_u32 s39, s38, 8192
    s_add_u32 m0, s84, 114688
    s_add_u32 s43, s88, s38
    buffer_load_dwordx4 v2, s[48:51], s43 offen  lds
    s_add_u32 m0, s84, 115712
    s_add_u32 s43, s88, s39
    buffer_load_dwordx4 v14, s[48:51], s43 offen  lds
    s_add_u32 m0, s85, 114688
    s_add_u32 s43, s89, s38
    buffer_load_dwordx4 v2, s[48:51], s43 offen  lds
    s_add_u32 m0, s85, 115712
    s_add_u32 s43, s89, s39
    buffer_load_dwordx4 v14, s[48:51], s43 offen  lds
    s_add_u32 m0, s77, 24576
    s_add_u32 s43, s70, 0
    buffer_load_dwordx4 v3, s[52:55], s43 offen  lds
    s_add_u32 m0, s77, 26624
    s_add_u32 s43, s70, 28672
    buffer_load_dwordx4 v66, s[52:55], s43 offen  lds
    s_waitcnt vmcnt(12)
    s_barrier
Ls2_6:
    s_add_u32 m0, s77, 28672
    s_add_u32 s43, s70, 57344
    buffer_load_dwordx4 v3, s[52:55], s43 offen  lds
    s_add_u32 m0, s77, 30720
    s_add_u32 s43, s70, 86016
    buffer_load_dwordx4 v66, s[52:55], s43 offen  lds
    s_add_u32 s70, s70, 114688
    s_add_u32 s38, s71, 512
    s_and_b32 s38, s38, 1023
    s_add_u32 s39, s38, 8192
    s_add_u32 m0, s86, 114688
    s_add_u32 s43, s90, s38
    buffer_load_dwordx4 v2, s[48:51], s43 offen  lds
    s_add_u32 m0, s86, 115712
    s_add_u32 s43, s90, s39
    buffer_load_dwordx4 v14, s[48:51], s43 offen  lds
    s_add_u32 m0, s87, 114688
    s_add_u32 s43, s91, s38
    buffer_load_dwordx4 v2, s[48:51], s43 offen  lds
    s_add_u32 m0, s77, 32768
    s_add_u32 s43, s70, 0
    buffer_load_dwordx4 v3, s[52:55], s43 offen  lds
    s_add_u32 m0, s77, 34816
    s_add_u32 s43, s70, 28672
    buffer_load_dwordx4 v66, s[52:55], s43 offen  lds
    s_add_u32 m0, s77, 36864
    s_add_u32 s43, s70, 57344
    buffer_load_dwordx4 v3, s[52:55], s43 offen  lds
    s_add_u32 m0, s77, 38912
    s_add_u32 s43, s70, 86016
    buffer_load_dwordx4 v66, s[52:55], s43 offen  lds
    s_add_u32 s70, s70, 114688
    s_mov_b32 s42, 65536
    s_branch Lnp_15c
Lnp_15:
    global_load_dwordx2 v[8:9], v6, s[26:27] sc1
    s_waitcnt vmcnt(0)
Lnp_15c:
    v_readfirstlane_b32 s36, v8
    v_readfirstlane_b32 s37, v9
    s_sub_u32 s42, s42, 1
    s_cmp_eq_u32 s42, 0
    s_cbranch_scc1 Lnp_15d
    s_cmp_eq_u32 s36, 0
    s_cbranch_scc1 Lnp_15
Lnp_15d:
    v_mov_b32 v6, 156672
    ds_write_b64 v6, v[8:9]
    s_and_b32 s39, s2, 7
    s_lshl_b32 s39, s39, 5
    s_lshr_b32 s38, s2, 3
    s_add_u32 s39, s39, s38
    s_lshl_b32 s38, s39, 7
    s_add_u32 s80, s38, 7733248
    v_mov_b32 v10, s36
    v_mov_b32 v11, s37
    s_mov_b64 exec, 1
    buffer_store_dwordx2 v[10:11], off, s[44:47], s80 sc1
    s_mov_b64 exec, -1
    s_waitcnt lgkmcnt(0)
    s_waitcnt vmcnt(16)
    s_barrier
Ls2_7:
    s_add_u32 s38, s71, 640
    s_and_b32 s38, s38, 1023
    s_add_u32 s39, s38, 8192
    s_add_u32 m0, s84, 131072
    s_add_u32 s43, s88, s38
    buffer_load_dwordx4 v2, s[48:51], s43 offen  lds
    s_add_u32 m0, s84, 132096
    s_add_u32 s43, s88, s39
    buffer_load_dwordx4 v14, s[48:51], s43 offen  lds
    s_add_u32 m0, s85, 131072
    s_add_u32 s43, s89, s38
    buffer_load_dwordx4 v2, s[48:51], s43 offen  lds
    s_add_u32 m0, s85, 132096
    s_add_u32 s43, s89, s39
    buffer_load_dwordx4 v14, s[48:51], s43 offen  lds
    s_add_u32 m0, s77, 0
    s_add_u32 s43, s70, 0
    buffer_load_dwordx4 v3, s[52:55], s43 offen  lds
    s_add_u32 m0, s77, 2048
    s_add_u32 s43, s70, 28672
    buffer_load_dwordx4 v66, s[52:55], s43 offen  lds
    s_add_u32 m0, s77, 4096
    s_add_u32 s43, s70, 57344
    buffer_load_dwordx4 v3, s[52:55], s43 offen  lds
    s_add_u32 m0, s77, 6144
    s_add_u32 s43, s70, 86016
    buffer_load_dwordx4 v66, s[52:55], s43 offen  lds
    s_add_u32 s70, s70, 114688
    s_add_u32 s38, s71, 640
    s_and_b32 s38, s38, 1023
    s_add_u32 s39, s38, 8192
    s_add_u32 m0, s86, 131072
    s_add_u32 s43, s90, s38
    buffer_load_dwordx4 v2, s[48:51], s43 offen  lds
    s_add_u32 m0, s86, 132096
    s_add_u32 s43, s90, s39
    buffer_load_dwordx4 v14, s[48:51], s43 offen  lds
    s_lshr_b32 s38, s2, 3
    s_lshl_b32 s38, s38, 11
    s_add_u32 s38, s38, 917504
    s_add_u32 s60, s22, s38
    s_addc_u32 s61, s23, 0
    s_load_dwordx2 s[82:83], s[60:61], -917060
    s_load_dwordx2 s[82:83], s[60:61], -458308
    s_load_dwordx2 s[82:83], s[60:61], 444
    s_load_dwordx2 s[82:83], s[60:61], 459196
    s_load_dwordx2 s[82:83], s[60:61], -859716
    s_waitcnt vmcnt(15)
    s_barrier
Ls2_8:
    s_add_u32 s38, s71, 640
    s_and_b32 s38, s38, 1023
    s_add_u32 m0, s87, 131072
    s_add_u32 s43, s91, s38
    buffer_load_dwordx4 v2, s[48:51], s43 offen  lds
    s_add_u32 m0, s77, 8192
    s_add_u32 s43, s70, 0
    buffer_load_dwordx4 v3, s[52:55], s43 offen  lds
    s_add_u32 m0, s77, 10240
    s_add_u32 s43, s70, 28672
    buffer_load_dwordx4 v66, s[52:55], s43 offen  lds
    s_add_u32 m0, s77, 12288
    s_add_u32 s43, s70, 57344
    buffer_load_dwordx4 v3, s[52:55], s43 offen  lds
    s_add_u32 m0, s77, 14336
    s_add_u32 s43, s70, 86016
    buffer_load_dwordx4 v66, s[52:55], s43 offen  lds
    s_add_u32 s70, s70, 114688
    s_cmp_eq_u32 s70, 1835008
    s_cselect_b32 s70, 0, s70
    s_add_u32 s38, s71, 768
    s_and_b32 s38, s38, 1023
    s_add_u32 s39, s38, 8192
    s_add_u32 m0, s84, 81920
    s_add_u32 s43, s88, s38
    buffer_load_dwordx4 v2, s[48:51], s43 offen  lds
    s_add_u32 m0, s84, 82944
    s_add_u32 s43, s88, s39
    buffer_load_dwordx4 v14, s[48:51], s43 offen  lds
    s_add_u32 m0, s85, 81920
    s_add_u32 s43, s89, s38
    buffer_load_dwordx4 v2, s[48:51], s43 offen  lds
    s_add_u32 m0, s85, 82944
    s_add_u32 s43, s89, s39
    buffer_load_dwordx4 v14, s[48:51], s43 offen  lds
    s_load_dwordx2 s[82:83], s[60:61], -400964
    s_load_dwordx2 s[82:83], s[60:61], 57788
    s_load_dwordx2 s[82:83], s[60:61], 516540
    s_load_dwordx2 s[82:83], s[60:61], -802372
    s_load_dwordx2 s[82:83], s[60:61], -343620
    s_waitcnt vmcnt(20)
    s_barrier
Ls2_9:
    s_add_u32 m0, s77, 16384
    s_add_u32 s43, s70, 0
    buffer_load_dwordx4 v3, s[52:55], s43 offen  lds
    s_add_u32 m0, s77, 18432
    s_add_u32 s43, s70, 28672
    buffer_load_dwordx4 v66, s[52:55], s43 offen  lds
    s_add_u32 m0, s77, 20480
    s_add_u32 s43, s70, 57344
    buffer_load_dwordx4 v3, s[52:55], s43 offen  lds
    s_add_u32 m0, s77, 22528
    s_add_u32 s43, s70, 86016
    buffer_load_dwordx4 v66, s[52:55], s43 offen  lds
    s_add_u32 s70, s70, 114688
    s_add_u32 s38, s71, 768
    s_and_b32 s38, s38, 1023
    s_add_u32 s39, s38, 8192
    s_add_u32 m0, s86, 81920
    s_add_u32 s43, s90, s38
    buffer_load_dwordx4 v2, s[48:51], s43 offen  lds
    s_add_u32 m0, s86, 82944
    s_add_u32 s43, s90, s39
    buffer_load_dwordx4 v14, s[48:51], s43 offen  lds
    s_add_u32 m0, s87, 81920
    s_add_u32 s43, s91, s38
    buffer_load_dwordx4 v2, s[48:51], s43 offen  lds
    s_add_u32 m0, s77, 24576
    s_add_u32 s43, s70, 0
    buffer_load_dwordx4 v3, s[52:55], s43 offen  lds
    s_load_dwordx2 s[82:83], s[60:61], 115132
    s_load_dwordx2 s[82:83], s[60:61], 573884
    s_load_dwordx2 s[82:83], s[60:61], -745028
    s_load_dwordx2 s[82:83], s[60:61], -286276
    s_load_dwordx2 s[82:83], s[60:61], 172476
    s_waitcnt vmcnt(16)
    s_barrier
Ls2_10:
    s_add_u32 m0, s77, 26624
    s_add_u32 s43, s70, 28672
    buffer_load_dwordx4 v66, s[52:55], s43 offen  lds
    s_add_u32 m0, s77, 28672
    s_add_u32 s43, s70, 57344
    buffer_load_dwordx4 v3, s[52:55], s43 offen  lds
    s_add_u32 m0, s77, 30720
    s_add_u32 s43, s70, 86016
    buffer_load_dwordx4 v66, s[52:55], s43 offen  lds
    s_add_u32 s70, s70, 114688
    s_add_u32 s38, s71, 896
    s_and_b32 s38, s38, 1023
    s_add_u32 s39, s38, 8192
    s_add_u32 m0, s84, 98304
    s_add_u32 s43, s88, s38
    buffer_load_dwordx4 v2, s[48:51], s43 offen  lds
    s_add_u32 m0, s84, 99328
    s_add_u32 s43, s88, s39
    buffer_load_dwordx4 v14, s[48:51], s43 offen  lds
    s_add_u32 m0, s85, 98304
    s_add_u32 s43, s89, s38
    buffer_load_dwordx4 v2, s[48:51], s43 offen  lds
    s_add_u32 m0, s85, 99328
    s_add_u32 s43, s89, s39
    buffer_load_dwordx4 v14, s[48:51], s43 offen  lds
    s_load_dwordx2 s[82:83], s[60:61], 631228
    s_load_dwordx2 s[82:83], s[60:61], -687684
    s_load_dwordx2 s[82:83], s[60:61], -228932
    s_load_dwordx2 s[82:83], s[60:61], 229820
    s_load_dwordx2 s[82:83], s[60:61], 688572
    s_waitcnt vmcnt(19)
    s_barrier
Ls2_11:
    s_add_u32 m0, s77, 32768
    s_add_u32 s43, s70, 0
    buffer_load_dwordx4 v3, s[52:55], s43 offen  lds
    s_add_u32 m0, s77, 34816
    s_add_u32 s43, s70, 28672
    buffer_load_dwordx4 v66, s[52:55], s43 offen  lds
    s_add_u32 m0, s77, 36864
    s_add_u32 s43, s70, 57344
    buffer_load_dwordx4 v3, s[52:55], s43 offen  lds
    s_add_u32 m0, s77, 38912
    s_add_u32 s43, s70, 86016
    buffer_load_dwordx4 v66, s[52:55], s43 offen  lds
    s_add_u32 s70, s70, 114688
    s_add_u32 s38, s71, 896
    s_and_b32 s38, s38, 1023
    s_add_u32 s39, s38, 8192
    s_add_u32 m0, s86, 98304
    s_add_u32 s43, s90, s38
    buffer_load_dwordx4 v2, s[48:51], s43 offen  lds
    s_add_u32 m0, s86, 99328
    s_add_u32 s43, s90, s39
    buffer_load_dwordx4 v14, s[48:51], s43 offen  lds
    s_add_u32 m0, s87, 98304
    s_add_u32 s43, s91, s38
    buffer_load_dwordx4 v2, s[48:51], s43 offen  lds
    s_add_u32 m0, s77, 0
    s_add_u32 s43, s70, 0
    buffer_load_dwordx4 v3, s[52:55], s43 offen  lds
    s_load_dwordx2 s[82:83], s[60:61], -630340
    s_load_dwordx2 s[82:83], s[60:61], -171588
    s_load_dwordx2 s[82:83], s[60:61], 287164
    s_load_dwordx2 s[82:83], s[60:61], 745916
    s_load_dwordx2 s[82:83], s[60:61], -572996
    s_waitcnt vmcnt(16)
    s_barrier
Ls2_12:
    s_add_u32 m0, s77, 2048
    s_add_u32 s43, s70, 28672
    buffer_load_dwordx4 v66, s[52:55], s43 offen  lds
    s_add_u32 m0, s77, 4096
    s_add_u32 s43, s70, 57344
    buffer_load_dwordx4 v3, s[52:55], s43 offen  lds
    s_add_u32 m0, s77, 6144
    s_add_u32 s43, s70, 86016
    buffer_load_dwordx4 v66, s[52:55], s43 offen  lds
    s_add_u32 s70, s70, 114688
    s_cmp_eq_u32 s70, 1835008
    s_cselect_b32 s70, 0, s70
    v_lshrrev_b32 v12, 2, v1
    v_lshlrev_b32 v12, 7, v12
    v_bfe_u32 v13, v1, 3, 1
    v_lshl_add_u32 v12, v13, 6, v12
    v_and_b32 v13, 3, v1
    v_lshl_add_u32 v12, v13, 4, v12
    v_add_u32 v184, s78, v12
    v_xor_b32 v185, 64, v184
    v_add_u32 v186, 0x10000, v184
    v_add_u32 v187, 0x10000, v185
    v_add_u32 v68, 98304, v184
    v_add_u32 v69, 98304, v185
    s_add_u32 s38, s78, 98304
    v_lshl_add_u32 v70, v1, 4, s38
    s_mul_i32 s38, s33, 233472
    s_mul_i32 s39, s74, 14336
    s_add_u32 s38, s38, s39
    v_lshl_add_u32 v190, v1, 4, s38
    s_and_b32 s76, s34, 3
    s_xor_b32 s76, s76, s74
    s_mul_i32 s100, s76, 58368
    s_xor_b32 s38, s76, 1
    s_mul_i32 s98, s38, 58368
    s_xor_b32 s38, s76, 2
    s_mul_i32 s97, s38, 58368
    s_xor_b32 s38, s76, 3
    s_mul_i32 s96, s38, 58368
    s_mul_i32 s38, s33, 28
    s_mul_i32 s39, s74, 7
    s_add_u32 s38, s38, s39
    s_lshl_b32 s38, s38, 7
    s_add_u32 s38, s38, 7864320
    v_min_u32 v12, 6, v1
    v_lshl_add_u32 v12, v12, 7, s38
    s_lshl_b32 s41, s33, 10
    s_add_u32 s41, s41, 7733248
    v_and_b32 v13, 7, v1
    v_cmp_gt_u32 vcc, 8, v1
    v_lshl_add_u32 v13, v13, 7, s41
    s_nop 0
    v_cndmask_b32 v189, v13, v12, vcc
    s_lshl_b32 s38, s74, 2
    s_add_u32 s38, s38, 156704
    v_mov_b32 v71, s38
    s_load_dwordx2 s[82:83], s[60:61], -114244
    s_load_dwordx2 s[82:83], s[60:61], 344508
    s_load_dwordx2 s[82:83], s[60:61], 803260
    s_load_dwordx2 s[82:83], s[60:61], -515652
    s_load_dwordx2 s[82:83], s[60:61], -56900
    s_waitcnt vmcnt(15)
    s_barrier
Ls2_13:
    s_load_dwordx2 s[82:83], s[60:61], 401852
    s_load_dwordx2 s[82:83], s[60:61], 860604
    s_lshl_b32 s38, s64, 5
    s_add_u32 m0, s78, 8192
    s_add_u32 s43, s38, 131072
    buffer_load_dwordx4 v188, s[92:95], s43 offen lds
    s_add_u32 m0, s78, 9216
    s_add_u32 s43, s38, 139264
    buffer_load_dwordx4 v188, s[92:95], s43 offen lds
    s_lshl_b32 s38, s64, 5
    s_add_u32 m0, s78, 49152
    s_add_u32 s43, s38, 147456
    buffer_load_dwordx4 v188, s[92:95], s43 offen lds
    s_add_u32 m0, s78, 50176
    s_add_u32 s43, s38, 155648
    buffer_load_dwordx4 v188, s[92:95], s43 offen lds
    s_lshl_b32 s38, s65, 5
    s_add_u32 m0, s78, 16384
    s_add_u32 s43, s38, 131072
    buffer_load_dwordx4 v188, s[92:95], s43 offen lds
    s_add_u32 m0, s78, 17408
    s_add_u32 s43, s38, 139264
    buffer_load_dwordx4 v188, s[92:95], s43 offen lds
    s_waitcnt vmcnt(10)
    s_barrier
Ls2_14:
    s_lshl_b32 s38, s65, 5
    s_add_u32 m0, s78, 57344
    s_add_u32 s43, s38, 147456
    buffer_load_dwordx4 v188, s[92:95], s43 offen lds
    s_add_u32 m0, s78, 58368
    s_add_u32 s43, s38, 155648
    buffer_load_dwordx4 v188, s[92:95], s43 offen lds
    s_lshl_b32 s38, s64, 5
    s_add_u32 m0, s78, 24576
    s_add_u32 s43, s38, 262144
    buffer_load_dwordx4 v188, s[92:95], s43 offen lds
    s_add_u32 m0, s78, 25600
    s_add_u32 s43, s38, 270336
    buffer_load_dwordx4 v188, s[92:95], s43 offen lds
    s_lshl_b32 s38, s64, 5
    s_add_u32 m0, s78, 65536
    s_add_u32 s43, s38, 278528
    buffer_load_dwordx4 v188, s[92:95], s43 offen lds
    s_add_u32 m0, s78, 66560
    s_add_u32 s43, s38, 286720
    buffer_load_dwordx4 v188, s[92:95], s43 offen lds
    s_lshl_b32 s38, s65, 5
    s_add_u32 m0, s78, 81920
    s_add_u32 s43, s38, 262144
    buffer_load_dwordx4 v188, s[92:95], s43 offen lds
    s_add_u32 m0, s78, 82944
    s_add_u32 s43, s38, 270336
    buffer_load_dwordx4 v188, s[92:95], s43 offen lds
    s_waitcnt vmcnt(14)
    s_barrier
Ls2_15:
    s_lshl_b32 s38, s65, 5
    s_add_u32 m0, s78, 90112
    s_add_u32 s43, s38, 278528
    buffer_load_dwordx4 v188, s[92:95], s43 offen lds
    s_add_u32 m0, s78, 91136
    s_add_u32 s43, s38, 286720
    buffer_load_dwordx4 v188, s[92:95], s43 offen lds
    s_lshl_b32 s38, s66, 5
    s_add_u32 m0, s78, 32768
    s_add_u32 s43, s38, 393216
    buffer_load_dwordx4 v188, s[92:95], s43 offen lds
    s_add_u32 m0, s78, 33792
    s_add_u32 s43, s38, 401408
    buffer_load_dwordx4 v188, s[92:95], s43 offen lds
    s_lshl_b32 s38, s66, 5
    s_add_u32 m0, s78, 73728
    s_add_u32 s43, s38, 409600
    buffer_load_dwordx4 v188, s[92:95], s43 offen lds
    s_add_u32 m0, s78, 74752
    s_add_u32 s43, s38, 417792
    buffer_load_dwordx4 v188, s[92:95], s43 offen lds
    s_barrier
Ls2_16:
    s_mov_b32 s75, 0
    s_branch Lg2
    .fill ((Lbase - .) & 4095) / 4, 4, 0xBF800000
Lh3:
    s_add_u32 s38, s34, 4
    s_lshl_b32 s38, s38, 11
    s_add_u32 s84, s38, 0
    s_and_b32 s84, s84, 0x3fff
    s_lshl_b32 s88, s84, 3
    s_add_u32 s88, s88, s75
    s_add_u32 s85, s38, 2048
    s_and_b32 s85, s85, 0x3fff
    s_lshl_b32 s89, s85, 3
    s_add_u32 s89, s89, s75
    s_add_u32 s86, s38, 4096
    s_and_b32 s86, s86, 0x3fff
    s_lshl_b32 s90, s86, 3
    s_add_u32 s90, s90, s75
    s_add_u32 s87, s38, 6144
    s_and_b32 s87, s87, 0x3fff
    s_lshl_b32 s91, s87, 3
    s_add_u32 s91, s91, s75
    s_add_u32 s38, s71, 128
    s_and_b32 s38, s38, 1023
    s_add_u32 s39, s38, 8192
    s_add_u32 m0, s84, 132096
    s_add_u32 s43, s88, s39
    buffer_load_dwordx4 v14, s[48:51], s43 offen  lds
    s_add_u32 m0, s85, 131072
    s_add_u32 s43, s89, s38
    buffer_load_dwordx4 v2, s[48:51], s43 offen  lds
    s_add_u32 m0, s85, 132096
    s_add_u32 s43, s89, s39
    buffer_load_dwordx4 v14, s[48:51], s43 offen  lds
    s_and_b32 s38, s34, 3
    s_cmp_eq_u32 s38, 3
    s_cselect_b32 s38, 4, 0
    s_xor_b32 s34, s34, s38
    s_mov_b32 s92, s22
    s_mov_b32 s93, s23
    s_mov_b32 s94, 1835008
    s_mov_b32 s95, 0x20000
    s_lshr_b32 s38, s34, 2
    s_add_u32 s38, s38, s79
    s_and_b32 s38, s38, 1
    s_lshl_b32 s66, s38, 10
    s_xor_b32 s67, s66, 1024
    s_lshl_b32 s64, s66, 1
    s_lshl_b32 s65, s67, 1
    v_bfe_u32 v188, v1, 4, 1
    v_lshlrev_b32 v188, 2, v188
    v_and_b32 v12, 7, v1
    v_xor_b32 v188, v188, v12
    v_lshlrev_b32 v188, 4, v188
    v_lshrrev_b32 v12, 3, v1
    v_lshl_add_u32 v188, v12, 10, v188
    s_mul_i32 s38, s74, 458752
    s_lshl_b32 s39, s34, 7
    s_add_u32 s38, s38, s39
    v_add_u32 v188, s38, v188
    s_lshl_b32 s78, s74, 11
    s_waitcnt vmcnt(7)
    s_barrier
Ls3_0:
    s_add_u32 m0, s77, 16384
    s_add_u32 s43, s70, 0
    buffer_load_dwordx4 v3, s[52:55], s43 offen  lds
    s_add_u32 m0, s77, 18432
    s_add_u32 s43, s70, 28672
    buffer_load_dwordx4 v66, s[52:55], s43 offen  lds
    s_add_u32 m0, s77, 20480
    s_add_u32 s43, s70, 57344
    buffer_load_dwordx4 v3, s[52:55], s43 offen  lds
    s_add_u32 m0, s77, 22528
    s_add_u32 s43, s70, 86016
    buffer_load_dwordx4 v66, s[52:55], s43 offen  lds
    s_add_u32 s70, s70, 114688
    s_add_u32 s38, s71, 128
    s_and_b32 s38, s38, 1023
    s_add_u32 s39, s38, 8192
    s_add_u32 m0, s86, 131072
    s_add_u32 s43, s90, s38
    buffer_load_dwordx4 v2, s[48:51], s43 offen  lds
    s_add_u32 m0, s86, 132096
    s_add_u32 s43, s90, s39
    buffer_load_dwordx4 v14, s[48:51], s43 offen  lds
    s_add_u32 m0, s87, 131072
    s_add_u32 s43, s91, s38
    buffer_load_dwordx4 v2, s[48:51], s43 offen  lds
    s_add_u32 m0, s87, 132096
    s_add_u32 s43, s91, s39
    buffer_load_dwordx4 v14, s[48:51], s43 offen  lds
    s_waitcnt vmcnt(11)
    s_barrier
Ls3_1:
    s_add_u32 m0, s77, 24576
    s_add_u32 s43, s70, 0
    buffer_load_dwordx4 v3, s[52:55], s43 offen  lds
    s_add_u32 m0, s77, 26624
    s_add_u32 s43, s70, 28672
    buffer_load_dwordx4 v66, s[52:55], s43 offen  lds
    s_add_u32 m0, s77, 28672
    s_add_u32 s43, s70, 57344
    buffer_load_dwordx4 v3, s[52:55], s43 offen  lds
    s_add_u32 m0, s77, 30720
    s_add_u32 s43, s70, 86016
    buffer_load_dwordx4 v66, s[52:55], s43 offen  lds
    s_add_u32 s70, s70, 114688
    s_cmp_eq_u32 s70, 1835008
    s_cselect_b32 s70, 0, s70
    s_add_u32 s38, s71, 256
    s_and_b32 s38, s38, 1023
    s_add_u32 s39, s38, 8192
    s_add_u32 m0, s84, 82944
    s_add_u32 s43, s88, s39
    buffer_load_dwordx4 v14, s[48:51], s43 offen  lds
    s_add_u32 m0, s85, 81920
    s_add_u32 s43, s89, s38
    buffer_load_dwordx4 v2, s[48:51], s43 offen  lds
    s_add_u32 m0, s85, 82944
    s_add_u32 s43, s89, s39
    buffer_load_dwordx4 v14, s[48:51], s43 offen  lds
    s_lshl_b32 s38, s64, 5
    s_add_u32 s43, s38, 0
    buffer_load_dwordx4 v[72:75], v188, s[92:95], s43 offen
    s_add_u32 s43, s38, 8192
    buffer_load_dwordx4 v[76:79], v188, s[92:95], s43 offen
    s_waitcnt vmcnt(9)
    s_barrier
Ls3_2:
    s_add_u32 m0, s77, 32768
    s_add_u32 s43, s70, 0
    buffer_load_dwordx4 v3, s[52:55], s43 offen  lds
    s_add_u32 m0, s77, 34816
    s_add_u32 s43, s70, 28672
    buffer_load_dwordx4 v66, s[52:55], s43 offen  lds
    s_add_u32 m0, s77, 36864
    s_add_u32 s43, s70, 57344
    buffer_load_dwordx4 v3, s[52:55], s43 offen  lds
    s_add_u32 m0, s77, 38912
    s_add_u32 s43, s70, 86016
    buffer_load_dwordx4 v66, s[52:55], s43 offen  lds
    s_add_u32 s70, s70, 114688
    s_add_u32 s38, s71, 256
    s_and_b32 s38, s38, 1023
    s_add_u32 s39, s38, 8192
    s_add_u32 m0, s86, 81920
    s_add_u32 s43, s90, s38
    buffer_load_dwordx4 v2, s[48:51], s43 offen  lds
    s_add_u32 m0, s86, 82944
    s_add_u32 s43, s90, s39
    buffer_load_dwordx4 v14, s[48:51], s43 offen  lds
    s_add_u32 m0, s87, 81920
    s_add_u32 s43, s91, s38
    buffer_load_dwordx4 v2, s[48:51], s43 offen  lds
    s_add_u32 m0, s87, 82944
    s_add_u32 s43, s91, s39
    buffer_load_dwordx4 v14, s[48:51], s43 offen  lds
    s_lshl_b32 s38, s64, 5
    s_add_u32 s43, s38, 16384
    buffer_load_dwordx4 v[80:83], v188, s[92:95], s43 offen
    s_add_u32 s43, s38, 24576
    buffer_load_dwordx4 v[84:87], v188, s[92:95], s43 offen
    s_waitcnt vmcnt(15)
    s_barrier
Ls3_3:
    s_add_u32 m0, s77, 0
    s_add_u32 s43, s70, 0
    buffer_load_dwordx4 v3, s[52:55], s43 offen  lds
    s_add_u32 m0, s77, 2048
    s_add_u32 s43, s70, 28672
    buffer_load_dwordx4 v66, s[52:55], s43 offen  lds
    s_add_u32 m0, s77, 4096
    s_add_u32 s43, s70, 57344
    buffer_load_dwordx4 v3, s[52:55], s43 offen  lds
    s_add_u32 m0, s77, 6144
    s_add_u32 s43, s70, 86016
    buffer_load_dwordx4 v66, s[52:55], s43 offen  lds
    s_add_u32 s70, s70, 114688
    s_add_u32 s38, s71, 384
    s_and_b32 s38, s38, 1023
    s_add_u32 s39, s38, 8192
    s_add_u32 m0, s84, 99328
    s_add_u32 s43, s88, s39
    buffer_load_dwordx4 v14, s[48:51], s43 offen  lds
    s_add_u32 m0, s85, 98304
    s_add_u32 s43, s89, s38
    buffer_load_dwordx4 v2, s[48:51], s43 offen  lds
    s_add_u32 m0, s85, 99328
    s_add_u32 s43, s89, s39
    buffer_load_dwordx4 v14, s[48:51], s43 offen  lds
    s_lshl_b32 s38, s65, 5
    s_add_u32 s43, s38, 0
    buffer_load_dwordx4 v[88:91], v188, s[92:95], s43 offen
    s_add_u32 s43, s38, 8192
    buffer_load_dwordx4 v[92:95], v188, s[92:95], s43 offen
    s_waitcnt vmcnt(11)
    s_barrier
Ls3_4:
    s_add_u32 m0, s77, 8192
    s_add_u32 s43, s70, 0
    buffer_load_dwordx4 v3, s[52:55], s43 offen  lds
    s_add_u32 m0, s77, 10240
    s_add_u32 s43, s70, 28672
    buffer_load_dwordx4 v66, s[52:55], s43 offen  lds
    s_add_u32 m0, s77, 12288
    s_add_u32 s43, s70, 57344
    buffer_load_dwordx4 v3, s[52:55], s43 offen  lds
    s_add_u32 m0, s77, 14336
    s_add_u32 s43, s70, 86016
    buffer_load_dwordx4 v66, s[52:55], s43 offen  lds
    s_add_u32 s70, s70, 114688
    s_add_u32 s38, s71, 384
    s_and_b32 s38, s38, 1023
    s_add_u32 s39, s38, 8192
    s_add_u32 m0, s86, 98304
    s_add_u32 s43, s90, s38
    buffer_load_dwordx4 v2, s[48:51], s43 offen  lds
    s_add_u32 m0, s86, 99328
    s_add_u32 s43, s90, s39
    buffer_load_dwordx4 v14, s[48:51], s43 offen  lds
    s_add_u32 m0, s87, 98304
    s_add_u32 s43, s91, s38
    buffer_load_dwordx4 v2, s[48:51], s43 offen  lds
    s_add_u32 m0, s87, 99328
    s_add_u32 s43, s91, s39
    buffer_load_dwordx4 v14, s[48:51], s43 offen  lds
    s_lshl_b32 s38, s65, 5
    s_add_u32 s43, s38, 16384
    buffer_load_dwordx4 v[96:99], v188, s[92:95], s43 offen
    s_add_u32 s43, s38, 24576
    buffer_load_dwordx4 v[100:103], v188, s[92:95], s43 offen
    s_waitcnt vmcnt(15)
    s_barrier
Ls3_5:
    s_add_u32 m0, s77, 16384
    s_add_u32 s43, s70, 0
    buffer_load_dwordx4 v3, s[52:55], s43 offen  lds
    s_add_u32 m0, s77, 18432
    s_add_u32 s43, s70, 28672
    buffer_load_dwordx4 v66, s[52:55], s43 offen  lds
    s_add_u32 m0, s77, 20480
    s_add_u32 s43, s70, 57344
    buffer_load_dwordx4 v3, s[52:55], s43 offen  lds
    s_add_u32 m0, s77, 22528
    s_add_u32 s43, s70, 86016
    buffer_load_dwordx4 v66, s[52:55], s43 offen  lds
    s_add_u32 s70, s70, 114688
    s_cmp_eq_u32 s70, 1835008
    s_cselect_b32 s70, 0, s70
    s_add_u32 s38, s71, 512
    s_and_b32 s38, s38, 1023
    s_add_u32 s39, s38, 8192
    s_add_u32 m0, s84, 115712
    s_add_u32 s43, s88, s39
    buffer_load_dwordx4 v14, s[48:51], s43 offen  lds
    s_add_u32 m0, s85, 114688
    s_add_u32 s43, s89, s38
    buffer_load_dwordx4 v2, s[48:51], s43 offen  lds
    s_add_u32 m0, s85, 115712
    s_add_u32 s43, s89, s39
    buffer_load_dwordx4 v14, s[48:51], s43 offen  lds
    s_add_u32 m0, s77, 24576
    s_add_u32 s43, s70, 0
    buffer_load_dwordx4 v3, s[52:55], s43 offen  lds
    s_add_u32 m0, s77, 26624
    s_add_u32 s43, s70, 28672
    buffer_load_dwordx4 v66, s[52:55], s43 offen  lds
    s_waitcnt vmcnt(11)
    s_barrier
Ls3_6:
    s_add_u32 m0, s77, 28672
    s_add_u32 s43, s70, 57344
    buffer_load_dwordx4 v3, s[52:55], s43 offen  lds
    s_add_u32 m0, s77, 30720
    s_add_u32 s43, s70, 86016
    buffer_load_dwordx4 v66, s[52:55], s43 offen  lds
    s_add_u32 s70, s70, 114688
    s_add_u32 s38, s71, 512
    s_and_b32 s38, s38, 1023
    s_add_u32 s39, s38, 8192
    s_add_u32 m0, s86, 114688
    s_add_u32 s43, s90, s38
    buffer_load_dwordx4 v2, s[48:51], s43 offen  lds
    s_add_u32 m0, s86, 115712
    s_add_u32 s43, s90, s39
    buffer_load_dwordx4 v14, s[48:51], s43 offen  lds
    s_add_u32 m0, s87, 114688
    s_add_u32 s43, s91, s38
    buffer_load_dwordx4 v2, s[48:51], s43 offen  lds
    s_add_u32 m0, s87, 115712
    s_add_u32 s43, s91, s39
    buffer_load_dwordx4 v14, s[48:51], s43 offen  lds
    s_add_u32 m0, s77, 32768
    s_add_u32 s43, s70, 0
    buffer_load_dwordx4 v3, s[52:55], s43 offen  lds
    s_add_u32 m0, s77, 34816
    s_add_u32 s43, s70, 28672
    buffer_load_dwordx4 v66, s[52:55], s43 offen  lds
    s_add_u32 m0, s77, 36864
    s_add_u32 s43, s70, 57344
    buffer_load_dwordx4 v3, s[52:55], s43 offen  lds
    s_add_u32 m0, s77, 38912
    s_add_u32 s43, s70, 86016
    buffer_load_dwordx4 v66, s[52:55], s43 offen  lds
    s_add_u32 s70, s70, 114688
    s_waitcnt vmcnt(15)
    s_barrier
Ls3_7:
    v_mov_b32 v8, 156672
    ds_read_b64 v[8:9], v8
    s_add_u32 s38, s71, 640
    s_and_b32 s38, s38, 1023
    s_add_u32 s39, s38, 8192
    s_add_u32 m0, s84, 132096
    s_add_u32 s43, s88, s39
    buffer_load_dwordx4 v14, s[48:51], s43 offen  lds
    s_add_u32 m0, s85, 131072
    s_add_u32 s43, s89, s38
    buffer_load_dwordx4 v2, s[48:51], s43 offen  lds
    s_add_u32 m0, s85, 132096
    s_add_u32 s43, s89, s39
    buffer_load_dwordx4 v14, s[48:51], s43 offen  lds
    s_add_u32 m0, s77, 0
    s_add_u32 s43, s70, 0
    buffer_load_dwordx4 v3, s[52:55], s43 offen  lds
    s_add_u32 m0, s77, 2048
    s_add_u32 s43, s70, 28672
    buffer_load_dwordx4 v66, s[52:55], s43 offen  lds
    s_add_u32 m0, s77, 4096
    s_add_u32 s43, s70, 57344
    buffer_load_dwordx4 v3, s[52:55], s43 offen  lds
    s_add_u32 m0, s77, 6144
    s_add_u32 s43, s70, 86016
    buffer_load_dwordx4 v66, s[52:55], s43 offen  lds
    s_add_u32 s70, s70, 114688
    s_add_u32 s38, s71, 640
    s_and_b32 s38, s38, 1023
    s_add_u32 s39, s38, 8192
    s_add_u32 m0, s86, 131072
    s_add_u32 s43, s90, s38
    buffer_load_dwordx4 v2, s[48:51], s43 offen  lds
    s_add_u32 m0, s86, 132096
    s_add_u32 s43, s90, s39
    buffer_load_dwordx4 v14, s[48:51], s43 offen  lds
    s_waitcnt lgkmcnt(0)
    v_readfirstlane_b32 s36, v8
    v_readfirstlane_b32 s37, v9
    s_nop 1
    s_waitcnt vmcnt(13)
    s_barrier
Ls3_8:
    s_add_u32 s38, s71, 640
    s_and_b32 s38, s38, 1023
    s_add_u32 s39, s38, 8192
    s_add_u32 m0, s87, 131072
    s_add_u32 s43, s91, s38
    buffer_load_dwordx4 v2, s[48:51], s43 offen  lds
    s_add_u32 m0, s87, 132096
    s_add_u32 s43, s91, s39
    buffer_load_dwordx4 v14, s[48:51], s43 offen  lds
    s_add_u32 m0, s77, 8192
    s_add_u32 s43, s70, 0
    buffer_load_dwordx4 v3, s[52:55], s43 offen  lds
    s_add_u32 m0, s77, 10240
    s_add_u32 s43, s70, 28672
    buffer_load_dwordx4 v66, s[52:55], s43 offen  lds
    s_add_u32 m0, s77, 12288
    s_add_u32 s43, s70, 57344
    buffer_load_dwordx4 v3, s[52:55], s43 offen  lds
    s_add_u32 m0, s77, 14336
    s_add_u32 s43, s70, 86016
    buffer_load_dwordx4 v66, s[52:55], s43 offen  lds
    s_add_u32 s70, s70, 114688
    s_cmp_eq_u32 s70, 1835008
    s_cselect_b32 s70, 0, s70
    s_add_u32 s38, s71, 768
    s_and_b32 s38, s38, 1023
    s_add_u32 s39, s38, 8192
    s_add_u32 m0, s84, 82944
    s_add_u32 s43, s88, s39
    buffer_load_dwordx4 v14, s[48:51], s43 offen  lds
    s_add_u32 m0, s85, 81920
    s_add_u32 s43, s89, s38
    buffer_load_dwordx4 v2, s[48:51], s43 offen  lds
    s_add_u32 m0, s85, 82944
    s_add_u32 s43, s89, s39
    buffer_load_dwordx4 v14, s[48:51], s43 offen  lds
    s_add_u32 m0, s77, 16384
    s_add_u32 s43, s70, 0
    buffer_load_dwordx4 v3, s[52:55], s43 offen  lds
    s_lshr_b32 s38, s2, 3
    s_lshl_b32 s38, s38, 11
    s_add_u32 s38, s38, 918528
    s_add_u32 s60, s22, s38
    s_addc_u32 s61, s23, 0
    s_load_dwordx2 s[82:83], s[60:61], -917060
    s_load_dwordx2 s[82:83], s[60:61], -458308
    s_load_dwordx2 s[82:83], s[60:61], 444
    s_load_dwordx2 s[82:83], s[60:61], 459196
    s_load_dwordx2 s[82:83], s[60:61], -859716
    s_waitcnt vmcnt(19)
    s_barrier
Ls3_9:
    s_add_u32 m0, s77, 18432
    s_add_u32 s43, s70, 28672
    buffer_load_dwordx4 v66, s[52:55], s43 offen  lds
    s_add_u32 m0, s77, 20480
    s_add_u32 s43, s70, 57344
    buffer_load_dwordx4 v3, s[52:55], s43 offen  lds
    s_add_u32 m0, s77, 22528
    s_add_u32 s43, s70, 86016
    buffer_load_dwordx4 v66, s[52:55], s43 offen  lds
    s_add_u32 s70, s70, 114688
    s_add_u32 s38, s71, 768
    s_and_b32 s38, s38, 1023
    s_add_u32 s39, s38, 8192
    s_add_u32 m0, s86, 81920
    s_add_u32 s43, s90, s38
    buffer_load_dwordx4 v2, s[48:51], s43 offen  lds
    s_add_u32 m0, s86, 82944
    s_add_u32 s43, s90, s39
    buffer_load_dwordx4 v14, s[48:51], s43 offen  lds
    s_add_u32 m0, s87, 81920
    s_add_u32 s43, s91, s38
    buffer_load_dwordx4 v2, s[48:51], s43 offen  lds
    s_add_u32 m0, s87, 82944
    s_add_u32 s43, s91, s39
    buffer_load_dwordx4 v14, s[48:51], s43 offen  lds
    s_load_dwordx2 s[82:83], s[60:61], -400964
    s_load_dwordx2 s[82:83], s[60:61], 57788
    s_load_dwordx2 s[82:83], s[60:61], 516540
    s_load_dwordx2 s[82:83], s[60:61], -802372
    s_load_dwordx2 s[82:83], s[60:61], -343620
    s_waitcnt vmcnt(15)
    s_barrier
Ls3_10:
    s_add_u32 m0, s77, 24576
    s_add_u32 s43, s70, 0
    buffer_load_dwordx4 v3, s[52:55], s43 offen  lds
    s_add_u32 m0, s77, 26624
    s_add_u32 s43, s70, 28672
    buffer_load_dwordx4 v66, s[52:55], s43 offen  lds
    s_add_u32 m0, s77, 28672
    s_add_u32 s43, s70, 57344
    buffer_load_dwordx4 v3, s[52:55], s43 offen  lds
    s_add_u32 m0, s77, 30720
    s_add_u32 s43, s70, 86016
    buffer_load_dwordx4 v66, s[52:55], s43 offen  lds
    s_add_u32 s70, s70, 114688
    s_add_u32 s38, s71, 896
    s_and_b32 s38, s38, 1023
    s_add_u32 s39, s38, 8192
    s_add_u32 m0, s84, 99328
    s_add_u32 s43, s88, s39
    buffer_load_dwordx4 v14, s[48:51], s43 offen  lds
    s_add_u32 m0, s85, 98304
    s_add_u32 s43, s89, s38
    buffer_load_dwordx4 v2, s[48:51], s43 offen  lds
    s_add_u32 m0, s85, 99328
    s_add_u32 s43, s89, s39
    buffer_load_dwordx4 v14, s[48:51], s43 offen  lds
    s_add_u32 m0, s77, 32768
    s_add_u32 s43, s70, 0
    buffer_load_dwordx4 v3, s[52:55], s43 offen  lds
    s_load_dwordx2 s[82:83], s[60:61], 115132
    s_load_dwordx2 s[82:83], s[60:61], 573884
    s_load_dwordx2 s[82:83], s[60:61], -745028
    s_load_dwordx2 s[82:83], s[60:61], -286276
    s_load_dwordx2 s[82:83], s[60:61], 172476
    s_waitcnt vmcnt(19)
    s_barrier
Ls3_11:
    s_add_u32 m0, s77, 34816
    s_add_u32 s43, s70, 28672
    buffer_load_dwordx4 v66, s[52:55], s43 offen  lds
    s_add_u32 m0, s77, 36864
    s_add_u32 s43, s70, 57344
    buffer_load_dwordx4 v3, s[52:55], s43 offen  lds
    s_add_u32 m0, s77, 38912
    s_add_u32 s43, s70, 86016
    buffer_load_dwordx4 v66, s[52:55], s43 offen  lds
    s_add_u32 s70, s70, 114688
    s_add_u32 s38, s71, 896
    s_and_b32 s38, s38, 1023
    s_add_u32 s39, s38, 8192
    s_add_u32 m0, s86, 98304
    s_add_u32 s43, s90, s38
    buffer_load_dwordx4 v2, s[48:51], s43 offen  lds
    s_add_u32 m0, s86, 99328
    s_add_u32 s43, s90, s39
    buffer_load_dwordx4 v14, s[48:51], s43 offen  lds
    s_add_u32 m0, s87, 98304
    s_add_u32 s43, s91, s38
    buffer_load_dwordx4 v2, s[48:51], s43 offen  lds
    s_add_u32 m0, s87, 99328
    s_add_u32 s43, s91, s39
    buffer_load_dwordx4 v14, s[48:51], s43 offen  lds
    s_load_dwordx2 s[82:83], s[60:61], 631228
    s_load_dwordx2 s[82:83], s[60:61], -687684
    s_load_dwordx2 s[82:83], s[60:61], -228932
    s_load_dwordx2 s[82:83], s[60:61], 229820
    s_load_dwordx2 s[82:83], s[60:61], 688572
    s_waitcnt vmcnt(15)
    s_barrier
Ls3_12:
    s_add_u32 m0, s77, 0
    s_add_u32 s43, s70, 0
    buffer_load_dwordx4 v3, s[52:55], s43 offen  lds
    s_add_u32 m0, s77, 2048
    s_add_u32 s43, s70, 28672
    buffer_load_dwordx4 v66, s[52:55], s43 offen  lds
    s_add_u32 m0, s77, 4096
    s_add_u32 s43, s70, 57344
    buffer_load_dwordx4 v3, s[52:55], s43 offen  lds
    s_add_u32 m0, s77, 6144
    s_add_u32 s43, s70, 86016
    buffer_load_dwordx4 v66, s[52:55], s43 offen  lds
    s_add_u32 s70, s70, 114688
    s_cmp_eq_u32 s70, 1835008
    s_cselect_b32 s70, 0, s70
    v_lshrrev_b32 v12, 2, v1
    v_lshlrev_b32 v12, 7, v12
    v_bfe_u32 v13, v1, 3, 1
    v_lshl_add_u32 v12, v13, 6, v12
    v_and_b32 v13, 3, v1
    v_lshl_add_u32 v12, v13, 4, v12
    v_add_u32 v184, s78, v12
    v_xor_b32 v185, 64, v184
    v_add_u32 v186, 0x10000, v184
    v_add_u32 v187, 0x10000, v185
    v_add_u32 v68, 98304, v184
    v_add_u32 v69, 98304, v185
    s_add_u32 s38, s78, 98304
    v_lshl_add_u32 v70, v1, 4, s38
    s_mul_i32 s38, s33, 233472
    s_mul_i32 s39, s74, 14336
    s_add_u32 s38, s38, s39
    v_lshl_add_u32 v190, v1, 4, s38
    s_and_b32 s76, s34, 3
    s_xor_b32 s76, s76, s74
    s_mul_i32 s100, s76, 58368
    s_xor_b32 s38, s76, 1
    s_mul_i32 s98, s38, 58368
    s_xor_b32 s38, s76, 2
    s_mul_i32 s97, s38, 58368
    s_xor_b32 s38, s76, 3
    s_mul_i32 s96, s38, 58368
    s_mul_i32 s38, s33, 28
    s_mul_i32 s39, s74, 7
    s_add_u32 s38, s38, s39
    s_lshl_b32 s38, s38, 7
    s_add_u32 s38, s38, 7864320
    v_min_u32 v12, 6, v1
    v_lshl_add_u32 v12, v12, 7, s38
    s_lshl_b32 s41, s33, 10
    s_add_u32 s41, s41, 7733248
    v_and_b32 v13, 7, v1
    v_cmp_gt_u32 vcc, 8, v1
    v_lshl_add_u32 v13, v13, 7, s41
    s_nop 0
    v_cndmask_b32 v189, v13, v12, vcc
    s_lshl_b32 s38, s74, 2
    s_add_u32 s38, s38, 156704
    v_mov_b32 v71, s38
    s_load_dwordx2 s[82:83], s[60:61], -630340
    s_load_dwordx2 s[82:83], s[60:61], -171588
    s_load_dwordx2 s[82:83], s[60:61], 287164
    s_load_dwordx2 s[82:83], s[60:61], 745916
    s_load_dwordx2 s[82:83], s[60:61], -572996
    s_waitcnt vmcnt(15)
    s_barrier
Ls3_13:
    s_load_dwordx2 s[82:83], s[60:61], -114244
    s_load_dwordx2 s[82:83], s[60:61], 344508
    s_load_dwordx2 s[82:83], s[60:61], 803260
    s_load_dwordx2 s[82:83], s[60:61], -515652
    s_load_dwordx2 s[82:83], s[60:61], -56900
    s_lshl_b32 s38, s64, 5
    s_add_u32 m0, s78, 8192
    s_add_u32 s43, s38, 131072
    buffer_load_dwordx4 v188, s[92:95], s43 offen lds
    s_add_u32 m0, s78, 9216
    s_add_u32 s43, s38, 139264
    buffer_load_dwordx4 v188, s[92:95], s43 offen lds
    s_lshl_b32 s38, s64, 5
    s_add_u32 m0, s78, 49152
    s_add_u32 s43, s38, 147456
    buffer_load_dwordx4 v188, s[92:95], s43 offen lds
    s_add_u32 m0, s78, 50176
    s_add_u32 s43, s38, 155648
    buffer_load_dwordx4 v188, s[92:95], s43 offen lds
    s_lshl_b32 s38, s65, 5
    s_add_u32 m0, s78, 16384
    s_add_u32 s43, s38, 131072
    buffer_load_dwordx4 v188, s[92:95], s43 offen lds
    s_add_u32 m0, s78, 17408
    s_add_u32 s43, s38, 139264
    buffer_load_dwordx4 v188, s[92:95], s43 offen lds
    s_waitcnt vmcnt(10)
    s_barrier
Ls3_14:
    s_load_dwordx2 s[82:83], s[60:61], 401852
    s_load_dwordx2 s[82:83], s[60:61], 860604
    s_lshl_b32 s38, s65, 5
    s_add_u32 m0, s78, 57344
    s_add_u32 s43, s38, 147456
    buffer_load_dwordx4 v188, s[92:95], s43 offen lds
    s_add_u32 m0, s78, 58368
    s_add_u32 s43, s38, 155648
    buffer_load_dwordx4 v188, s[92:95], s43 offen lds
    s_lshl_b32 s38, s64, 5
    s_add_u32 m0, s78, 24576
    s_add_u32 s43, s38, 262144
    buffer_load_dwordx4 v188, s[92:95], s43 offen lds
    s_add_u32 m0, s78, 25600
    s_add_u32 s43, s38, 270336
    buffer_load_dwordx4 v188, s[92:95], s43 offen lds
    s_lshl_b32 s38, s64, 5
    s_add_u32 m0, s78, 65536
    s_add_u32 s43, s38, 278528
    buffer_load_dwordx4 v188, s[92:95], s43 offen lds
    s_add_u32 m0, s78, 66560
    s_add_u32 s43, s38, 286720
    buffer_load_dwordx4 v188, s[92:95], s43 offen lds
    s_lshl_b32 s38, s65, 5
    s_add_u32 m0, s78, 81920
    s_add_u32 s43, s38, 262144
    buffer_load_dwordx4 v188, s[92:95], s43 offen lds
    s_add_u32 m0, s78, 82944
    s_add_u32 s43, s38, 270336
    buffer_load_dwordx4 v188, s[92:95], s43 offen lds
    s_waitcnt vmcnt(14)
    s_barrier
Ls3_15:
    s_lshl_b32 s38, s65, 5
    s_add_u32 m0, s78, 90112
    s_add_u32 s43, s38, 278528
    buffer_load_dwordx4 v188, s[92:95], s43 offen lds
    s_add_u32 m0, s78, 91136
    s_add_u32 s43, s38, 286720
    buffer_load_dwordx4 v188, s[92:95], s43 offen lds
    s_lshl_b32 s38, s66, 5
    s_add_u32 m0, s78, 32768
    s_add_u32 s43, s38, 393216
    buffer_load_dwordx4 v188, s[92:95], s43 offen lds
    s_add_u32 m0, s78, 33792
    s_add_u32 s43, s38, 401408
    buffer_load_dwordx4 v188, s[92:95], s43 offen lds
    s_lshl_b32 s38, s66, 5
    s_add_u32 m0, s78, 73728
    s_add_u32 s43, s38, 409600
    buffer_load_dwordx4 v188, s[92:95], s43 offen lds
    s_add_u32 m0, s78, 74752
    s_add_u32 s43, s38, 417792
    buffer_load_dwordx4 v188, s[92:95], s43 offen lds
    s_barrier
Ls3_16:
    s_mov_b32 s75, 0
    s_branch Lg2
Lg2:
    s_setprio 0
    s_mov_b32 s48, s4
    s_mov_b32 s49, s5
    s_mov_b32 s50, 2097152
    s_mov_b32 s51, 0x20000
    s_mov_b32 s56, s24
    s_mov_b32 s57, s25
    s_mov_b32 s58, 2097152
    s_mov_b32 s59, 0x20000
    s_lshl_b32 s38, s67, 5
    s_add_u32 m0, s78, 0
    s_add_u32 s43, s38, 393216
    buffer_load_dwordx4 v188, s[92:95], s43 offen lds
    s_add_u32 m0, s78, 1024
    s_add_u32 s43, s38, 401408
    buffer_load_dwordx4 v188, s[92:95], s43 offen lds
    s_lshl_b32 s38, s67, 5
    s_add_u32 m0, s78, 40960
    s_add_u32 s43, s38, 409600
    buffer_load_dwordx4 v188, s[92:95], s43 offen lds
    s_add_u32 m0, s78, 41984
    s_add_u32 s43, s38, 417792
    buffer_load_dwordx4 v188, s[92:95], s43 offen lds
    s_waitcnt vmcnt(4)
    ds_read_b64_tr_b16 v[104:105], v184 offset:8192
    ds_read_b64_tr_b16 v[108:109], v184 offset:8200
    ds_read_b64_tr_b16 v[112:113], v185 offset:8192
    ds_read_b64_tr_b16 v[116:117], v185 offset:8200
    ds_read_b64_tr_b16 v[106:107], v184 offset:49152
    ds_read_b64_tr_b16 v[110:111], v184 offset:49160
    ds_read_b64_tr_b16 v[114:115], v185 offset:49152
    ds_read_b64_tr_b16 v[118:119], v185 offset:49160
    ds_read_b64_tr_b16 v[120:121], v184 offset:16384
    ds_read_b64_tr_b16 v[124:125], v184 offset:16392
    ds_read_b64_tr_b16 v[128:129], v185 offset:16384
    ds_read_b64_tr_b16 v[132:133], v185 offset:16392
    ds_read_b64_tr_b16 v[122:123], v184 offset:57344
    ds_read_b64_tr_b16 v[126:127], v184 offset:57352
    ds_read_b64_tr_b16 v[130:131], v185 offset:57344
    ds_read_b64_tr_b16 v[134:135], v185 offset:57352
    ds_read_b64_tr_b16 v[136:137], v184 offset:24576
    ds_read_b64_tr_b16 v[140:141], v184 offset:24584
    ds_read_b64_tr_b16 v[144:145], v185 offset:24576
    ds_read_b64_tr_b16 v[148:149], v185 offset:24584
    ds_read_b64_tr_b16 v[138:139], v186 offset:0
    ds_read_b64_tr_b16 v[142:143], v186 offset:8
    ds_read_b64_tr_b16 v[146:147], v187 offset:0
    ds_read_b64_tr_b16 v[150:151], v187 offset:8
    ds_read_b64_tr_b16 v[152:153], v186 offset:16384
    ds_read_b64_tr_b16 v[156:157], v186 offset:16392
    ds_read_b64_tr_b16 v[160:161], v187 offset:16384
    ds_read_b64_tr_b16 v[164:165], v187 offset:16392
    ds_read_b64_tr_b16 v[154:155], v186 offset:24576
    ds_read_b64_tr_b16 v[158:159], v186 offset:24584
    ds_read_b64_tr_b16 v[162:163], v187 offset:24576
    ds_read_b64_tr_b16 v[166:167], v187 offset:24584
    ds_read_b64_tr_b16 v[168:169], v184 offset:32768
    ds_read_b64_tr_b16 v[172:173], v184 offset:32776
    ds_read_b64_tr_b16 v[176:177], v185 offset:32768
    ds_read_b64_tr_b16 v[180:181], v185 offset:32776
    ds_read_b64_tr_b16 v[170:171], v186 offset:8192
    ds_read_b64_tr_b16 v[174:175], v186 offset:8200
    ds_read_b64_tr_b16 v[178:179], v187 offset:8192
    ds_read_b64_tr_b16 v[182:183], v187 offset:8200
    s_waitcnt vmcnt(4)
    s_cmp_eq_u32 s75, 0
    s_cbranch_scc1 Lnvf
    v_lshlrev_b32 v7, 4, v1
    s_lshl_b32 s80, s2, 13
    s_lshr_b32 s40, s2, 5
    s_lshl_b32 s40, s40, 12
    s_add_u32 s40, s40, 7798784
    v_and_b32 v4, 31, v1
    v_lshl_add_u32 v4, v4, 7, s40
    s_mov_b32 s42, 65536
    s_branch Lpollc_18
Lpoll_16:
    buffer_load_dwordx2 v[8:9], v4, s[44:47], 0 offen sc1
    s_waitcnt vmcnt(0)
Lpollc_18:
    v_cmp_ne_u64 s[68:69], s[36:37], v[8:9]
    s_cmp_eq_u64 s[68:69], 0
    s_cbranch_scc1 Lpolld_17
    s_sleep 0
    s_sub_u32 s42, s42, 1
    s_cmp_lg_u32 s42, 0
    s_cbranch_scc1 Lpoll_16
Lpolld_17:
    s_mov_b32 m0, 127168
    s_add_u32 s43, s80, 8392704
    buffer_load_dwordx4 v7, s[44:47], s43 offen sc1 lds
    s_mov_b32 m0, 128192
    s_add_u32 s43, s80, 8393728
    buffer_load_dwordx4 v7, s[44:47], s43 offen sc1 lds
    s_mov_b32 m0, 129216
    s_add_u32 s43, s80, 8394752
    buffer_load_dwordx4 v7, s[44:47], s43 offen sc1 lds
    s_mov_b32 m0, 130240
    s_add_u32 s43, s80, 8395776
    buffer_load_dwordx4 v7, s[44:47], s43 offen sc1 lds
    s_mov_b32 m0, 131776
    s_add_u32 s43, s80, 8396800
    buffer_load_dwordx4 v7, s[44:47], s43 offen sc1 lds
    s_mov_b32 m0, 132800
    s_add_u32 s43, s80, 8397824
    buffer_load_dwordx4 v7, s[44:47], s43 offen sc1 lds
    s_mov_b32 m0, 133824
    s_add_u32 s43, s80, 8398848
    buffer_load_dwordx4 v7, s[44:47], s43 offen sc1 lds
    s_mov_b32 m0, 134848
    s_add_u32 s43, s80, 8399872
    buffer_load_dwordx4 v7, s[44:47], s43 offen sc1 lds
    s_waitcnt vmcnt(0)
Lnvf:
    ds_write_b32 v71, v71
    s_waitcnt lgkmcnt(0)
    s_lshl_b32 s38, s65, 5
    s_add_u32 m0, s78, 8192
    s_add_u32 s43, s38, 32768
    buffer_load_dwordx4 v188, s[92:95], s43 offen lds
    s_add_u32 m0, s78, 9216
    s_add_u32 s43, s38, 40960
    buffer_load_dwordx4 v188, s[92:95], s43 offen lds
    s_cmp_eq_u32 s35, 0
    s_cbranch_scc1 Lntr0
    ds_write_b128 v70, v[72:75] offset:0
    ds_write_b128 v70, v[76:79] offset:1024
    ds_write_b128 v70, v[80:83] offset:8192
    ds_write_b128 v70, v[84:87] offset:9216
    ds_read_b64_tr_b16 v[72:73], v68 offset:0
    ds_read_b64_tr_b16 v[76:77], v68 offset:8
    ds_read_b64_tr_b16 v[80:81], v69 offset:0
    ds_read_b64_tr_b16 v[84:85], v69 offset:8
    ds_read_b64_tr_b16 v[74:75], v68 offset:8192
    ds_read_b64_tr_b16 v[78:79], v68 offset:8200
    ds_read_b64_tr_b16 v[82:83], v69 offset:8192
    ds_read_b64_tr_b16 v[86:87], v69 offset:8200
Lntr0:
    s_lshl_b32 s38, s65, 5
    s_add_u32 m0, s78, 49152
    s_add_u32 s43, s38, 49152
    buffer_load_dwordx4 v188, s[92:95], s43 offen lds
    s_add_u32 m0, s78, 50176
    s_add_u32 s43, s38, 57344
    buffer_load_dwordx4 v188, s[92:95], s43 offen lds
    s_lshl_b32 s38, s64, 5
    s_add_u32 m0, s78, 16384
    s_add_u32 s43, s38, 163840
    buffer_load_dwordx4 v188, s[92:95], s43 offen lds
    s_add_u32 m0, s78, 17408
    s_add_u32 s43, s38, 172032
    buffer_load_dwordx4 v188, s[92:95], s43 offen lds
    s_cmp_eq_u32 s35, 0
    s_cbranch_scc1 Lntr1
    ds_write_b128 v70, v[88:91] offset:0
    ds_write_b128 v70, v[92:95] offset:1024
    ds_write_b128 v70, v[96:99] offset:8192
    ds_write_b128 v70, v[100:103] offset:9216
    ds_read_b64_tr_b16 v[88:89], v68 offset:0
    ds_read_b64_tr_b16 v[92:93], v68 offset:8
    ds_read_b64_tr_b16 v[96:97], v69 offset:0
    ds_read_b64_tr_b16 v[100:101], v69 offset:8
    ds_read_b64_tr_b16 v[90:91], v68 offset:8192
    ds_read_b64_tr_b16 v[94:95], v68 offset:8200
    ds_read_b64_tr_b16 v[98:99], v69 offset:8192
    ds_read_b64_tr_b16 v[102:103], v69 offset:8200
Lntr1:
    s_waitcnt lgkmcnt(0)
    s_lshl_b32 s38, s64, 5
    s_add_u32 m0, s78, 98304
    s_add_u32 s43, s38, 32768
    buffer_load_dwordx4 v188, s[92:95], s43 offen lds
    s_add_u32 m0, s78, 99328
    s_add_u32 s43, s38, 40960
    buffer_load_dwordx4 v188, s[92:95], s43 offen lds
    s_lshl_b32 s38, s64, 5
    s_add_u32 m0, s78, 106496
    s_add_u32 s43, s38, 49152
    buffer_load_dwordx4 v188, s[92:95], s43 offen lds
    s_add_u32 m0, s78, 107520
    s_add_u32 s43, s38, 57344
    buffer_load_dwordx4 v188, s[92:95], s43 offen lds
    s_lshl_b32 s38, s64, 5
    s_add_u32 m0, s78, 57344
    s_add_u32 s43, s38, 180224
    buffer_load_dwordx4 v188, s[92:95], s43 offen lds
    s_add_u32 m0, s78, 58368
    s_add_u32 s43, s38, 188416
    buffer_load_dwordx4 v188, s[92:95], s43 offen lds
    s_lshl_b32 s38, s76, 4
    s_lshl_b32 s39, s33, 6
    s_add_u32 s38, s38, s39
    v_and_b32 v14, 15, v1
    v_add_u32 v14, s38, v14
    v_lshlrev_b32 v12, 3, v14
    v_lshlrev_b32 v14, 10, v14
    v_and_b32 v11, 48, v1
    s_lshl_b32 s41, s34, 7
    v_add3_u32 v14, v14, v11, s41
    buffer_load_dwordx4 v[2:5], v14, s[48:51], 0 offen
    buffer_load_dwordx4 v[6:9], v14, s[48:51], 0 offen offset:64
    v_mov_b32 v17, 160896
    s_mov_b32 s42, 262144
Llw_19:
    s_sleep 1
    ds_read_b128 v[18:21], v17
    s_waitcnt lgkmcnt(0)
    v_min_u32 v18, v18, v19
    v_min3_u32 v18, v18, v20, v21
    s_nop 0
    v_readfirstlane_b32 s68, v18
    s_sub_u32 s42, s42, 1
    s_cmp_eq_u32 s42, 0
    s_cbranch_scc1 Llw_19d
    s_cmp_eq_u32 s68, 0
    s_cbranch_scc1 Llw_19
Llw_19d:
    s_lshl_b32 s38, s65, 5
    s_add_u32 m0, s78, 24576
    s_add_u32 s43, s38, 163840
    buffer_load_dwordx4 v188, s[92:95], s43 offen lds
    s_add_u32 m0, s78, 25600
    s_add_u32 s43, s38, 172032
    buffer_load_dwordx4 v188, s[92:95], s43 offen lds
    s_lshl_b32 s38, s65, 5
    s_add_u32 m0, s78, 65536
    s_add_u32 s43, s38, 180224
    buffer_load_dwordx4 v188, s[92:95], s43 offen lds
    s_add_u32 m0, s78, 66560
    s_add_u32 s43, s38, 188416
    buffer_load_dwordx4 v188, s[92:95], s43 offen lds
    s_lshl_b32 s38, s64, 5
    s_add_u32 m0, s78, 81920
    s_add_u32 s43, s38, 294912
    buffer_load_dwordx4 v188, s[92:95], s43 offen lds
    s_add_u32 m0, s78, 82944
    s_add_u32 s43, s38, 303104
    buffer_load_dwordx4 v188, s[92:95], s43 offen lds
    s_lshl_b32 s38, s64, 5
    s_add_u32 m0, s78, 90112
    s_add_u32 s43, s38, 311296
    buffer_load_dwordx4 v188, s[92:95], s43 offen lds
    s_add_u32 m0, s78, 91136
    s_add_u32 s43, s38, 319488
    buffer_load_dwordx4 v188, s[92:95], s43 offen lds
    s_lshl_b32 s38, s65, 5
    s_add_u32 m0, s78, 32768
    s_add_u32 s43, s38, 294912
    buffer_load_dwordx4 v188, s[92:95], s43 offen lds
    s_add_u32 m0, s78, 33792
    s_add_u32 s43, s38, 303104
    buffer_load_dwordx4 v188, s[92:95], s43 offen lds
    s_lshl_b32 s38, s65, 5
    s_add_u32 m0, s78, 73728
    s_add_u32 s43, s38, 311296
    buffer_load_dwordx4 v188, s[92:95], s43 offen lds
    s_add_u32 m0, s78, 74752
    s_add_u32 s43, s38, 319488
    buffer_load_dwordx4 v188, s[92:95], s43 offen lds
    s_waitcnt lgkmcnt(0)
    buffer_load_dwordx2 v[10:11], v189, s[44:47], 0 offen sc1
    s_mov_b32 s42, 65536
    s_waitcnt vmcnt(0)
    s_branch Lpollc_22
Lpoll_20:
    buffer_load_dwordx2 v[10:11], v189, s[44:47], 0 offen sc1
    s_waitcnt vmcnt(0)
Lpollc_22:
    v_cmp_ne_u64 s[68:69], s[36:37], v[10:11]
    s_cmp_eq_u64 s[68:69], 0
    s_cbranch_scc1 Lpolld_21
    s_sleep 0
    s_sub_u32 s42, s42, 1
    s_cmp_lg_u32 s42, 0
    s_cbranch_scc1 Lpoll_20
Lpolld_21:
    s_setprio 0
    s_add_u32 s43, s64, s96
    buffer_load_dwordx4 v[16:19], v190, s[44:47], s43 offen offset:0 sc1
    s_add_u32 s43, s64, s96
    s_add_u32 s43, s43, 4096
    buffer_load_dwordx4 v[20:23], v190, s[44:47], s43 offen offset:0 sc1
    s_add_u32 s43, s64, s97
    buffer_load_dwordx4 v[24:27], v190, s[44:47], s43 offen offset:0 sc1
    s_add_u32 s43, s64, s98
    buffer_load_dwordx4 v[28:31], v190, s[44:47], s43 offen offset:0 sc1
    s_add_u32 s43, s64, s100
    buffer_load_dwordx4 v[32:35], v190, s[44:47], s43 offen offset:0 sc1
    s_add_u32 s43, s65, s96
    buffer_load_dwordx4 v[36:39], v190, s[44:47], s43 offen offset:0 sc1
    s_add_u32 s43, s65, s97
    buffer_load_dwordx4 v[40:43], v190, s[44:47], s43 offen offset:0 sc1
    s_add_u32 s43, s65, s98
    buffer_load_dwordx4 v[44:47], v190, s[44:47], s43 offen offset:0 sc1
    s_add_u32 s43, s65, s100
    buffer_load_dwordx4 v[48:51], v190, s[44:47], s43 offen offset:0 sc1
    s_add_u32 s43, s64, s96
    s_add_u32 s43, s43, 8192
    buffer_load_dwordx4 v[52:55], v190, s[44:47], s43 offen offset:0 sc1
    s_add_u32 s43, s64, s97
    s_add_u32 s43, s43, 4096
    buffer_load_dwordx4 v[56:59], v190, s[44:47], s43 offen offset:0 sc1
    s_add_u32 s43, s64, s98
    s_add_u32 s43, s43, 4096
    buffer_load_dwordx4 v[60:63], v190, s[44:47], s43 offen offset:0 sc1
    s_add_u32 s43, s64, s100
    s_add_u32 s43, s43, 4096
    buffer_load_dwordx4 v[64:67], v190, s[44:47], s43 offen offset:0 sc1
    s_add_u32 s43, s65, s96
    s_add_u32 s43, s43, 4096
    buffer_load_dwordx4 v[68:71], v190, s[44:47], s43 offen offset:0 sc1
    s_mov_b32 s43, 7602176
    buffer_load_dwordx2 v[12:13], v12, s[44:47], s43 offen sc1
    v_readfirstlane_b32 s38, v189
    v_min_u32 v189, 6, v1
    s_add_u32 s38, s38, 131072
    v_lshl_add_u32 v189, v189, 7, s38
    s_lshl_b32 s39, s34, 2
    s_add_u32 s39, s39, s74
    s_lshl_b32 s39, s39, 17
    s_lshl_b32 s38, s33, 8
    s_add_u32 s80, s39, s38
    s_add_u32 s80, s80, 16777216
    v_lshlrev_b32 v240, 16, v2
    v_and_b32 v241, 0xffff0000, v2
    v_lshlrev_b32 v242, 16, v3
    v_and_b32 v243, 0xffff0000, v3
    v_lshlrev_b32 v244, 16, v4
    v_and_b32 v245, 0xffff0000, v4
    v_lshlrev_b32 v246, 16, v5
    v_and_b32 v247, 0xffff0000, v5
    v_lshlrev_b32 v248, 16, v6
    v_and_b32 v249, 0xffff0000, v6
    v_lshlrev_b32 v250, 16, v7
    v_and_b32 v251, 0xffff0000, v7
    v_lshlrev_b32 v252, 16, v8
    v_and_b32 v253, 0xffff0000, v8
    v_lshlrev_b32 v254, 16, v9
    v_and_b32 v255, 0xffff0000, v9
    s_waitcnt vmcnt(14)
    v_mfma_f32_16x16x32_bf16 v[192:195], v[72:75], v[16:19], 0
    v_mfma_f32_16x16x32_bf16 v[196:199], v[76:79], v[16:19], 0
    v_mfma_f32_16x16x32_bf16 v[200:203], v[80:83], v[16:19], 0
    v_mfma_f32_16x16x32_bf16 v[204:207], v[84:87], v[16:19], 0
    s_add_u32 s43, s65, s97
    s_add_u32 s43, s43, 4096
    buffer_load_dwordx4 v[16:19], v190, s[44:47], s43 offen offset:0 sc1
    s_waitcnt vmcnt(13)
    v_mfma_f32_16x16x32_bf16 v[220:223], v[84:87], v[24:27], 0
    v_mfma_f32_16x16x32_bf16 v[216:219], v[80:83], v[24:27], 0
    v_mfma_f32_16x16x32_bf16 v[212:215], v[76:79], v[24:27], 0
    v_mfma_f32_16x16x32_bf16 v[208:211], v[72:75], v[24:27], 0
    s_add_u32 s43, s65, s98
    s_add_u32 s43, s43, 4096
    buffer_load_dwordx4 v[24:27], v190, s[44:47], s43 offen offset:0 sc1
    s_waitcnt vmcnt(13)
    v_mfma_f32_16x16x32_bf16 v[224:227], v[72:75], v[28:31], 0
    v_mfma_f32_16x16x32_bf16 v[228:231], v[76:79], v[28:31], 0
    v_mfma_f32_16x16x32_bf16 v[232:235], v[80:83], v[28:31], 0
    v_mfma_f32_16x16x32_bf16 v[236:239], v[84:87], v[28:31], 0
    s_add_u32 s43, s65, s100
    s_add_u32 s43, s43, 4096
    buffer_load_dwordx4 v[28:31], v190, s[44:47], s43 offen offset:0 sc1
    s_waitcnt vmcnt(13)
    v_mfma_f32_16x16x32_bf16 v[252:255], v[84:87], v[32:35], v[252:255]
    v_mfma_f32_16x16x32_bf16 v[248:251], v[80:83], v[32:35], v[248:251]
    v_mfma_f32_16x16x32_bf16 v[244:247], v[76:79], v[32:35], v[244:247]
    v_mfma_f32_16x16x32_bf16 v[240:243], v[72:75], v[32:35], v[240:243]
    s_add_u32 s43, s64, s97
    s_add_u32 s43, s43, 8192
    buffer_load_dwordx4 v[32:35], v190, s[44:47], s43 offen offset:0 sc1
    buffer_load_dwordx2 v[10:11], v189, s[44:47], 0 offen sc1
    s_waitcnt vmcnt(14)
    v_mfma_f32_16x16x32_bf16 v[192:195], v[88:91], v[36:39], v[192:195]
    v_mfma_f32_16x16x32_bf16 v[196:199], v[92:95], v[36:39], v[196:199]
    v_mfma_f32_16x16x32_bf16 v[200:203], v[96:99], v[36:39], v[200:203]
    v_mfma_f32_16x16x32_bf16 v[204:207], v[100:103], v[36:39], v[204:207]
    s_add_u32 s43, s64, s98
    s_add_u32 s43, s43, 8192
    buffer_load_dwordx4 v[36:39], v190, s[44:47], s43 offen offset:0 sc1
    s_waitcnt vmcnt(14)
    v_mfma_f32_16x16x32_bf16 v[220:223], v[100:103], v[40:43], v[220:223]
    v_mfma_f32_16x16x32_bf16 v[216:219], v[96:99], v[40:43], v[216:219]
    v_mfma_f32_16x16x32_bf16 v[212:215], v[92:95], v[40:43], v[212:215]
    v_mfma_f32_16x16x32_bf16 v[208:211], v[88:91], v[40:43], v[208:211]
    s_add_u32 s43, s64, s100
    s_add_u32 s43, s43, 8192
    buffer_load_dwordx4 v[40:43], v190, s[44:47], s43 offen offset:0 sc1
    s_waitcnt vmcnt(14)
    v_mfma_f32_16x16x32_bf16 v[224:227], v[88:91], v[44:47], v[224:227]
    v_mfma_f32_16x16x32_bf16 v[228:231], v[92:95], v[44:47], v[228:231]
    v_mfma_f32_16x16x32_bf16 v[232:235], v[96:99], v[44:47], v[232:235]
    v_mfma_f32_16x16x32_bf16 v[236:239], v[100:103], v[44:47], v[236:239]
    s_add_u32 s43, s65, s96
    s_add_u32 s43, s43, 8192
    buffer_load_dwordx4 v[44:47], v190, s[44:47], s43 offen offset:0 sc1
    s_waitcnt vmcnt(14)
    v_mfma_f32_16x16x32_bf16 v[252:255], v[100:103], v[48:51], v[252:255]
    v_mfma_f32_16x16x32_bf16 v[248:251], v[96:99], v[48:51], v[248:251]
    v_mfma_f32_16x16x32_bf16 v[244:247], v[92:95], v[48:51], v[244:247]
    v_mfma_f32_16x16x32_bf16 v[240:243], v[88:91], v[48:51], v[240:243]
    s_add_u32 s43, s65, s97
    s_add_u32 s43, s43, 8192
    buffer_load_dwordx4 v[48:51], v190, s[44:47], s43 offen offset:0 sc1
    v_mfma_f32_16x16x32_bf16 v[192:195], v[104:107], v[20:23], v[192:195]
    v_mfma_f32_16x16x32_bf16 v[196:199], v[108:111], v[20:23], v[196:199]
    v_mfma_f32_16x16x32_bf16 v[200:203], v[112:115], v[20:23], v[200:203]
    v_mfma_f32_16x16x32_bf16 v[204:207], v[116:119], v[20:23], v[204:207]
    s_add_u32 s43, s65, s98
    s_add_u32 s43, s43, 8192
    buffer_load_dwordx4 v[20:23], v190, s[44:47], s43 offen offset:0 sc1
    s_waitcnt vmcnt(14)
    v_mfma_f32_16x16x32_bf16 v[220:223], v[116:119], v[56:59], v[220:223]
    v_mfma_f32_16x16x32_bf16 v[216:219], v[112:115], v[56:59], v[216:219]
    v_mfma_f32_16x16x32_bf16 v[212:215], v[108:111], v[56:59], v[212:215]
    v_mfma_f32_16x16x32_bf16 v[208:211], v[104:107], v[56:59], v[208:211]
    s_add_u32 s43, s65, s100
    s_add_u32 s43, s43, 8192
    buffer_load_dwordx4 v[56:59], v190, s[44:47], s43 offen offset:0 sc1
    s_waitcnt vmcnt(14)
    v_mfma_f32_16x16x32_bf16 v[224:227], v[104:107], v[60:63], v[224:227]
    v_mfma_f32_16x16x32_bf16 v[228:231], v[108:111], v[60:63], v[228:231]
    v_mfma_f32_16x16x32_bf16 v[232:235], v[112:115], v[60:63], v[232:235]
    v_mfma_f32_16x16x32_bf16 v[236:239], v[116:119], v[60:63], v[236:239]
    s_waitcnt vmcnt(13)
    v_mfma_f32_16x16x32_bf16 v[252:255], v[116:119], v[64:67], v[252:255]
    v_mfma_f32_16x16x32_bf16 v[248:251], v[112:115], v[64:67], v[248:251]
    v_mfma_f32_16x16x32_bf16 v[244:247], v[108:111], v[64:67], v[244:247]
    v_mfma_f32_16x16x32_bf16 v[240:243], v[104:107], v[64:67], v[240:243]
    s_mov_b32 s42, 65536
    s_waitcnt vmcnt(6)
    s_branch Lpollc_25
Lpoll_23:
    buffer_load_dwordx2 v[10:11], v189, s[44:47], 0 offen sc1
    s_waitcnt vmcnt(0)
Lpollc_25:
    v_cmp_ne_u64 s[68:69], s[36:37], v[10:11]
    s_cmp_eq_u64 s[68:69], 0
    s_cbranch_scc1 Lpolld_24
    s_sleep 0
    s_sub_u32 s42, s42, 1
    s_cmp_lg_u32 s42, 0
    s_cbranch_scc1 Lpoll_23
Lpolld_24:
    s_add_u32 s43, s66, s96
    s_add_u32 s43, s43, 12288
    buffer_load_dwordx4 v[60:63], v190, s[44:47], s43 offen offset:0 sc1
    s_add_u32 s43, s64, s96
    buffer_load_dwordx4 v[64:67], v190, s[44:47], s43 offen offset:1024 sc1
    v_mfma_f32_16x16x32_bf16 v[192:195], v[120:123], v[68:71], v[192:195]
    v_mfma_f32_16x16x32_bf16 v[196:199], v[124:127], v[68:71], v[196:199]
    v_mfma_f32_16x16x32_bf16 v[200:203], v[128:131], v[68:71], v[200:203]
    v_mfma_f32_16x16x32_bf16 v[204:207], v[132:135], v[68:71], v[204:207]
    s_add_u32 s43, s66, s97
    s_add_u32 s43, s43, 12288
    buffer_load_dwordx4 v[68:71], v190, s[44:47], s43 offen offset:0 sc1
    v_mfma_f32_16x16x32_bf16 v[220:223], v[132:135], v[16:19], v[220:223]
    v_mfma_f32_16x16x32_bf16 v[216:219], v[128:131], v[16:19], v[216:219]
    v_mfma_f32_16x16x32_bf16 v[212:215], v[124:127], v[16:19], v[212:215]
    v_mfma_f32_16x16x32_bf16 v[208:211], v[120:123], v[16:19], v[208:211]
    s_add_u32 s43, s66, s98
    s_add_u32 s43, s43, 12288
    buffer_load_dwordx4 v[16:19], v190, s[44:47], s43 offen offset:0 sc1
    v_mfma_f32_16x16x32_bf16 v[224:227], v[120:123], v[24:27], v[224:227]
    v_mfma_f32_16x16x32_bf16 v[228:231], v[124:127], v[24:27], v[228:231]
    v_mfma_f32_16x16x32_bf16 v[232:235], v[128:131], v[24:27], v[232:235]
    v_mfma_f32_16x16x32_bf16 v[236:239], v[132:135], v[24:27], v[236:239]
    s_add_u32 s43, s66, s100
    s_add_u32 s43, s43, 12288
    buffer_load_dwordx4 v[24:27], v190, s[44:47], s43 offen offset:0 sc1
    v_mfma_f32_16x16x32_bf16 v[252:255], v[132:135], v[28:31], v[252:255]
    v_mfma_f32_16x16x32_bf16 v[248:251], v[128:131], v[28:31], v[248:251]
    v_mfma_f32_16x16x32_bf16 v[244:247], v[124:127], v[28:31], v[244:247]
    v_mfma_f32_16x16x32_bf16 v[240:243], v[120:123], v[28:31], v[240:243]
    s_add_u32 s43, s67, s96
    s_add_u32 s43, s43, 12288
    buffer_load_dwordx4 v[28:31], v190, s[44:47], s43 offen offset:0 sc1
    v_mfma_f32_16x16x32_bf16 v[192:195], v[136:139], v[52:55], v[192:195]
    v_mfma_f32_16x16x32_bf16 v[196:199], v[140:143], v[52:55], v[196:199]
    v_mfma_f32_16x16x32_bf16 v[200:203], v[144:147], v[52:55], v[200:203]
    v_mfma_f32_16x16x32_bf16 v[204:207], v[148:151], v[52:55], v[204:207]
    s_add_u32 s43, s67, s97
    s_add_u32 s43, s43, 12288
    buffer_load_dwordx4 v[52:55], v190, s[44:47], s43 offen offset:0 sc1
    v_mfma_f32_16x16x32_bf16 v[220:223], v[148:151], v[32:35], v[220:223]
    v_mfma_f32_16x16x32_bf16 v[216:219], v[144:147], v[32:35], v[216:219]
    v_mfma_f32_16x16x32_bf16 v[212:215], v[140:143], v[32:35], v[212:215]
    v_mfma_f32_16x16x32_bf16 v[208:211], v[136:139], v[32:35], v[208:211]
    s_add_u32 s43, s67, s98
    s_add_u32 s43, s43, 12288
    buffer_load_dwordx4 v[32:35], v190, s[44:47], s43 offen offset:0 sc1
    s_waitcnt vmcnt(13)
    v_mfma_f32_16x16x32_bf16 v[224:227], v[136:139], v[36:39], v[224:227]
    v_mfma_f32_16x16x32_bf16 v[228:231], v[140:143], v[36:39], v[228:231]
    v_mfma_f32_16x16x32_bf16 v[232:235], v[144:147], v[36:39], v[232:235]
    v_mfma_f32_16x16x32_bf16 v[236:239], v[148:151], v[36:39], v[236:239]
    s_add_u32 s43, s67, s100
    s_add_u32 s43, s43, 12288
    buffer_load_dwordx4 v[36:39], v190, s[44:47], s43 offen offset:0 sc1
    s_waitcnt vmcnt(13)
    v_mfma_f32_16x16x32_bf16 v[252:255], v[148:151], v[40:43], v[252:255]
    v_mfma_f32_16x16x32_bf16 v[248:251], v[144:147], v[40:43], v[248:251]
    v_mfma_f32_16x16x32_bf16 v[244:247], v[140:143], v[40:43], v[244:247]
    v_mfma_f32_16x16x32_bf16 v[240:243], v[136:139], v[40:43], v[240:243]
    s_add_u32 s43, s64, s96
    s_add_u32 s43, s43, 4096
    buffer_load_dwordx4 v[40:43], v190, s[44:47], s43 offen offset:1024 sc1
    s_waitcnt vmcnt(13)
    v_mfma_f32_16x16x32_bf16 v[192:195], v[152:155], v[44:47], v[192:195]
    ds_read_b64_tr_b16 v[72:73], v184 offset:0
    v_mfma_f32_16x16x32_bf16 v[196:199], v[156:159], v[44:47], v[196:199]
    ds_read_b64_tr_b16 v[76:77], v184 offset:8
    v_mfma_f32_16x16x32_bf16 v[200:203], v[160:163], v[44:47], v[200:203]
    ds_read_b64_tr_b16 v[80:81], v185 offset:0
    v_mfma_f32_16x16x32_bf16 v[204:207], v[164:167], v[44:47], v[204:207]
    ds_read_b64_tr_b16 v[84:85], v185 offset:8
    s_add_u32 s43, s64, s97
    buffer_load_dwordx4 v[44:47], v190, s[44:47], s43 offen offset:1024 sc1
    s_waitcnt vmcnt(13)
    v_mfma_f32_16x16x32_bf16 v[220:223], v[164:167], v[48:51], v[220:223]
    ds_read_b64_tr_b16 v[74:75], v184 offset:40960
    v_mfma_f32_16x16x32_bf16 v[216:219], v[160:163], v[48:51], v[216:219]
    ds_read_b64_tr_b16 v[78:79], v184 offset:40968
    v_mfma_f32_16x16x32_bf16 v[212:215], v[156:159], v[48:51], v[212:215]
    ds_read_b64_tr_b16 v[82:83], v185 offset:40960
    v_mfma_f32_16x16x32_bf16 v[208:211], v[152:155], v[48:51], v[208:211]
    ds_read_b64_tr_b16 v[86:87], v185 offset:40968
    s_add_u32 s43, s64, s98
    buffer_load_dwordx4 v[48:51], v190, s[44:47], s43 offen offset:1024 sc1
    s_waitcnt vmcnt(13)
    v_mfma_f32_16x16x32_bf16 v[224:227], v[152:155], v[20:23], v[224:227]
    ds_read_b64_tr_b16 v[88:89], v186 offset:32768
    v_mfma_f32_16x16x32_bf16 v[228:231], v[156:159], v[20:23], v[228:231]
    ds_read_b64_tr_b16 v[92:93], v186 offset:32776
    v_mfma_f32_16x16x32_bf16 v[232:235], v[160:163], v[20:23], v[232:235]
    ds_read_b64_tr_b16 v[96:97], v187 offset:32768
    v_mfma_f32_16x16x32_bf16 v[236:239], v[164:167], v[20:23], v[236:239]
    ds_read_b64_tr_b16 v[100:101], v187 offset:32776
    s_add_u32 s43, s64, s100
    buffer_load_dwordx4 v[20:23], v190, s[44:47], s43 offen offset:1024 sc1
    s_waitcnt vmcnt(13)
    v_mfma_f32_16x16x32_bf16 v[252:255], v[164:167], v[56:59], v[252:255]
    ds_read_b64_tr_b16 v[90:91], v186 offset:40960
    v_mfma_f32_16x16x32_bf16 v[248:251], v[160:163], v[56:59], v[248:251]
    ds_read_b64_tr_b16 v[94:95], v186 offset:40968
    v_mfma_f32_16x16x32_bf16 v[244:247], v[156:159], v[56:59], v[244:247]
    ds_read_b64_tr_b16 v[98:99], v187 offset:40960
    v_mfma_f32_16x16x32_bf16 v[240:243], v[152:155], v[56:59], v[240:243]
    ds_read_b64_tr_b16 v[102:103], v187 offset:40968
    s_add_u32 s43, s65, s96
    buffer_load_dwordx4 v[56:59], v190, s[44:47], s43 offen offset:1024 sc1
    s_waitcnt vmcnt(13)
    v_mfma_f32_16x16x32_bf16 v[192:195], v[168:171], v[60:63], v[192:195]
    ds_read_b64_tr_b16 v[104:105], v184 offset:8192
    v_mfma_f32_16x16x32_bf16 v[196:199], v[172:175], v[60:63], v[196:199]
    ds_read_b64_tr_b16 v[108:109], v184 offset:8200
    v_mfma_f32_16x16x32_bf16 v[200:203], v[176:179], v[60:63], v[200:203]
    ds_read_b64_tr_b16 v[112:113], v185 offset:8192
    v_mfma_f32_16x16x32_bf16 v[204:207], v[180:183], v[60:63], v[204:207]
    ds_read_b64_tr_b16 v[116:117], v185 offset:8200
    s_add_u32 s43, s65, s97
    buffer_load_dwordx4 v[60:63], v190, s[44:47], s43 offen offset:1024 sc1
    s_waitcnt vmcnt(12)
    v_mfma_f32_16x16x32_bf16 v[220:223], v[180:183], v[68:71], v[220:223]
    ds_read_b64_tr_b16 v[106:107], v184 offset:49152
    v_mfma_f32_16x16x32_bf16 v[216:219], v[176:179], v[68:71], v[216:219]
    ds_read_b64_tr_b16 v[110:111], v184 offset:49160
    v_mfma_f32_16x16x32_bf16 v[212:215], v[172:175], v[68:71], v[212:215]
    ds_read_b64_tr_b16 v[114:115], v185 offset:49152
    v_mfma_f32_16x16x32_bf16 v[208:211], v[168:171], v[68:71], v[208:211]
    ds_read_b64_tr_b16 v[118:119], v185 offset:49160
    s_add_u32 s43, s65, s98
    buffer_load_dwordx4 v[68:71], v190, s[44:47], s43 offen offset:1024 sc1
    s_waitcnt vmcnt(12)
    v_mfma_f32_16x16x32_bf16 v[224:227], v[168:171], v[16:19], v[224:227]
    ds_read_b64_tr_b16 v[120:121], v184 offset:16384
    v_mfma_f32_16x16x32_bf16 v[228:231], v[172:175], v[16:19], v[228:231]
    ds_read_b64_tr_b16 v[124:125], v184 offset:16392
    v_mfma_f32_16x16x32_bf16 v[232:235], v[176:179], v[16:19], v[232:235]
    ds_read_b64_tr_b16 v[128:129], v185 offset:16384
    v_mfma_f32_16x16x32_bf16 v[236:239], v[180:183], v[16:19], v[236:239]
    ds_read_b64_tr_b16 v[132:133], v185 offset:16392
    s_add_u32 s43, s65, s100
    buffer_load_dwordx4 v[16:19], v190, s[44:47], s43 offen offset:1024 sc1
    s_waitcnt vmcnt(12)
    v_mfma_f32_16x16x32_bf16 v[252:255], v[180:183], v[24:27], v[252:255]
    ds_read_b64_tr_b16 v[122:123], v184 offset:57344
    v_mfma_f32_16x16x32_bf16 v[248:251], v[176:179], v[24:27], v[248:251]
    ds_read_b64_tr_b16 v[126:127], v184 offset:57352
    v_mfma_f32_16x16x32_bf16 v[244:247], v[172:175], v[24:27], v[244:247]
    ds_read_b64_tr_b16 v[130:131], v185 offset:57344
    v_mfma_f32_16x16x32_bf16 v[240:243], v[168:171], v[24:27], v[240:243]
    ds_read_b64_tr_b16 v[134:135], v185 offset:57352
    s_add_u32 s43, s64, s96
    s_add_u32 s43, s43, 8192
    buffer_load_dwordx4 v[24:27], v190, s[44:47], s43 offen offset:1024 sc1
    s_waitcnt lgkmcnt(15)
    s_waitcnt vmcnt(12)
    v_mfma_f32_16x16x32_bf16 v[192:195], v[72:75], v[28:31], v[192:195]
    ds_read_b64_tr_b16 v[136:137], v184 offset:24576
    v_mfma_f32_16x16x32_bf16 v[196:199], v[76:79], v[28:31], v[196:199]
    ds_read_b64_tr_b16 v[140:141], v184 offset:24584
    v_mfma_f32_16x16x32_bf16 v[200:203], v[80:83], v[28:31], v[200:203]
    ds_read_b64_tr_b16 v[144:145], v185 offset:24576
    v_mfma_f32_16x16x32_bf16 v[204:207], v[84:87], v[28:31], v[204:207]
    ds_read_b64_tr_b16 v[148:149], v185 offset:24584
    s_add_u32 s43, s64, s97
    s_add_u32 s43, s43, 4096
    buffer_load_dwordx4 v[28:31], v190, s[44:47], s43 offen offset:1024 sc1
    s_waitcnt vmcnt(12)
    v_mfma_f32_16x16x32_bf16 v[220:223], v[84:87], v[52:55], v[220:223]
    ds_read_b64_tr_b16 v[138:139], v186 offset:0
    v_mfma_f32_16x16x32_bf16 v[216:219], v[80:83], v[52:55], v[216:219]
    ds_read_b64_tr_b16 v[142:143], v186 offset:8
    v_mfma_f32_16x16x32_bf16 v[212:215], v[76:79], v[52:55], v[212:215]
    ds_read_b64_tr_b16 v[146:147], v187 offset:0
    v_mfma_f32_16x16x32_bf16 v[208:211], v[72:75], v[52:55], v[208:211]
    ds_read_b64_tr_b16 v[150:151], v187 offset:8
    s_add_u32 s43, s64, s98
    s_add_u32 s43, s43, 4096
    buffer_load_dwordx4 v[52:55], v190, s[44:47], s43 offen offset:1024 sc1
    s_waitcnt vmcnt(12)
    v_mfma_f32_16x16x32_bf16 v[224:227], v[72:75], v[32:35], v[224:227]
    ds_read_b64_tr_b16 v[152:153], v186 offset:16384
    v_mfma_f32_16x16x32_bf16 v[228:231], v[76:79], v[32:35], v[228:231]
    ds_read_b64_tr_b16 v[156:157], v186 offset:16392
    v_mfma_f32_16x16x32_bf16 v[232:235], v[80:83], v[32:35], v[232:235]
    ds_read_b64_tr_b16 v[160:161], v187 offset:16384
    v_mfma_f32_16x16x32_bf16 v[236:239], v[84:87], v[32:35], v[236:239]
    ds_read_b64_tr_b16 v[164:165], v187 offset:16392
    s_add_u32 s43, s64, s100
    s_add_u32 s43, s43, 4096
    buffer_load_dwordx4 v[32:35], v190, s[44:47], s43 offen offset:1024 sc1
    s_waitcnt vmcnt(12)
    v_mfma_f32_16x16x32_bf16 v[252:255], v[84:87], v[36:39], v[252:255]
    ds_read_b64_tr_b16 v[154:155], v186 offset:24576
    v_mfma_f32_16x16x32_bf16 v[248:251], v[80:83], v[36:39], v[248:251]
    ds_read_b64_tr_b16 v[158:159], v186 offset:24584
    v_mfma_f32_16x16x32_bf16 v[244:247], v[76:79], v[36:39], v[244:247]
    ds_read_b64_tr_b16 v[162:163], v187 offset:24576
    v_mfma_f32_16x16x32_bf16 v[240:243], v[72:75], v[36:39], v[240:243]
    ds_read_b64_tr_b16 v[166:167], v187 offset:24584
    s_add_u32 s43, s65, s96
    s_add_u32 s43, s43, 4096
    buffer_load_dwordx4 v[36:39], v190, s[44:47], s43 offen offset:1024 sc1
    s_waitcnt lgkmcnt(15)
    v_mfma_f32_16x16x32_bf16 v[192:195], v[88:91], v[64:67], v[192:195]
    ds_read_b64_tr_b16 v[168:169], v184 offset:32768
    v_mfma_f32_16x16x32_bf16 v[196:199], v[92:95], v[64:67], v[196:199]
    ds_read_b64_tr_b16 v[172:173], v184 offset:32776
    v_mfma_f32_16x16x32_bf16 v[200:203], v[96:99], v[64:67], v[200:203]
    ds_read_b64_tr_b16 v[176:177], v185 offset:32768
    v_mfma_f32_16x16x32_bf16 v[204:207], v[100:103], v[64:67], v[204:207]
    ds_read_b64_tr_b16 v[180:181], v185 offset:32776
    s_add_u32 s43, s65, s97
    s_add_u32 s43, s43, 4096
    buffer_load_dwordx4 v[64:67], v190, s[44:47], s43 offen offset:1024 sc1
    s_waitcnt vmcnt(12)
    v_mfma_f32_16x16x32_bf16 v[220:223], v[100:103], v[44:47], v[220:223]
    ds_read_b64_tr_b16 v[170:171], v186 offset:8192
    v_mfma_f32_16x16x32_bf16 v[216:219], v[96:99], v[44:47], v[216:219]
    ds_read_b64_tr_b16 v[174:175], v186 offset:8200
    v_mfma_f32_16x16x32_bf16 v[212:215], v[92:95], v[44:47], v[212:215]
    ds_read_b64_tr_b16 v[178:179], v187 offset:8192
    v_mfma_f32_16x16x32_bf16 v[208:211], v[88:91], v[44:47], v[208:211]
    ds_read_b64_tr_b16 v[182:183], v187 offset:8200
    s_add_u32 s43, s65, s98
    s_add_u32 s43, s43, 4096
    buffer_load_dwordx4 v[44:47], v190, s[44:47], s43 offen offset:1024 sc1
    s_waitcnt vmcnt(12)
    v_mfma_f32_16x16x32_bf16 v[224:227], v[88:91], v[48:51], v[224:227]
    v_mfma_f32_16x16x32_bf16 v[228:231], v[92:95], v[48:51], v[228:231]
    v_mfma_f32_16x16x32_bf16 v[232:235], v[96:99], v[48:51], v[232:235]
    v_mfma_f32_16x16x32_bf16 v[236:239], v[100:103], v[48:51], v[236:239]
    s_add_u32 s43, s64, s97
    s_add_u32 s43, s43, 8192
    buffer_load_dwordx4 v[48:51], v190, s[44:47], s43 offen offset:1024 sc1
    s_waitcnt vmcnt(12)
    v_mfma_f32_16x16x32_bf16 v[252:255], v[100:103], v[20:23], v[252:255]
    v_mfma_f32_16x16x32_bf16 v[248:251], v[96:99], v[20:23], v[248:251]
    v_mfma_f32_16x16x32_bf16 v[244:247], v[92:95], v[20:23], v[244:247]
    v_mfma_f32_16x16x32_bf16 v[240:243], v[88:91], v[20:23], v[240:243]
    s_add_u32 s43, s64, s98
    s_add_u32 s43, s43, 8192
    buffer_load_dwordx4 v[20:23], v190, s[44:47], s43 offen offset:1024 sc1
    s_waitcnt lgkmcnt(15)
    s_waitcnt vmcnt(12)
    v_mfma_f32_16x16x32_bf16 v[192:195], v[104:107], v[56:59], v[192:195]
    v_rcp_f32 v13, v13
    v_lshlrev_b32 v12, 16, v12
    v_mfma_f32_16x16x32_bf16 v[196:199], v[108:111], v[56:59], v[196:199]
    v_lshlrev_b32 v72, 16, v2
    v_and_b32 v73, 0xffff0000, v2
    v_mfma_f32_16x16x32_bf16 v[200:203], v[112:115], v[56:59], v[200:203]
    v_lshlrev_b32 v74, 16, v3
    v_and_b32 v75, 0xffff0000, v3
    v_mfma_f32_16x16x32_bf16 v[204:207], v[116:119], v[56:59], v[204:207]
    v_lshlrev_b32 v76, 16, v4
    v_and_b32 v77, 0xffff0000, v4
    s_add_u32 s43, s65, s96
    s_add_u32 s43, s43, 8192
    buffer_load_dwordx4 v[56:59], v190, s[44:47], s43 offen offset:1024 sc1
    s_waitcnt vmcnt(12)
    v_mfma_f32_16x16x32_bf16 v[220:223], v[116:119], v[60:63], v[220:223]
    v_lshlrev_b32 v78, 16, v5
    v_and_b32 v79, 0xffff0000, v5
    v_mfma_f32_16x16x32_bf16 v[216:219], v[112:115], v[60:63], v[216:219]
    v_lshlrev_b32 v80, 16, v6
    v_and_b32 v81, 0xffff0000, v6
    v_mfma_f32_16x16x32_bf16 v[212:215], v[108:111], v[60:63], v[212:215]
    v_lshlrev_b32 v82, 16, v7
    v_and_b32 v83, 0xffff0000, v7
    v_mfma_f32_16x16x32_bf16 v[208:211], v[104:107], v[60:63], v[208:211]
    v_lshlrev_b32 v84, 16, v8
    v_and_b32 v85, 0xffff0000, v8
    s_add_u32 s43, s65, s97
    s_add_u32 s43, s43, 8192
    buffer_load_dwordx4 v[60:63], v190, s[44:47], s43 offen offset:1024 sc1
    s_waitcnt vmcnt(12)
    v_mfma_f32_16x16x32_bf16 v[224:227], v[104:107], v[68:71], v[224:227]
    v_lshlrev_b32 v86, 16, v9
    v_and_b32 v87, 0xffff0000, v9
    v_mfma_f32_16x16x32_bf16 v[228:231], v[108:111], v[68:71], v[228:231]
    v_add_f32 v72, v72, v12
    v_add_f32 v73, v73, v12
    v_mfma_f32_16x16x32_bf16 v[232:235], v[112:115], v[68:71], v[232:235]
    v_add_f32 v74, v74, v12
    v_add_f32 v75, v75, v12
    v_mfma_f32_16x16x32_bf16 v[236:239], v[116:119], v[68:71], v[236:239]
    v_add_f32 v76, v76, v12
    v_add_f32 v77, v77, v12
    s_add_u32 s43, s65, s98
    s_add_u32 s43, s43, 8192
    buffer_load_dwordx4 v[68:71], v190, s[44:47], s43 offen offset:1024 sc1
    s_waitcnt vmcnt(12)
    v_mfma_f32_16x16x32_bf16 v[252:255], v[116:119], v[16:19], v[252:255]
    v_add_f32 v78, v78, v12
    v_add_f32 v79, v79, v12
    v_mfma_f32_16x16x32_bf16 v[248:251], v[112:115], v[16:19], v[248:251]
    v_add_f32 v80, v80, v12
    v_add_f32 v81, v81, v12
    v_mfma_f32_16x16x32_bf16 v[244:247], v[108:111], v[16:19], v[244:247]
    v_add_f32 v82, v82, v12
    v_add_f32 v83, v83, v12
    v_mfma_f32_16x16x32_bf16 v[240:243], v[104:107], v[16:19], v[240:243]
    v_add_f32 v84, v84, v12
    v_add_f32 v85, v85, v12
    s_add_u32 s43, s65, s100
    s_add_u32 s43, s43, 4096
    buffer_load_dwordx4 v[16:19], v190, s[44:47], s43 offen offset:1024 sc1
    s_waitcnt lgkmcnt(15)
    v_mfma_f32_16x16x32_bf16 v[192:195], v[120:123], v[40:43], v[192:195]
    v_add_f32 v86, v86, v12
    v_add_f32 v87, v87, v12
    v_mfma_f32_16x16x32_bf16 v[196:199], v[124:127], v[40:43], v[196:199]
    v_mul_f32 v72, v72, v13
    v_mul_f32 v73, v73, v13
    v_mfma_f32_16x16x32_bf16 v[200:203], v[128:131], v[40:43], v[200:203]
    v_mul_f32 v74, v74, v13
    v_mul_f32 v75, v75, v13
    v_mfma_f32_16x16x32_bf16 v[204:207], v[132:135], v[40:43], v[204:207]
    v_mul_f32 v76, v76, v13
    v_mul_f32 v77, v77, v13
    s_add_u32 s43, s64, s100
    s_add_u32 s43, s43, 8192
    buffer_load_dwordx4 v[40:43], v190, s[44:47], s43 offen offset:1024 sc1
    s_waitcnt vmcnt(12)
    v_mfma_f32_16x16x32_bf16 v[220:223], v[132:135], v[28:31], v[220:223]
    v_mul_f32 v78, v78, v13
    v_mul_f32 v79, v79, v13
    v_mfma_f32_16x16x32_bf16 v[216:219], v[128:131], v[28:31], v[216:219]
    v_mul_f32 v80, v80, v13
    v_mul_f32 v81, v81, v13
    v_mfma_f32_16x16x32_bf16 v[212:215], v[124:127], v[28:31], v[212:215]
    v_mul_f32 v82, v82, v13
    v_mul_f32 v83, v83, v13
    v_mfma_f32_16x16x32_bf16 v[208:211], v[120:123], v[28:31], v[208:211]
    v_mul_f32 v84, v84, v13
    v_mul_f32 v85, v85, v13
    s_add_u32 s43, s65, s100
    s_add_u32 s43, s43, 8192
    buffer_load_dwordx4 v[28:31], v190, s[44:47], s43 offen offset:1024 sc1
    s_waitcnt vmcnt(12)
    v_mfma_f32_16x16x32_bf16 v[224:227], v[120:123], v[52:55], v[224:227]
    v_mul_f32 v86, v86, v13
    v_mul_f32 v87, v87, v13
    v_mfma_f32_16x16x32_bf16 v[228:231], v[124:127], v[52:55], v[228:231]
    v_lshl_add_u32 v88, v1, 4, s78
    v_xor_b32 v89, 6144, v88
    v_mfma_f32_16x16x32_bf16 v[232:235], v[128:131], v[52:55], v[232:235]
    v_xor_b32 v90, 4096, v88
    v_xor_b32 v91, 2048, v88
    v_mfma_f32_16x16x32_bf16 v[236:239], v[132:135], v[52:55], v[236:239]
    v_lshrrev_b32 v92, 4, v1
    v_lshlrev_b32 v92, 10, v92
    v_lshrrev_b32 v188, 4, v1
    v_and_b32 v10, 15, v1
    v_lshlrev_b32 v188, 13, v188
    v_lshl_add_u32 v188, v10, 4, v188
    s_add_u32 s38, s78, 0
    v_lshl_add_u32 v189, v1, 3, s38
    s_add_u32 s43, s80, 0
    buffer_load_dwordx4 v[96:99], v188, s[44:47], s43 offen sc1
    s_add_u32 s43, s80, 32768
    buffer_load_dwordx4 v[100:103], v188, s[44:47], s43 offen sc1
    s_add_u32 s43, s80, 65536
    buffer_load_dwordx4 v[184:187], v188, s[44:47], s43 offen sc1
    s_add_u32 s43, s80, 98304
    buffer_load_dwordx4 v[52:55], v188, s[44:47], s43 offen sc1
    s_waitcnt vmcnt(15)
    v_mfma_f32_16x16x32_bf16 v[252:255], v[132:135], v[32:35], v[252:255]
    v_bfe_u32 v93, v1, 2, 2
    v_lshl_add_u32 v92, v93, 7, v92
    v_mfma_f32_16x16x32_bf16 v[248:251], v[128:131], v[32:35], v[248:251]
    v_and_b32 v93, 3, v1
    v_lshl_add_u32 v92, v93, 3, v92
    v_mfma_f32_16x16x32_bf16 v[244:247], v[124:127], v[32:35], v[244:247]
    s_lshl_b32 s39, s76, 5
    v_add_u32 v92, s39, v92
    v_mfma_f32_16x16x32_bf16 v[240:243], v[120:123], v[32:35], v[240:243]
    s_waitcnt lgkmcnt(15)
    s_waitcnt vmcnt(14)
    v_mfma_f32_16x16x32_bf16 v[192:195], v[136:139], v[36:39], v[192:195]
    v_mfma_f32_16x16x32_bf16 v[196:199], v[140:143], v[36:39], v[196:199]
    v_mfma_f32_16x16x32_bf16 v[200:203], v[144:147], v[36:39], v[200:203]
    v_mfma_f32_16x16x32_bf16 v[204:207], v[148:151], v[36:39], v[204:207]
    s_waitcnt vmcnt(13)
    v_mfma_f32_16x16x32_bf16 v[220:223], v[148:151], v[64:67], v[220:223]
    v_mfma_f32_16x16x32_bf16 v[216:219], v[144:147], v[64:67], v[216:219]
    v_mfma_f32_16x16x32_bf16 v[212:215], v[140:143], v[64:67], v[212:215]
    v_mfma_f32_16x16x32_bf16 v[208:211], v[136:139], v[64:67], v[208:211]
    s_waitcnt vmcnt(12)
    v_mfma_f32_16x16x32_bf16 v[224:227], v[136:139], v[44:47], v[224:227]
    v_mfma_f32_16x16x32_bf16 v[228:231], v[140:143], v[44:47], v[228:231]
    v_mfma_f32_16x16x32_bf16 v[232:235], v[144:147], v[44:47], v[232:235]
    v_mfma_f32_16x16x32_bf16 v[236:239], v[148:151], v[44:47], v[236:239]
    s_waitcnt lgkmcnt(8)
    v_mfma_f32_16x16x32_bf16 v[204:207], v[164:167], v[24:27], v[204:207]
    v_mfma_f32_16x16x32_bf16 v[200:203], v[160:163], v[24:27], v[200:203]
    v_mfma_f32_16x16x32_bf16 v[196:199], v[156:159], v[24:27], v[196:199]
    v_mfma_f32_16x16x32_bf16 v[192:195], v[152:155], v[24:27], v[192:195]
    s_waitcnt vmcnt(11)
    v_mfma_f32_16x16x32_bf16 v[208:211], v[152:155], v[48:51], v[208:211]
    v_mfma_f32_16x16x32_bf16 v[212:215], v[156:159], v[48:51], v[212:215]
    v_mfma_f32_16x16x32_bf16 v[216:219], v[160:163], v[48:51], v[216:219]
    v_mfma_f32_16x16x32_bf16 v[220:223], v[164:167], v[48:51], v[220:223]
    s_waitcnt vmcnt(10)
    v_mfma_f32_16x16x32_bf16 v[236:239], v[164:167], v[20:23], v[236:239]
    v_mfma_f32_16x16x32_bf16 v[232:235], v[160:163], v[20:23], v[232:235]
    v_mfma_f32_16x16x32_bf16 v[228:231], v[156:159], v[20:23], v[228:231]
    v_mfma_f32_16x16x32_bf16 v[224:227], v[152:155], v[20:23], v[224:227]
    s_waitcnt lgkmcnt(0)
    s_waitcnt vmcnt(9)
    v_mfma_f32_16x16x32_bf16 v[192:195], v[168:171], v[56:59], v[192:195]
    v_mfma_f32_16x16x32_bf16 v[196:199], v[172:175], v[56:59], v[196:199]
    v_mfma_f32_16x16x32_bf16 v[200:203], v[176:179], v[56:59], v[200:203]
    v_mfma_f32_16x16x32_bf16 v[204:207], v[180:183], v[56:59], v[204:207]
    s_waitcnt vmcnt(8)
    v_mfma_f32_16x16x32_bf16 v[220:223], v[180:183], v[60:63], v[220:223]
    v_mfma_f32_16x16x32_bf16 v[216:219], v[176:179], v[60:63], v[216:219]
    v_mfma_f32_16x16x32_bf16 v[212:215], v[172:175], v[60:63], v[212:215]
    v_mfma_f32_16x16x32_bf16 v[208:211], v[168:171], v[60:63], v[208:211]
    s_waitcnt vmcnt(7)
    v_mfma_f32_16x16x32_bf16 v[224:227], v[168:171], v[68:71], v[224:227]
    v_mfma_f32_16x16x32_bf16 v[228:231], v[172:175], v[68:71], v[228:231]
    v_mfma_f32_16x16x32_bf16 v[232:235], v[176:179], v[68:71], v[232:235]
    v_mfma_f32_16x16x32_bf16 v[236:239], v[180:183], v[68:71], v[236:239]
    s_waitcnt vmcnt(6)
    v_mfma_f32_16x16x32_bf16 v[252:255], v[148:151], v[16:19], v[252:255]
    ds_write_b128 v88, v[192:195] offset:8192
    v_mfma_f32_16x16x32_bf16 v[248:251], v[144:147], v[16:19], v[248:251]
    ds_write_b128 v88, v[196:199] offset:9216
    v_mfma_f32_16x16x32_bf16 v[244:247], v[140:143], v[16:19], v[244:247]
    ds_write_b128 v88, v[200:203] offset:16384
    v_mfma_f32_16x16x32_bf16 v[240:243], v[136:139], v[16:19], v[240:243]
    ds_write_b128 v88, v[204:207] offset:17408
    s_waitcnt vmcnt(5)
    v_mfma_f32_16x16x32_bf16 v[240:243], v[152:155], v[40:43], v[240:243]
    ds_write_b128 v88, v[208:211] offset:24576
    v_mfma_f32_16x16x32_bf16 v[244:247], v[156:159], v[40:43], v[244:247]
    ds_write_b128 v88, v[212:215] offset:25600
    v_mfma_f32_16x16x32_bf16 v[248:251], v[160:163], v[40:43], v[248:251]
    ds_write_b128 v88, v[216:219] offset:32768
    v_mfma_f32_16x16x32_bf16 v[252:255], v[164:167], v[40:43], v[252:255]
    ds_write_b128 v88, v[220:223] offset:33792
    s_waitcnt vmcnt(4)
    v_mfma_f32_16x16x32_bf16 v[252:255], v[180:183], v[28:31], v[252:255]
    ds_write_b128 v88, v[224:227] offset:40960
    v_mfma_f32_16x16x32_bf16 v[248:251], v[176:179], v[28:31], v[248:251]
    ds_write_b128 v88, v[228:231] offset:41984
    v_mfma_f32_16x16x32_bf16 v[244:247], v[172:175], v[28:31], v[244:247]
    ds_write_b128 v88, v[232:235] offset:49152
    v_mfma_f32_16x16x32_bf16 v[240:243], v[168:171], v[28:31], v[240:243]
    ds_write_b128 v88, v[236:239] offset:50176
    s_waitcnt vmcnt(0)
    s_mov_b32 s42, 65536
    s_branch Lzc
Lzr:
    s_sleep 0
    s_add_u32 s43, s80, 0
    buffer_load_dwordx4 v[96:99], v188, s[44:47], s43 offen sc1
    s_add_u32 s43, s80, 32768
    buffer_load_dwordx4 v[100:103], v188, s[44:47], s43 offen sc1
    s_add_u32 s43, s80, 65536
    buffer_load_dwordx4 v[184:187], v188, s[44:47], s43 offen sc1
    s_add_u32 s43, s80, 98304
    buffer_load_dwordx4 v[52:55], v188, s[44:47], s43 offen sc1
    s_waitcnt vmcnt(0)
Lzc:
    v_xor_b32 v97, s36, v97
    v_xor_b32 v99, s36, v99
    v_xor_b32 v101, s36, v101
    v_xor_b32 v103, s36, v103
    v_xor_b32 v185, s36, v185
    v_xor_b32 v187, s36, v187
    v_xor_b32 v53, s36, v53
    v_xor_b32 v55, s36, v55
    v_or3_b32 v10, v97, v99, v101
    v_or3_b32 v11, v103, v185, v187
    v_or3_b32 v10, v10, v53, v55
    v_or_b32 v10, v10, v11
    v_cmp_ne_u32 vcc, 0, v10
    s_sub_u32 s42, s42, 1
    s_cbranch_scc1 Lzd
    s_cbranch_vccnz Lzr
Lzd:
    v_add_u32 v10, 1024, v189
    ds_write2_b32 v189, v96, v98 offset0:0 offset1:1
    ds_write2_b32 v189, v100, v102 offset0:128 offset1:129
    ds_write2_b32 v10, v184, v186 offset0:0 offset1:1
    ds_write2_b32 v10, v52, v54 offset0:128 offset1:129
    s_waitcnt vmcnt(0) lgkmcnt(0)
    s_barrier
    ds_read_b64_tr_b16 v[2:3], v92 offset:0
    ds_read_b64_tr_b16 v[4:5], v92 offset:512
    ds_read_b64_tr_b16 v[6:7], v92 offset:4096
    ds_read_b64_tr_b16 v[8:9], v92 offset:4608
    ds_read_b128 v[112:115], v89 offset:8192
    ds_read_b128 v[116:119], v89 offset:9216
    ds_read_b128 v[120:123], v89 offset:16384
    ds_read_b128 v[124:127], v89 offset:17408
    ds_read_b128 v[128:131], v90 offset:24576
    ds_read_b128 v[132:135], v90 offset:25600
    ds_read_b128 v[136:139], v90 offset:32768
    ds_read_b128 v[140:143], v90 offset:33792
    s_waitcnt lgkmcnt(8)
    ds_read_b128 v[144:147], v91 offset:40960
    ds_read_b128 v[148:151], v91 offset:41984
    ds_read_b128 v[152:155], v91 offset:49152
    ds_read_b128 v[156:159], v91 offset:50176
    v_lshlrev_b32 v16, 16, v2
    v_and_b32 v17, 0xffff0000, v2
    v_lshlrev_b32 v18, 16, v3
    v_and_b32 v19, 0xffff0000, v3
    v_lshlrev_b32 v20, 16, v4
    v_and_b32 v21, 0xffff0000, v4
    v_lshlrev_b32 v22, 16, v5
    v_and_b32 v23, 0xffff0000, v5
    v_lshlrev_b32 v24, 16, v6
    v_and_b32 v25, 0xffff0000, v6
    v_lshlrev_b32 v26, 16, v7
    v_and_b32 v27, 0xffff0000, v7
    v_lshlrev_b32 v28, 16, v8
    v_and_b32 v29, 0xffff0000, v8
    v_lshlrev_b32 v30, 16, v9
    v_and_b32 v31, 0xffff0000, v9
    v_pk_fma_f32 v[240:241], v[72:73], v[16:17], v[240:241]
    v_pk_fma_f32 v[242:243], v[74:75], v[18:19], v[242:243]
    v_pk_fma_f32 v[244:245], v[76:77], v[20:21], v[244:245]
    v_pk_fma_f32 v[246:247], v[78:79], v[22:23], v[246:247]
    v_pk_fma_f32 v[248:249], v[80:81], v[24:25], v[248:249]
    v_pk_fma_f32 v[250:251], v[82:83], v[26:27], v[250:251]
    v_pk_fma_f32 v[252:253], v[84:85], v[28:29], v[252:253]
    v_pk_fma_f32 v[254:255], v[86:87], v[30:31], v[254:255]
    s_waitcnt lgkmcnt(4)
    v_pk_add_f32 v[112:113], v[112:113], v[128:129]
    v_pk_add_f32 v[114:115], v[114:115], v[130:131]
    v_pk_add_f32 v[116:117], v[116:117], v[132:133]
    v_pk_add_f32 v[118:119], v[118:119], v[134:135]
    v_pk_add_f32 v[120:121], v[120:121], v[136:137]
    v_pk_add_f32 v[122:123], v[122:123], v[138:139]
    v_pk_add_f32 v[124:125], v[124:125], v[140:141]
    v_pk_add_f32 v[126:127], v[126:127], v[142:143]
    v_pk_add_f32 v[240:241], v[240:241], v[112:113]
    v_pk_add_f32 v[242:243], v[242:243], v[114:115]
    v_pk_add_f32 v[244:245], v[244:245], v[116:117]
    v_pk_add_f32 v[246:247], v[246:247], v[118:119]
    v_pk_add_f32 v[248:249], v[248:249], v[120:121]
    v_pk_add_f32 v[250:251], v[250:251], v[122:123]
    v_pk_add_f32 v[252:253], v[252:253], v[124:125]
    v_pk_add_f32 v[254:255], v[254:255], v[126:127]
    s_waitcnt lgkmcnt(0)
    v_pk_add_f32 v[240:241], v[240:241], v[144:145]
    v_pk_add_f32 v[242:243], v[242:243], v[146:147]
    v_pk_add_f32 v[244:245], v[244:245], v[148:149]
    v_pk_add_f32 v[246:247], v[246:247], v[150:151]
    v_cvt_pk_bf16_f32 v32, v240, v241
    v_cvt_pk_bf16_f32 v33, v242, v243
    v_cvt_pk_bf16_f32 v34, v244, v245
    v_cvt_pk_bf16_f32 v35, v246, v247
    buffer_store_dwordx4 v[32:35], v14, s[56:59], 0 offen offset:0 sc0 sc1
    v_pk_add_f32 v[248:249], v[248:249], v[152:153]
    v_pk_add_f32 v[250:251], v[250:251], v[154:155]
    v_pk_add_f32 v[252:253], v[252:253], v[156:157]
    v_pk_add_f32 v[254:255], v[254:255], v[158:159]
    v_cvt_pk_bf16_f32 v36, v248, v249
    v_cvt_pk_bf16_f32 v37, v250, v251
    v_cvt_pk_bf16_f32 v38, v252, v253
    v_cvt_pk_bf16_f32 v39, v254, v255
    buffer_store_dwordx4 v[36:39], v14, s[56:59], 0 offen offset:64 sc0 sc1
Lg2end:
    s_endpgm
    .fill ((0 - (Lw1 - Lcw) - (. - Lbase)) & 4095) / 4, 4, 0xBF800000
Lcw:
    s_setprio 2
    s_waitcnt lgkmcnt(0)
    v_and_b32 v10, 15, v1
    v_lshrrev_b32 v11, 4, v1
    v_bfe_u32 v13, v1, 1, 3
    v_xor_b32 v12, v11, v13
    v_lshlrev_b32 v12, 4, v12
    v_lshl_add_u32 v12, v10, 7, v12
    s_and_b32 s38, s30, 1
    s_lshl_b32 s38, s38, 13
    s_add_u32 s38, s38, 81920
    v_add_u32 v2, s38, v12
    v_xor_b32 v3, 64, v2
    v_bfe_u32 v10, v1, 2, 3
    s_lshr_b32 s38, s30, 1
    s_lshl_b32 s38, s38, 2
    v_xor_b32 v10, s38, v10
    v_and_b32 v12, 3, v1
    v_lshlrev_b32 v12, 3, v12
    v_lshl_add_u32 v12, v10, 5, v12
    v_bfe_u32 v13, v1, 2, 2
    v_lshl_add_u32 v12, v13, 8, v12
    v_lshl_add_u32 v4, v11, 11, v12
    v_xor_b32 v5, 32, v4
    v_xor_b32 v6, 64, v4
    v_xor_b32 v7, 96, v4
    v_add_u32 v112, 40960, v4
    v_add_u32 v113, 40960, v5
    v_add_u32 v114, 40960, v6
    v_add_u32 v115, 40960, v7
    v_bfe_u32 v10, v1, 4, 1
    v_lshl_add_u32 v12, v10, 11, v12
    v_lshrrev_b32 v10, 5, v1
    v_lshl_add_u32 v12, v10, 10, v12
    v_add_u32 v116, 147456, v12
    v_xor_b32 v117, 32, v116
    v_xor_b32 v118, 64, v116
    v_xor_b32 v119, 96, v116
    v_mov_b32 v16, 0
    s_lshl_b32 s38, s30, 2
    s_add_u32 s38, s38, 156688
    v_mov_b32 v10, s38
    ds_write_b32 v10, v16
    ds_write_b32 v10, v16 offset:16
    ds_write_b32 v10, v16 offset:32
    s_and_b32 s38, s30, 1
    s_lshl_b32 s38, s38, 8
    s_add_u32 s38, s38, 160896
    v_lshl_add_u32 v10, v1, 2, s38
    ds_write_b32 v10, v16
    s_lshl_b32 s38, s2, 2
    s_load_dword s42, s[14:15], s38
    s_mov_b32 s44, s28
    s_mov_b32 s45, s29
    s_mov_b32 s46, 20971520
    s_mov_b32 s47, 0x20000
    v_mov_b32 v12, 128
    global_load_dword v0, v12, s[26:27]
    s_cmp_lg_u32 s30, 0
    s_cbranch_scc1 Ltl_1a
    s_lshl_b32 s38, s2, 14
    s_add_u32 s38, s38, 16777216
    v_mov_b32 v10, s38
    s_xor_b32 s38, s38, 0x200000
    v_writelane_b32 v10, s38, 6
    s_mov_b32 s38, 57344
    v_writelane_b32 v10, s38, 0
    s_mov_b32 s38, 2392064
    v_writelane_b32 v10, s38, 1
    s_mov_b32 s38, 4726784
    v_writelane_b32 v10, s38, 2
    s_mov_b32 s38, 7831552
    v_writelane_b32 v10, s38, 3
    s_mov_b32 s38, 8388608
    v_writelane_b32 v10, s38, 4
    s_mov_b32 s38, 10493952
    v_writelane_b32 v10, s38, 5
    buffer_load_dword v0, v10, s[44:47], 0 offen sc1
    s_branch Ltl_1d
Ltl_1a:
    s_lshl_b32 s38, s33, 16
    s_lshl_b32 s39, s34, 7
    s_add_u32 s38, s38, s39
    v_mov_b32 v10, s38
    s_cmp_lg_u32 s30, 1
    s_cbranch_scc1 Ltl_1b
    global_load_dword v0, v10, s[24:25]
    s_branch Ltl_1d
Ltl_1b:
    v_mov_b32 v10, s39
    s_cmp_lg_u32 s30, 2
    s_cbranch_scc1 Ltl_1c
    global_load_dword v0, v10, s[22:23]
    s_branch Ltl_1d
Ltl_1c:
    s_lshl_b32 s38, s2, 13
    v_mov_b32 v10, s38
    global_load_dword v0, v10, s[12:13]
Ltl_1d:
    v_and_b32 v8, 15, v1
    s_and_b32 s38, s30, 1
    s_lshl_b32 s38, s38, 9
    s_add_u32 s38, s38, 155648
    v_lshl_add_u32 v9, v8, 3, s38
    v_lshlrev_b32 v8, 4, v1
    s_lshl_b32 s38, s30, 2
    s_add_u32 s38, s38, 156720
    v_mov_b32 v120, s38
    v_mov_b32 v121, 156672
    s_lshl_b32 s38, s31, 3
    s_and_b32 s39, s30, 1
    s_lshl_b32 s39, s39, 2
    s_add_u32 s38, s38, s39
    s_mul_i32 s38, s38, 57
    s_lshl_b32 s39, s32, 2
    s_add_u32 s38, s38, s39
    s_and_b32 s39, s30, 2
    s_add_u32 s38, s38, s39
    s_lshl_b32 s84, s38, 10
    s_add_u32 s85, s84, 58368
    s_add_u32 s86, s84, 116736
    s_add_u32 s87, s84, 175104
    s_lshl_b32 s81, s31, 1
    s_and_b32 s39, s30, 1
    s_add_u32 s81, s81, s39
    s_mul_i32 s81, s81, 28
    s_lshl_b32 s39, s32, 1
    s_add_u32 s81, s81, s39
    s_lshr_b32 s39, s30, 1
    s_add_u32 s81, s81, s39
    s_lshl_b32 s81, s81, 7
    s_add_u32 s81, s81, 7864320
    s_add_u32 s82, s81, 131072
    s_and_b32 s39, s2, 7
    s_lshl_b32 s39, s39, 5
    s_lshr_b32 s38, s2, 3
    s_add_u32 s39, s39, s38
    s_lshl_b32 s39, s39, 2
    s_add_u32 s39, s39, s30
    s_lshl_b32 s38, s39, 11
    v_and_b32 v89, 32, v1
    v_add_u32 v88, v89, v1
    v_lshl_add_u32 v88, v88, 4, s38
    s_lshl_b32 s38, s39, 4
    s_add_u32 s83, s38, 7602176
    s_waitcnt lgkmcnt(0)
    global_load_dwordx4 v[80:83], v88, s[4:5]
    global_load_dwordx4 v[84:87], v88, s[4:5] offset:512
    s_lshr_b32 s38, s30, 1
    s_and_b32 s39, s30, 1
    s_mul_i32 s40, s38, 4608
    s_lshl_b32 s41, s39, 6
    s_add_u32 s40, s40, s41
    s_add_u32 s40, s40, 127648
    v_and_b32 v10, 15, v1
    v_lshrrev_b32 v11, 4, v1
    v_lshlrev_b32 v12, 5, v10
    v_lshl_add_u32 v13, v11, 4, s40
    v_sub_u32 v122, v13, v12
    s_mul_i32 s40, s38, 8320
    s_add_u32 s40, s40, 114688
    s_mul_i32 s43, s38, 29568
    s_add_u32 s43, s43, 4160
    s_add_u32 s40, s40, s41
    v_lshl_add_u32 v10, v11, 3, v10
    v_add_u32 v12, 1, v10
    v_and_b32 v13, 1, v12
    v_lshrrev_b32 v12, 1, v12
    v_lshl_add_u32 v12, v12, 2, s40
    v_mul_u32_u24 v13, s43, v13
    v_add_u32 v123, v12, v13
    v_sub_u32 v12, 15, v10
    v_and_b32 v13, 1, v12
    v_lshlrev_b32 v13, 4, v13
    v_lshrrev_b32 v12, 1, v12
    s_lshl_b32 s38, s38, 4
    s_waitcnt lgkmcnt(0)
    s_lshr_b32 s40, s42, s38
    s_and_b32 s40, s40, 0xffff
    s_cmp_eq_u32 s39, 0
    s_cselect_b32 s40, s40, 0
    v_lshlrev_b32 v13, v13, s40
    v_cmp_eq_u32 vcc, 0, v12
    s_nop 1
    v_cndmask_b32 v124, 0, v13, vcc
    v_cmp_eq_u32 vcc, 1, v12
    s_nop 1
    v_cndmask_b32 v125, 0, v13, vcc
    v_cmp_eq_u32 vcc, 2, v12
    s_nop 1
    v_cndmask_b32 v126, 0, v13, vcc
    v_cmp_eq_u32 vcc, 3, v12
    s_nop 1
    v_cndmask_b32 v127, 0, v13, vcc
    s_barrier
    ds_read_b128 v[48:51], v2 offset:32768
    ds_read_b128 v[52:55], v2 offset:34816
    ds_read_b128 v[56:59], v2 offset:36864
    ds_read_b128 v[60:63], v2 offset:38912
    ds_read_b64_tr_b16 v[16:17], v4 offset:0
    ds_read_b64_tr_b16 v[18:19], v4 offset:1024
    ds_read_b64_tr_b16 v[20:21], v5 offset:0
    ds_read_b64_tr_b16 v[22:23], v5 offset:1024
    ds_read_b64_tr_b16 v[24:25], v112 offset:0
    ds_read_b64_tr_b16 v[26:27], v112 offset:1024
    ds_read_b64_tr_b16 v[28:29], v113 offset:0
    ds_read_b64_tr_b16 v[30:31], v113 offset:1024
    s_waitcnt lgkmcnt(0)
    v_mfma_f32_16x16x32_bf16 v[128:131], v[16:19], v[48:51], 0
    ds_read_b64_tr_b16 v[32:33], v6 offset:0
    v_mfma_f32_16x16x32_bf16 v[144:147], v[16:19], v[52:55], 0
    ds_read_b64_tr_b16 v[34:35], v6 offset:1024
    v_mfma_f32_16x16x32_bf16 v[160:163], v[16:19], v[56:59], 0
    ds_read_b64_tr_b16 v[36:37], v7 offset:0
    v_mfma_f32_16x16x32_bf16 v[176:179], v[16:19], v[60:63], 0
    ds_read_b64_tr_b16 v[38:39], v7 offset:1024
    v_mfma_f32_16x16x32_bf16 v[180:183], v[20:23], v[60:63], 0
    ds_read_b64_tr_b16 v[40:41], v114 offset:0
    v_mfma_f32_16x16x32_bf16 v[164:167], v[20:23], v[56:59], 0
    ds_read_b64_tr_b16 v[42:43], v114 offset:1024
    v_mfma_f32_16x16x32_bf16 v[148:151], v[20:23], v[52:55], 0
    ds_read_b64_tr_b16 v[44:45], v115 offset:0
    v_mfma_f32_16x16x32_bf16 v[132:135], v[20:23], v[48:51], 0
    ds_read_b64_tr_b16 v[46:47], v115 offset:1024
    v_mfma_f32_16x16x32_bf16 v[136:139], v[24:27], v[48:51], 0
    v_mfma_f32_16x16x32_bf16 v[152:155], v[24:27], v[52:55], 0
    v_mfma_f32_16x16x32_bf16 v[168:171], v[24:27], v[56:59], 0
    v_mfma_f32_16x16x32_bf16 v[184:187], v[24:27], v[60:63], 0
    v_mfma_f32_16x16x32_bf16 v[188:191], v[28:31], v[60:63], 0
    v_mfma_f32_16x16x32_bf16 v[172:175], v[28:31], v[56:59], 0
    v_mfma_f32_16x16x32_bf16 v[156:159], v[28:31], v[52:55], 0
    v_mfma_f32_16x16x32_bf16 v[140:143], v[28:31], v[48:51], 0
    s_waitcnt lgkmcnt(0)
    v_mfma_f32_16x16x32_bf16 v[192:195], v[32:35], v[48:51], 0
    s_barrier
    ds_read_b128 v[64:67], v3 offset:32768
    v_mfma_f32_16x16x32_bf16 v[208:211], v[32:35], v[52:55], 0
    ds_read_b128 v[68:71], v3 offset:34816
    v_mfma_f32_16x16x32_bf16 v[224:227], v[32:35], v[56:59], 0
    ds_read_b128 v[72:75], v3 offset:36864
    v_mfma_f32_16x16x32_bf16 v[240:243], v[32:35], v[60:63], 0
    ds_read_b128 v[76:79], v3 offset:38912
    v_mfma_f32_16x16x32_bf16 v[244:247], v[36:39], v[60:63], 0
    ds_read_b64_tr_b16 v[16:17], v4 offset:8192
    v_mfma_f32_16x16x32_bf16 v[228:231], v[36:39], v[56:59], 0
    ds_read_b64_tr_b16 v[18:19], v4 offset:9216
    v_mfma_f32_16x16x32_bf16 v[212:215], v[36:39], v[52:55], 0
    ds_read_b64_tr_b16 v[20:21], v5 offset:8192
    v_mfma_f32_16x16x32_bf16 v[196:199], v[36:39], v[48:51], 0
    ds_read_b64_tr_b16 v[22:23], v5 offset:9216
    v_mfma_f32_16x16x32_bf16 v[200:203], v[40:43], v[48:51], 0
    ds_read_b64_tr_b16 v[24:25], v112 offset:8192
    v_mfma_f32_16x16x32_bf16 v[216:219], v[40:43], v[52:55], 0
    ds_read_b64_tr_b16 v[26:27], v112 offset:9216
    v_mfma_f32_16x16x32_bf16 v[232:235], v[40:43], v[56:59], 0
    ds_read_b64_tr_b16 v[28:29], v113 offset:8192
    v_mfma_f32_16x16x32_bf16 v[248:251], v[40:43], v[60:63], 0
    ds_read_b64_tr_b16 v[30:31], v113 offset:9216
    v_mfma_f32_16x16x32_bf16 v[252:255], v[44:47], v[60:63], 0
    v_mfma_f32_16x16x32_bf16 v[236:239], v[44:47], v[56:59], 0
    v_mfma_f32_16x16x32_bf16 v[220:223], v[44:47], v[52:55], 0
    v_mfma_f32_16x16x32_bf16 v[204:207], v[44:47], v[48:51], 0
    s_waitcnt lgkmcnt(0)
    v_mfma_f32_16x16x32_bf16 v[128:131], v[16:19], v[64:67], v[128:131]
    ds_read_b64_tr_b16 v[32:33], v6 offset:8192
    v_mfma_f32_16x16x32_bf16 v[144:147], v[16:19], v[68:71], v[144:147]
    ds_read_b64_tr_b16 v[34:35], v6 offset:9216
    v_mfma_f32_16x16x32_bf16 v[160:163], v[16:19], v[72:75], v[160:163]
    ds_read_b64_tr_b16 v[36:37], v7 offset:8192
    v_mfma_f32_16x16x32_bf16 v[176:179], v[16:19], v[76:79], v[176:179]
    ds_read_b64_tr_b16 v[38:39], v7 offset:9216
    v_mfma_f32_16x16x32_bf16 v[180:183], v[20:23], v[76:79], v[180:183]
    ds_read_b64_tr_b16 v[40:41], v114 offset:8192
    v_mfma_f32_16x16x32_bf16 v[164:167], v[20:23], v[72:75], v[164:167]
    ds_read_b64_tr_b16 v[42:43], v114 offset:9216
    v_mfma_f32_16x16x32_bf16 v[148:151], v[20:23], v[68:71], v[148:151]
    ds_read_b64_tr_b16 v[44:45], v115 offset:8192
    v_mfma_f32_16x16x32_bf16 v[132:135], v[20:23], v[64:67], v[132:135]
    ds_read_b64_tr_b16 v[46:47], v115 offset:9216
    v_mfma_f32_16x16x32_bf16 v[136:139], v[24:27], v[64:67], v[136:139]
    v_mfma_f32_16x16x32_bf16 v[152:155], v[24:27], v[68:71], v[152:155]
    v_mfma_f32_16x16x32_bf16 v[168:171], v[24:27], v[72:75], v[168:171]
    v_mfma_f32_16x16x32_bf16 v[184:187], v[24:27], v[76:79], v[184:187]
    v_mfma_f32_16x16x32_bf16 v[188:191], v[28:31], v[76:79], v[188:191]
    v_mfma_f32_16x16x32_bf16 v[172:175], v[28:31], v[72:75], v[172:175]
    v_mfma_f32_16x16x32_bf16 v[156:159], v[28:31], v[68:71], v[156:159]
    v_mfma_f32_16x16x32_bf16 v[140:143], v[28:31], v[64:67], v[140:143]
    s_waitcnt vmcnt(0)
    v_lshlrev_b32 v90, 16, v80
    v_and_b32 v91, 0xffff0000, v80
    v_lshlrev_b32 v92, 16, v81
    v_and_b32 v93, 0xffff0000, v81
    v_lshlrev_b32 v94, 16, v82
    v_and_b32 v95, 0xffff0000, v82
    v_lshlrev_b32 v96, 16, v83
    v_and_b32 v97, 0xffff0000, v83
    v_lshlrev_b32 v98, 16, v84
    v_and_b32 v99, 0xffff0000, v84
    v_lshlrev_b32 v100, 16, v85
    v_and_b32 v101, 0xffff0000, v85
    v_lshlrev_b32 v102, 16, v86
    v_and_b32 v103, 0xffff0000, v86
    v_lshlrev_b32 v104, 16, v87
    v_and_b32 v105, 0xffff0000, v87
    v_pk_add_f32 v[106:107], v[90:91], v[92:93]
    v_pk_mul_f32 v[108:109], v[90:91], v[90:91]
    v_pk_fma_f32 v[108:109], v[92:93], v[92:93], v[108:109]
    v_pk_add_f32 v[106:107], v[106:107], v[94:95]
    v_pk_fma_f32 v[108:109], v[94:95], v[94:95], v[108:109]
    v_pk_add_f32 v[106:107], v[106:107], v[96:97]
    v_pk_fma_f32 v[108:109], v[96:97], v[96:97], v[108:109]
    v_pk_add_f32 v[106:107], v[106:107], v[98:99]
    v_pk_fma_f32 v[108:109], v[98:99], v[98:99], v[108:109]
    v_pk_add_f32 v[106:107], v[106:107], v[100:101]
    v_pk_fma_f32 v[108:109], v[100:101], v[100:101], v[108:109]
    v_pk_add_f32 v[106:107], v[106:107], v[102:103]
    v_pk_fma_f32 v[108:109], v[102:103], v[102:103], v[108:109]
    v_pk_add_f32 v[106:107], v[106:107], v[104:105]
    v_pk_fma_f32 v[108:109], v[104:105], v[104:105], v[108:109]
    v_add_f32 v106, v106, v107
    v_add_f32 v108, v108, v109
    s_nop 1
    v_add_f32_dpp v106, v106, v106 quad_perm:[1,0,3,2] row_mask:0xf bank_mask:0xf
    v_add_f32_dpp v108, v108, v108 quad_perm:[1,0,3,2] row_mask:0xf bank_mask:0xf
    s_nop 1
    v_add_f32_dpp v106, v106, v106 quad_perm:[2,3,0,1] row_mask:0xf bank_mask:0xf
    v_add_f32_dpp v108, v108, v108 quad_perm:[2,3,0,1] row_mask:0xf bank_mask:0xf
    s_nop 1
    v_add_f32_dpp v106, v106, v106 row_half_mirror row_mask:0xf bank_mask:0xf
    v_add_f32_dpp v108, v108, v108 row_half_mirror row_mask:0xf bank_mask:0xf
    s_nop 1
    v_add_f32_dpp v106, v106, v106 row_mirror row_mask:0xf bank_mask:0xf
    v_add_f32_dpp v108, v108, v108 row_mirror row_mask:0xf bank_mask:0xf
    v_mov_b32 v107, v106
    v_mov_b32 v109, v108
    s_nop 1
    v_permlane16_swap_b32 v106, v107
    v_permlane16_swap_b32 v108, v109
    v_add_f32 v106, v106, v107
    v_add_f32 v108, v108, v109
    v_mul_f32 v106, 989855744, v106
    v_mul_f32 v108, 989855744, v108
    v_fma_f32 v108, -v106, v106, v108
    v_max_f32 v108, 0, v108
    v_cvt_pk_bf16_f32 v108, v108, v108
    v_lshlrev_b32 v108, 16, v108
    v_add_f32 v108, 925353388, v108
    v_cvt_pk_bf16_f32 v108, v108, v108
    v_lshlrev_b32 v108, 16, v108
    v_sqrt_f32 v108, v108
    v_sub_f32 v106, 0, v106
    v_cvt_pk_bf16_f32 v108, v108, v108
    v_lshlrev_b32 v81, 16, v108
    v_cvt_pk_bf16_f32 v80, v106, v106
    v_lshrrev_b32 v89, 2, v89
    s_mov_b32 exec_lo, 1
    s_mov_b32 exec_hi, 1
    buffer_store_dwordx2 v[80:81], v89, s[44:47], s83 offen sc1
    s_mov_b64 exec, -1
    s_waitcnt lgkmcnt(0)
    v_mfma_f32_16x16x32_bf16 v[192:195], v[32:35], v[64:67], v[192:195]
    s_barrier
    ds_read_b128 v[48:51], v2 offset:49152
    v_mfma_f32_16x16x32_bf16 v[208:211], v[32:35], v[68:71], v[208:211]
    ds_read_b128 v[52:55], v2 offset:51200
    v_mfma_f32_16x16x32_bf16 v[224:227], v[32:35], v[72:75], v[224:227]
    ds_read_b128 v[56:59], v2 offset:53248
    v_mfma_f32_16x16x32_bf16 v[240:243], v[32:35], v[76:79], v[240:243]
    ds_read_b128 v[60:63], v2 offset:55296
    v_mfma_f32_16x16x32_bf16 v[244:247], v[36:39], v[76:79], v[244:247]
    ds_read_b64_tr_b16 v[16:17], v4 offset:16384
    v_mfma_f32_16x16x32_bf16 v[228:231], v[36:39], v[72:75], v[228:231]
    ds_read_b64_tr_b16 v[18:19], v4 offset:17408
    v_mfma_f32_16x16x32_bf16 v[212:215], v[36:39], v[68:71], v[212:215]
    ds_read_b64_tr_b16 v[20:21], v5 offset:16384
    v_mfma_f32_16x16x32_bf16 v[196:199], v[36:39], v[64:67], v[196:199]
    ds_read_b64_tr_b16 v[22:23], v5 offset:17408
    v_mfma_f32_16x16x32_bf16 v[200:203], v[40:43], v[64:67], v[200:203]
    ds_read_b64_tr_b16 v[24:25], v112 offset:16384
    v_mfma_f32_16x16x32_bf16 v[216:219], v[40:43], v[68:71], v[216:219]
    ds_read_b64_tr_b16 v[26:27], v112 offset:17408
    v_mfma_f32_16x16x32_bf16 v[232:235], v[40:43], v[72:75], v[232:235]
    ds_read_b64_tr_b16 v[28:29], v113 offset:16384
    v_mfma_f32_16x16x32_bf16 v[248:251], v[40:43], v[76:79], v[248:251]
    ds_read_b64_tr_b16 v[30:31], v113 offset:17408
    v_mfma_f32_16x16x32_bf16 v[252:255], v[44:47], v[76:79], v[252:255]
    v_mfma_f32_16x16x32_bf16 v[236:239], v[44:47], v[72:75], v[236:239]
    v_mfma_f32_16x16x32_bf16 v[220:223], v[44:47], v[68:71], v[220:223]
    v_mfma_f32_16x16x32_bf16 v[204:207], v[44:47], v[64:67], v[204:207]
    s_waitcnt lgkmcnt(0)
    v_mfma_f32_16x16x32_bf16 v[128:131], v[16:19], v[48:51], v[128:131]
    ds_read_b64_tr_b16 v[32:33], v6 offset:16384
    v_mfma_f32_16x16x32_bf16 v[144:147], v[16:19], v[52:55], v[144:147]
    ds_read_b64_tr_b16 v[34:35], v6 offset:17408
    v_mfma_f32_16x16x32_bf16 v[160:163], v[16:19], v[56:59], v[160:163]
    ds_read_b64_tr_b16 v[36:37], v7 offset:16384
    v_mfma_f32_16x16x32_bf16 v[176:179], v[16:19], v[60:63], v[176:179]
    ds_read_b64_tr_b16 v[38:39], v7 offset:17408
    v_mfma_f32_16x16x32_bf16 v[180:183], v[20:23], v[60:63], v[180:183]
    ds_read_b64_tr_b16 v[40:41], v114 offset:16384
    v_mfma_f32_16x16x32_bf16 v[164:167], v[20:23], v[56:59], v[164:167]
    ds_read_b64_tr_b16 v[42:43], v114 offset:17408
    v_mfma_f32_16x16x32_bf16 v[148:151], v[20:23], v[52:55], v[148:151]
    ds_read_b64_tr_b16 v[44:45], v115 offset:16384
    v_mfma_f32_16x16x32_bf16 v[132:135], v[20:23], v[48:51], v[132:135]
    ds_read_b64_tr_b16 v[46:47], v115 offset:17408
    v_mfma_f32_16x16x32_bf16 v[136:139], v[24:27], v[48:51], v[136:139]
    v_mfma_f32_16x16x32_bf16 v[152:155], v[24:27], v[52:55], v[152:155]
    v_mfma_f32_16x16x32_bf16 v[168:171], v[24:27], v[56:59], v[168:171]
    v_mfma_f32_16x16x32_bf16 v[184:187], v[24:27], v[60:63], v[184:187]
    v_mfma_f32_16x16x32_bf16 v[188:191], v[28:31], v[60:63], v[188:191]
    v_mfma_f32_16x16x32_bf16 v[172:175], v[28:31], v[56:59], v[172:175]
    v_mfma_f32_16x16x32_bf16 v[156:159], v[28:31], v[52:55], v[156:159]
    v_mfma_f32_16x16x32_bf16 v[140:143], v[28:31], v[48:51], v[140:143]
    s_waitcnt lgkmcnt(0)
    v_mfma_f32_16x16x32_bf16 v[192:195], v[32:35], v[48:51], v[192:195]
    s_barrier
    ds_read_b128 v[64:67], v3 offset:49152
    v_mfma_f32_16x16x32_bf16 v[208:211], v[32:35], v[52:55], v[208:211]
    ds_read_b128 v[68:71], v3 offset:51200
    v_mfma_f32_16x16x32_bf16 v[224:227], v[32:35], v[56:59], v[224:227]
    ds_read_b128 v[72:75], v3 offset:53248
    v_mfma_f32_16x16x32_bf16 v[240:243], v[32:35], v[60:63], v[240:243]
    ds_read_b128 v[76:79], v3 offset:55296
    v_mfma_f32_16x16x32_bf16 v[244:247], v[36:39], v[60:63], v[244:247]
    ds_read_b64_tr_b16 v[16:17], v4 offset:24576
    v_mfma_f32_16x16x32_bf16 v[228:231], v[36:39], v[56:59], v[228:231]
    ds_read_b64_tr_b16 v[18:19], v4 offset:25600
    v_mfma_f32_16x16x32_bf16 v[212:215], v[36:39], v[52:55], v[212:215]
    ds_read_b64_tr_b16 v[20:21], v5 offset:24576
    v_mfma_f32_16x16x32_bf16 v[196:199], v[36:39], v[48:51], v[196:199]
    ds_read_b64_tr_b16 v[22:23], v5 offset:25600
    v_mfma_f32_16x16x32_bf16 v[200:203], v[40:43], v[48:51], v[200:203]
    ds_read_b64_tr_b16 v[24:25], v112 offset:24576
    v_mfma_f32_16x16x32_bf16 v[216:219], v[40:43], v[52:55], v[216:219]
    ds_read_b64_tr_b16 v[26:27], v112 offset:25600
    v_mfma_f32_16x16x32_bf16 v[232:235], v[40:43], v[56:59], v[232:235]
    ds_read_b64_tr_b16 v[28:29], v113 offset:24576
    v_mfma_f32_16x16x32_bf16 v[248:251], v[40:43], v[60:63], v[248:251]
    ds_read_b64_tr_b16 v[30:31], v113 offset:25600
    v_mfma_f32_16x16x32_bf16 v[252:255], v[44:47], v[60:63], v[252:255]
    v_mfma_f32_16x16x32_bf16 v[236:239], v[44:47], v[56:59], v[236:239]
    v_mfma_f32_16x16x32_bf16 v[220:223], v[44:47], v[52:55], v[220:223]
    v_mfma_f32_16x16x32_bf16 v[204:207], v[44:47], v[48:51], v[204:207]
    s_waitcnt lgkmcnt(0)
    v_mfma_f32_16x16x32_bf16 v[128:131], v[16:19], v[64:67], v[128:131]
    ds_read_b64_tr_b16 v[32:33], v6 offset:24576
    v_mfma_f32_16x16x32_bf16 v[144:147], v[16:19], v[68:71], v[144:147]
    ds_read_b64_tr_b16 v[34:35], v6 offset:25600
    v_mfma_f32_16x16x32_bf16 v[160:163], v[16:19], v[72:75], v[160:163]
    ds_read_b64_tr_b16 v[36:37], v7 offset:24576
    v_mfma_f32_16x16x32_bf16 v[176:179], v[16:19], v[76:79], v[176:179]
    ds_read_b64_tr_b16 v[38:39], v7 offset:25600
    v_mfma_f32_16x16x32_bf16 v[180:183], v[20:23], v[76:79], v[180:183]
    ds_read_b64_tr_b16 v[40:41], v114 offset:24576
    v_mfma_f32_16x16x32_bf16 v[164:167], v[20:23], v[72:75], v[164:167]
    ds_read_b64_tr_b16 v[42:43], v114 offset:25600
    v_mfma_f32_16x16x32_bf16 v[148:151], v[20:23], v[68:71], v[148:151]
    ds_read_b64_tr_b16 v[44:45], v115 offset:24576
    v_mfma_f32_16x16x32_bf16 v[132:135], v[20:23], v[64:67], v[132:135]
    ds_read_b64_tr_b16 v[46:47], v115 offset:25600
    v_mfma_f32_16x16x32_bf16 v[136:139], v[24:27], v[64:67], v[136:139]
    v_mfma_f32_16x16x32_bf16 v[152:155], v[24:27], v[68:71], v[152:155]
    v_mfma_f32_16x16x32_bf16 v[168:171], v[24:27], v[72:75], v[168:171]
    v_mfma_f32_16x16x32_bf16 v[184:187], v[24:27], v[76:79], v[184:187]
    v_mfma_f32_16x16x32_bf16 v[188:191], v[28:31], v[76:79], v[188:191]
    v_mfma_f32_16x16x32_bf16 v[172:175], v[28:31], v[72:75], v[172:175]
    v_mfma_f32_16x16x32_bf16 v[156:159], v[28:31], v[68:71], v[156:159]
    v_mfma_f32_16x16x32_bf16 v[140:143], v[28:31], v[64:67], v[140:143]
    s_waitcnt lgkmcnt(0)
    v_mfma_f32_16x16x32_bf16 v[192:195], v[32:35], v[64:67], v[192:195]
    s_barrier
    ds_read_b128 v[48:51], v2 offset:0
    v_mfma_f32_16x16x32_bf16 v[208:211], v[32:35], v[68:71], v[208:211]
    ds_read_b128 v[52:55], v2 offset:2048
    v_mfma_f32_16x16x32_bf16 v[224:227], v[32:35], v[72:75], v[224:227]
    ds_read_b128 v[56:59], v2 offset:4096
    v_mfma_f32_16x16x32_bf16 v[240:243], v[32:35], v[76:79], v[240:243]
    ds_read_b128 v[60:63], v2 offset:6144
    v_mfma_f32_16x16x32_bf16 v[244:247], v[36:39], v[76:79], v[244:247]
    ds_read_b64_tr_b16 v[16:17], v4 offset:32768
    v_mfma_f32_16x16x32_bf16 v[228:231], v[36:39], v[72:75], v[228:231]
    ds_read_b64_tr_b16 v[18:19], v4 offset:33792
    v_mfma_f32_16x16x32_bf16 v[212:215], v[36:39], v[68:71], v[212:215]
    ds_read_b64_tr_b16 v[20:21], v5 offset:32768
    v_mfma_f32_16x16x32_bf16 v[196:199], v[36:39], v[64:67], v[196:199]
    ds_read_b64_tr_b16 v[22:23], v5 offset:33792
    v_mfma_f32_16x16x32_bf16 v[200:203], v[40:43], v[64:67], v[200:203]
    ds_read_b64_tr_b16 v[24:25], v112 offset:32768
    v_mfma_f32_16x16x32_bf16 v[216:219], v[40:43], v[68:71], v[216:219]
    ds_read_b64_tr_b16 v[26:27], v112 offset:33792
    v_mfma_f32_16x16x32_bf16 v[232:235], v[40:43], v[72:75], v[232:235]
    ds_read_b64_tr_b16 v[28:29], v113 offset:32768
    v_mfma_f32_16x16x32_bf16 v[248:251], v[40:43], v[76:79], v[248:251]
    ds_read_b64_tr_b16 v[30:31], v113 offset:33792
    v_mfma_f32_16x16x32_bf16 v[252:255], v[44:47], v[76:79], v[252:255]
    v_mfma_f32_16x16x32_bf16 v[236:239], v[44:47], v[72:75], v[236:239]
    v_mfma_f32_16x16x32_bf16 v[220:223], v[44:47], v[68:71], v[220:223]
    v_mfma_f32_16x16x32_bf16 v[204:207], v[44:47], v[64:67], v[204:207]
    s_waitcnt lgkmcnt(0)
    v_mfma_f32_16x16x32_bf16 v[128:131], v[16:19], v[48:51], v[128:131]
    ds_read_b64_tr_b16 v[32:33], v6 offset:32768
    v_mfma_f32_16x16x32_bf16 v[144:147], v[16:19], v[52:55], v[144:147]
    ds_read_b64_tr_b16 v[34:35], v6 offset:33792
    v_mfma_f32_16x16x32_bf16 v[160:163], v[16:19], v[56:59], v[160:163]
    ds_read_b64_tr_b16 v[36:37], v7 offset:32768
    v_mfma_f32_16x16x32_bf16 v[176:179], v[16:19], v[60:63], v[176:179]
    ds_read_b64_tr_b16 v[38:39], v7 offset:33792
    v_mfma_f32_16x16x32_bf16 v[180:183], v[20:23], v[60:63], v[180:183]
    ds_read_b64_tr_b16 v[40:41], v114 offset:32768
    v_mfma_f32_16x16x32_bf16 v[164:167], v[20:23], v[56:59], v[164:167]
    ds_read_b64_tr_b16 v[42:43], v114 offset:33792
    v_mfma_f32_16x16x32_bf16 v[148:151], v[20:23], v[52:55], v[148:151]
    ds_read_b64_tr_b16 v[44:45], v115 offset:32768
    v_mfma_f32_16x16x32_bf16 v[132:135], v[20:23], v[48:51], v[132:135]
    ds_read_b64_tr_b16 v[46:47], v115 offset:33792
    v_mfma_f32_16x16x32_bf16 v[136:139], v[24:27], v[48:51], v[136:139]
    v_mfma_f32_16x16x32_bf16 v[152:155], v[24:27], v[52:55], v[152:155]
    v_mfma_f32_16x16x32_bf16 v[168:171], v[24:27], v[56:59], v[168:171]
    v_mfma_f32_16x16x32_bf16 v[184:187], v[24:27], v[60:63], v[184:187]
    v_mfma_f32_16x16x32_bf16 v[188:191], v[28:31], v[60:63], v[188:191]
    v_mfma_f32_16x16x32_bf16 v[172:175], v[28:31], v[56:59], v[172:175]
    v_mfma_f32_16x16x32_bf16 v[156:159], v[28:31], v[52:55], v[156:159]
    v_mfma_f32_16x16x32_bf16 v[140:143], v[28:31], v[48:51], v[140:143]
    s_waitcnt lgkmcnt(0)
    v_mfma_f32_16x16x32_bf16 v[192:195], v[32:35], v[48:51], v[192:195]
    s_barrier
    ds_read_b128 v[64:67], v3 offset:0
    v_mfma_f32_16x16x32_bf16 v[208:211], v[32:35], v[52:55], v[208:211]
    ds_read_b128 v[68:71], v3 offset:2048
    v_mfma_f32_16x16x32_bf16 v[224:227], v[32:35], v[56:59], v[224:227]
    ds_read_b128 v[72:75], v3 offset:4096
    v_mfma_f32_16x16x32_bf16 v[240:243], v[32:35], v[60:63], v[240:243]
    ds_read_b128 v[76:79], v3 offset:6144
    v_mfma_f32_16x16x32_bf16 v[244:247], v[36:39], v[60:63], v[244:247]
    ds_read_b64_tr_b16 v[16:17], v4 offset:0
    v_mfma_f32_16x16x32_bf16 v[228:231], v[36:39], v[56:59], v[228:231]
    ds_read_b64_tr_b16 v[18:19], v4 offset:1024
    v_mfma_f32_16x16x32_bf16 v[212:215], v[36:39], v[52:55], v[212:215]
    ds_read_b64_tr_b16 v[20:21], v5 offset:0
    v_mfma_f32_16x16x32_bf16 v[196:199], v[36:39], v[48:51], v[196:199]
    ds_read_b64_tr_b16 v[22:23], v5 offset:1024
    v_mfma_f32_16x16x32_bf16 v[200:203], v[40:43], v[48:51], v[200:203]
    ds_read_b64_tr_b16 v[24:25], v112 offset:0
    v_mfma_f32_16x16x32_bf16 v[216:219], v[40:43], v[52:55], v[216:219]
    ds_read_b64_tr_b16 v[26:27], v112 offset:1024
    v_mfma_f32_16x16x32_bf16 v[232:235], v[40:43], v[56:59], v[232:235]
    ds_read_b64_tr_b16 v[28:29], v113 offset:0
    v_mfma_f32_16x16x32_bf16 v[248:251], v[40:43], v[60:63], v[248:251]
    ds_read_b64_tr_b16 v[30:31], v113 offset:1024
    v_mfma_f32_16x16x32_bf16 v[252:255], v[44:47], v[60:63], v[252:255]
    v_mfma_f32_16x16x32_bf16 v[236:239], v[44:47], v[56:59], v[236:239]
    v_mfma_f32_16x16x32_bf16 v[220:223], v[44:47], v[52:55], v[220:223]
    v_mfma_f32_16x16x32_bf16 v[204:207], v[44:47], v[48:51], v[204:207]
    s_waitcnt vmcnt(0) lgkmcnt(0)
    v_mfma_f32_16x16x32_bf16 v[128:131], v[16:19], v[64:67], v[128:131]
    ds_read_b64_tr_b16 v[32:33], v6 offset:0
    v_mfma_f32_16x16x32_bf16 v[144:147], v[16:19], v[68:71], v[144:147]
    ds_read_b64_tr_b16 v[34:35], v6 offset:1024
    v_mfma_f32_16x16x32_bf16 v[160:163], v[16:19], v[72:75], v[160:163]
    ds_read_b64_tr_b16 v[36:37], v7 offset:0
    v_mfma_f32_16x16x32_bf16 v[176:179], v[16:19], v[76:79], v[176:179]
    ds_read_b64_tr_b16 v[38:39], v7 offset:1024
    v_mfma_f32_16x16x32_bf16 v[180:183], v[20:23], v[76:79], v[180:183]
    ds_read_b64_tr_b16 v[40:41], v114 offset:0
    v_mfma_f32_16x16x32_bf16 v[164:167], v[20:23], v[72:75], v[164:167]
    ds_read_b64_tr_b16 v[42:43], v114 offset:1024
    v_mfma_f32_16x16x32_bf16 v[148:151], v[20:23], v[68:71], v[148:151]
    ds_read_b64_tr_b16 v[44:45], v115 offset:0
    v_mfma_f32_16x16x32_bf16 v[132:135], v[20:23], v[64:67], v[132:135]
    ds_read_b64_tr_b16 v[46:47], v115 offset:1024
    v_mfma_f32_16x16x32_bf16 v[136:139], v[24:27], v[64:67], v[136:139]
    v_mfma_f32_16x16x32_bf16 v[152:155], v[24:27], v[68:71], v[152:155]
    v_mfma_f32_16x16x32_bf16 v[168:171], v[24:27], v[72:75], v[168:171]
    v_mfma_f32_16x16x32_bf16 v[184:187], v[24:27], v[76:79], v[184:187]
    v_mfma_f32_16x16x32_bf16 v[188:191], v[28:31], v[76:79], v[188:191]
    v_mfma_f32_16x16x32_bf16 v[172:175], v[28:31], v[72:75], v[172:175]
    v_mfma_f32_16x16x32_bf16 v[156:159], v[28:31], v[68:71], v[156:159]
    v_mfma_f32_16x16x32_bf16 v[140:143], v[28:31], v[64:67], v[140:143]
    s_waitcnt lgkmcnt(0)
    v_mfma_f32_16x16x32_bf16 v[192:195], v[32:35], v[64:67], v[192:195]
    s_barrier
    ds_read_b128 v[48:51], v2 offset:16384
    v_mfma_f32_16x16x32_bf16 v[208:211], v[32:35], v[68:71], v[208:211]
    ds_read_b128 v[52:55], v2 offset:18432
    v_mfma_f32_16x16x32_bf16 v[224:227], v[32:35], v[72:75], v[224:227]
    ds_read_b128 v[56:59], v2 offset:20480
    v_mfma_f32_16x16x32_bf16 v[240:243], v[32:35], v[76:79], v[240:243]
    ds_read_b128 v[60:63], v2 offset:22528
    v_mfma_f32_16x16x32_bf16 v[244:247], v[36:39], v[76:79], v[244:247]
    ds_read_b64_tr_b16 v[16:17], v4 offset:8192
    v_mfma_f32_16x16x32_bf16 v[228:231], v[36:39], v[72:75], v[228:231]
    ds_read_b64_tr_b16 v[18:19], v4 offset:9216
    v_mfma_f32_16x16x32_bf16 v[212:215], v[36:39], v[68:71], v[212:215]
    ds_read_b64_tr_b16 v[20:21], v5 offset:8192
    v_mfma_f32_16x16x32_bf16 v[196:199], v[36:39], v[64:67], v[196:199]
    ds_read_b64_tr_b16 v[22:23], v5 offset:9216
    v_mfma_f32_16x16x32_bf16 v[200:203], v[40:43], v[64:67], v[200:203]
    ds_read_b64_tr_b16 v[24:25], v112 offset:8192
    v_mfma_f32_16x16x32_bf16 v[216:219], v[40:43], v[68:71], v[216:219]
    ds_read_b64_tr_b16 v[26:27], v112 offset:9216
    v_mfma_f32_16x16x32_bf16 v[232:235], v[40:43], v[72:75], v[232:235]
    ds_read_b64_tr_b16 v[28:29], v113 offset:8192
    v_mfma_f32_16x16x32_bf16 v[248:251], v[40:43], v[76:79], v[248:251]
    ds_read_b64_tr_b16 v[30:31], v113 offset:9216
    v_mfma_f32_16x16x32_bf16 v[252:255], v[44:47], v[76:79], v[252:255]
    v_mfma_f32_16x16x32_bf16 v[236:239], v[44:47], v[72:75], v[236:239]
    v_mfma_f32_16x16x32_bf16 v[220:223], v[44:47], v[68:71], v[220:223]
    v_mfma_f32_16x16x32_bf16 v[204:207], v[44:47], v[64:67], v[204:207]
    s_waitcnt lgkmcnt(0)
    v_mfma_f32_16x16x32_bf16 v[128:131], v[16:19], v[48:51], v[128:131]
    ds_read_b64_tr_b16 v[32:33], v6 offset:8192
    v_mfma_f32_16x16x32_bf16 v[144:147], v[16:19], v[52:55], v[144:147]
    ds_read_b64_tr_b16 v[34:35], v6 offset:9216
    v_mfma_f32_16x16x32_bf16 v[160:163], v[16:19], v[56:59], v[160:163]
    ds_read_b64_tr_b16 v[36:37], v7 offset:8192
    v_mfma_f32_16x16x32_bf16 v[176:179], v[16:19], v[60:63], v[176:179]
    ds_read_b64_tr_b16 v[38:39], v7 offset:9216
    v_mfma_f32_16x16x32_bf16 v[180:183], v[20:23], v[60:63], v[180:183]
    ds_read_b64_tr_b16 v[40:41], v114 offset:8192
    v_mfma_f32_16x16x32_bf16 v[164:167], v[20:23], v[56:59], v[164:167]
    ds_read_b64_tr_b16 v[42:43], v114 offset:9216
    v_mfma_f32_16x16x32_bf16 v[148:151], v[20:23], v[52:55], v[148:151]
    ds_read_b64_tr_b16 v[44:45], v115 offset:8192
    v_mfma_f32_16x16x32_bf16 v[132:135], v[20:23], v[48:51], v[132:135]
    ds_read_b64_tr_b16 v[46:47], v115 offset:9216
    v_mfma_f32_16x16x32_bf16 v[136:139], v[24:27], v[48:51], v[136:139]
    v_mfma_f32_16x16x32_bf16 v[152:155], v[24:27], v[52:55], v[152:155]
    v_mfma_f32_16x16x32_bf16 v[168:171], v[24:27], v[56:59], v[168:171]
    v_mfma_f32_16x16x32_bf16 v[184:187], v[24:27], v[60:63], v[184:187]
    v_mfma_f32_16x16x32_bf16 v[188:191], v[28:31], v[60:63], v[188:191]
    v_mfma_f32_16x16x32_bf16 v[172:175], v[28:31], v[56:59], v[172:175]
    v_mfma_f32_16x16x32_bf16 v[156:159], v[28:31], v[52:55], v[156:159]
    v_mfma_f32_16x16x32_bf16 v[140:143], v[28:31], v[48:51], v[140:143]
    s_waitcnt lgkmcnt(0)
    v_mfma_f32_16x16x32_bf16 v[192:195], v[32:35], v[48:51], v[192:195]
    s_barrier
    ds_read_b128 v[64:67], v3 offset:16384
    v_mfma_f32_16x16x32_bf16 v[208:211], v[32:35], v[52:55], v[208:211]
    ds_read_b128 v[68:71], v3 offset:18432
    v_mfma_f32_16x16x32_bf16 v[224:227], v[32:35], v[56:59], v[224:227]
    ds_read_b128 v[72:75], v3 offset:20480
    v_mfma_f32_16x16x32_bf16 v[240:243], v[32:35], v[60:63], v[240:243]
    ds_read_b128 v[76:79], v3 offset:22528
    v_mfma_f32_16x16x32_bf16 v[244:247], v[36:39], v[60:63], v[244:247]
    ds_read_b64_tr_b16 v[16:17], v4 offset:16384
    v_mfma_f32_16x16x32_bf16 v[228:231], v[36:39], v[56:59], v[228:231]
    ds_read_b64_tr_b16 v[18:19], v4 offset:17408
    v_mfma_f32_16x16x32_bf16 v[212:215], v[36:39], v[52:55], v[212:215]
    ds_read_b64_tr_b16 v[20:21], v5 offset:16384
    v_mfma_f32_16x16x32_bf16 v[196:199], v[36:39], v[48:51], v[196:199]
    ds_read_b64_tr_b16 v[22:23], v5 offset:17408
    v_mfma_f32_16x16x32_bf16 v[200:203], v[40:43], v[48:51], v[200:203]
    ds_read_b64_tr_b16 v[24:25], v112 offset:16384
    v_mfma_f32_16x16x32_bf16 v[216:219], v[40:43], v[52:55], v[216:219]
    ds_read_b64_tr_b16 v[26:27], v112 offset:17408
    v_mfma_f32_16x16x32_bf16 v[232:235], v[40:43], v[56:59], v[232:235]
    ds_read_b64_tr_b16 v[28:29], v113 offset:16384
    v_mfma_f32_16x16x32_bf16 v[248:251], v[40:43], v[60:63], v[248:251]
    ds_read_b64_tr_b16 v[30:31], v113 offset:17408
    v_mfma_f32_16x16x32_bf16 v[252:255], v[44:47], v[60:63], v[252:255]
    v_mfma_f32_16x16x32_bf16 v[236:239], v[44:47], v[56:59], v[236:239]
    v_mfma_f32_16x16x32_bf16 v[220:223], v[44:47], v[52:55], v[220:223]
    v_mfma_f32_16x16x32_bf16 v[204:207], v[44:47], v[48:51], v[204:207]
    s_waitcnt lgkmcnt(0)
    v_mfma_f32_16x16x32_bf16 v[128:131], v[16:19], v[64:67], v[128:131]
    ds_read_b64_tr_b16 v[32:33], v6 offset:16384
    v_mfma_f32_16x16x32_bf16 v[144:147], v[16:19], v[68:71], v[144:147]
    ds_read_b64_tr_b16 v[34:35], v6 offset:17408
    v_mfma_f32_16x16x32_bf16 v[160:163], v[16:19], v[72:75], v[160:163]
    ds_read_b64_tr_b16 v[36:37], v7 offset:16384
    v_mfma_f32_16x16x32_bf16 v[176:179], v[16:19], v[76:79], v[176:179]
    ds_read_b64_tr_b16 v[38:39], v7 offset:17408
    v_mfma_f32_16x16x32_bf16 v[180:183], v[20:23], v[76:79], v[180:183]
    ds_read_b64_tr_b16 v[40:41], v114 offset:16384
    v_mfma_f32_16x16x32_bf16 v[164:167], v[20:23], v[72:75], v[164:167]
    ds_read_b64_tr_b16 v[42:43], v114 offset:17408
    v_mfma_f32_16x16x32_bf16 v[148:151], v[20:23], v[68:71], v[148:151]
    ds_read_b64_tr_b16 v[44:45], v115 offset:16384
    v_mfma_f32_16x16x32_bf16 v[132:135], v[20:23], v[64:67], v[132:135]
    ds_read_b64_tr_b16 v[46:47], v115 offset:17408
    v_mfma_f32_16x16x32_bf16 v[136:139], v[24:27], v[64:67], v[136:139]
    v_mfma_f32_16x16x32_bf16 v[152:155], v[24:27], v[68:71], v[152:155]
    v_mfma_f32_16x16x32_bf16 v[168:171], v[24:27], v[72:75], v[168:171]
    v_mfma_f32_16x16x32_bf16 v[184:187], v[24:27], v[76:79], v[184:187]
    v_mfma_f32_16x16x32_bf16 v[188:191], v[28:31], v[76:79], v[188:191]
    v_mfma_f32_16x16x32_bf16 v[172:175], v[28:31], v[72:75], v[172:175]
    v_mfma_f32_16x16x32_bf16 v[156:159], v[28:31], v[68:71], v[156:159]
    v_mfma_f32_16x16x32_bf16 v[140:143], v[28:31], v[64:67], v[140:143]
    s_waitcnt lgkmcnt(0)
    v_mfma_f32_16x16x32_bf16 v[192:195], v[32:35], v[64:67], v[192:195]
    s_barrier
    ds_read_b128 v[48:51], v2 offset:32768
    v_mfma_f32_16x16x32_bf16 v[208:211], v[32:35], v[68:71], v[208:211]
    ds_read_b128 v[52:55], v2 offset:34816
    v_mfma_f32_16x16x32_bf16 v[224:227], v[32:35], v[72:75], v[224:227]
    ds_read_b128 v[56:59], v2 offset:36864
    v_mfma_f32_16x16x32_bf16 v[240:243], v[32:35], v[76:79], v[240:243]
    ds_read_b128 v[60:63], v2 offset:38912
    v_mfma_f32_16x16x32_bf16 v[244:247], v[36:39], v[76:79], v[244:247]
    ds_read_b64_tr_b16 v[16:17], v4 offset:24576
    v_mfma_f32_16x16x32_bf16 v[228:231], v[36:39], v[72:75], v[228:231]
    ds_read_b64_tr_b16 v[18:19], v4 offset:25600
    v_mfma_f32_16x16x32_bf16 v[212:215], v[36:39], v[68:71], v[212:215]
    ds_read_b64_tr_b16 v[20:21], v5 offset:24576
    v_mfma_f32_16x16x32_bf16 v[196:199], v[36:39], v[64:67], v[196:199]
    ds_read_b64_tr_b16 v[22:23], v5 offset:25600
    v_mfma_f32_16x16x32_bf16 v[200:203], v[40:43], v[64:67], v[200:203]
    ds_read_b64_tr_b16 v[24:25], v112 offset:24576
    v_mfma_f32_16x16x32_bf16 v[216:219], v[40:43], v[68:71], v[216:219]
    ds_read_b64_tr_b16 v[26:27], v112 offset:25600
    v_mfma_f32_16x16x32_bf16 v[232:235], v[40:43], v[72:75], v[232:235]
    ds_read_b64_tr_b16 v[28:29], v113 offset:24576
    v_mfma_f32_16x16x32_bf16 v[248:251], v[40:43], v[76:79], v[248:251]
    ds_read_b64_tr_b16 v[30:31], v113 offset:25600
    v_mfma_f32_16x16x32_bf16 v[252:255], v[44:47], v[76:79], v[252:255]
    v_mfma_f32_16x16x32_bf16 v[236:239], v[44:47], v[72:75], v[236:239]
    v_mfma_f32_16x16x32_bf16 v[220:223], v[44:47], v[68:71], v[220:223]
    v_mfma_f32_16x16x32_bf16 v[204:207], v[44:47], v[64:67], v[204:207]
    s_waitcnt lgkmcnt(0)
    v_mfma_f32_16x16x32_bf16 v[128:131], v[16:19], v[48:51], v[128:131]
    ds_read_b64_tr_b16 v[32:33], v6 offset:24576
    v_mfma_f32_16x16x32_bf16 v[144:147], v[16:19], v[52:55], v[144:147]
    ds_read_b64_tr_b16 v[34:35], v6 offset:25600
    v_mfma_f32_16x16x32_bf16 v[160:163], v[16:19], v[56:59], v[160:163]
    ds_read_b64_tr_b16 v[36:37], v7 offset:24576
    v_mfma_f32_16x16x32_bf16 v[176:179], v[16:19], v[60:63], v[176:179]
    ds_read_b64_tr_b16 v[38:39], v7 offset:25600
    v_mfma_f32_16x16x32_bf16 v[180:183], v[20:23], v[60:63], v[180:183]
    ds_read_b64_tr_b16 v[40:41], v114 offset:24576
    v_mfma_f32_16x16x32_bf16 v[164:167], v[20:23], v[56:59], v[164:167]
    ds_read_b64_tr_b16 v[42:43], v114 offset:25600
    v_mfma_f32_16x16x32_bf16 v[148:151], v[20:23], v[52:55], v[148:151]
    ds_read_b64_tr_b16 v[44:45], v115 offset:24576
    v_mfma_f32_16x16x32_bf16 v[132:135], v[20:23], v[48:51], v[132:135]
    ds_read_b64_tr_b16 v[46:47], v115 offset:25600
    v_mfma_f32_16x16x32_bf16 v[136:139], v[24:27], v[48:51], v[136:139]
    v_mfma_f32_16x16x32_bf16 v[152:155], v[24:27], v[52:55], v[152:155]
    v_mfma_f32_16x16x32_bf16 v[168:171], v[24:27], v[56:59], v[168:171]
    v_mfma_f32_16x16x32_bf16 v[184:187], v[24:27], v[60:63], v[184:187]
    v_mfma_f32_16x16x32_bf16 v[188:191], v[28:31], v[60:63], v[188:191]
    v_mfma_f32_16x16x32_bf16 v[172:175], v[28:31], v[56:59], v[172:175]
    v_mfma_f32_16x16x32_bf16 v[156:159], v[28:31], v[52:55], v[156:159]
    v_mfma_f32_16x16x32_bf16 v[140:143], v[28:31], v[48:51], v[140:143]
    s_waitcnt lgkmcnt(0)
    v_mfma_f32_16x16x32_bf16 v[192:195], v[32:35], v[48:51], v[192:195]
    s_barrier
    ds_read_b128 v[64:67], v3 offset:32768
    v_mfma_f32_16x16x32_bf16 v[208:211], v[32:35], v[52:55], v[208:211]
    ds_read_b128 v[68:71], v3 offset:34816
    v_mfma_f32_16x16x32_bf16 v[224:227], v[32:35], v[56:59], v[224:227]
    ds_read_b128 v[72:75], v3 offset:36864
    v_mfma_f32_16x16x32_bf16 v[240:243], v[32:35], v[60:63], v[240:243]
    ds_read_b128 v[76:79], v3 offset:38912
    v_mfma_f32_16x16x32_bf16 v[244:247], v[36:39], v[60:63], v[244:247]
    ds_read_b64_tr_b16 v[16:17], v4 offset:32768
    v_mfma_f32_16x16x32_bf16 v[228:231], v[36:39], v[56:59], v[228:231]
    ds_read_b64_tr_b16 v[18:19], v4 offset:33792
    v_mfma_f32_16x16x32_bf16 v[212:215], v[36:39], v[52:55], v[212:215]
    ds_read_b64_tr_b16 v[20:21], v5 offset:32768
    v_mfma_f32_16x16x32_bf16 v[196:199], v[36:39], v[48:51], v[196:199]
    ds_read_b64_tr_b16 v[22:23], v5 offset:33792
    v_mfma_f32_16x16x32_bf16 v[200:203], v[40:43], v[48:51], v[200:203]
    ds_read_b64_tr_b16 v[24:25], v112 offset:32768
    v_mfma_f32_16x16x32_bf16 v[216:219], v[40:43], v[52:55], v[216:219]
    ds_read_b64_tr_b16 v[26:27], v112 offset:33792
    v_mfma_f32_16x16x32_bf16 v[232:235], v[40:43], v[56:59], v[232:235]
    ds_read_b64_tr_b16 v[28:29], v113 offset:32768
    v_mfma_f32_16x16x32_bf16 v[248:251], v[40:43], v[60:63], v[248:251]
    ds_read_b64_tr_b16 v[30:31], v113 offset:33792
    v_mfma_f32_16x16x32_bf16 v[252:255], v[44:47], v[60:63], v[252:255]
    v_mfma_f32_16x16x32_bf16 v[236:239], v[44:47], v[56:59], v[236:239]
    v_mfma_f32_16x16x32_bf16 v[220:223], v[44:47], v[52:55], v[220:223]
    v_mfma_f32_16x16x32_bf16 v[204:207], v[44:47], v[48:51], v[204:207]
    s_waitcnt lgkmcnt(0)
    v_mfma_f32_16x16x32_bf16 v[128:131], v[16:19], v[64:67], v[128:131]
    ds_read_b64_tr_b16 v[32:33], v6 offset:32768
    v_mfma_f32_16x16x32_bf16 v[144:147], v[16:19], v[68:71], v[144:147]
    ds_read_b64_tr_b16 v[34:35], v6 offset:33792
    v_mfma_f32_16x16x32_bf16 v[160:163], v[16:19], v[72:75], v[160:163]
    ds_read_b64_tr_b16 v[36:37], v7 offset:32768
    v_mfma_f32_16x16x32_bf16 v[176:179], v[16:19], v[76:79], v[176:179]
    ds_read_b64_tr_b16 v[38:39], v7 offset:33792
    v_mfma_f32_16x16x32_bf16 v[180:183], v[20:23], v[76:79], v[180:183]
    ds_read_b64_tr_b16 v[40:41], v114 offset:32768
    v_mfma_f32_16x16x32_bf16 v[164:167], v[20:23], v[72:75], v[164:167]
    ds_read_b64_tr_b16 v[42:43], v114 offset:33792
    v_mfma_f32_16x16x32_bf16 v[148:151], v[20:23], v[68:71], v[148:151]
    ds_read_b64_tr_b16 v[44:45], v115 offset:32768
    v_mfma_f32_16x16x32_bf16 v[132:135], v[20:23], v[64:67], v[132:135]
    ds_read_b64_tr_b16 v[46:47], v115 offset:33792
    v_mfma_f32_16x16x32_bf16 v[136:139], v[24:27], v[64:67], v[136:139]
    v_mfma_f32_16x16x32_bf16 v[152:155], v[24:27], v[68:71], v[152:155]
    v_mfma_f32_16x16x32_bf16 v[168:171], v[24:27], v[72:75], v[168:171]
    v_mfma_f32_16x16x32_bf16 v[184:187], v[24:27], v[76:79], v[184:187]
    v_mfma_f32_16x16x32_bf16 v[188:191], v[28:31], v[76:79], v[188:191]
    v_mfma_f32_16x16x32_bf16 v[172:175], v[28:31], v[72:75], v[172:175]
    v_mfma_f32_16x16x32_bf16 v[156:159], v[28:31], v[68:71], v[156:159]
    v_mfma_f32_16x16x32_bf16 v[140:143], v[28:31], v[64:67], v[140:143]
    s_waitcnt lgkmcnt(0)
    v_mfma_f32_16x16x32_bf16 v[192:195], v[32:35], v[64:67], v[192:195]
    s_barrier
    ds_read_b128 v[48:51], v2 offset:49152
    v_mfma_f32_16x16x32_bf16 v[208:211], v[32:35], v[68:71], v[208:211]
    ds_read_b128 v[52:55], v2 offset:51200
    v_mfma_f32_16x16x32_bf16 v[224:227], v[32:35], v[72:75], v[224:227]
    ds_read_b128 v[56:59], v2 offset:53248
    v_mfma_f32_16x16x32_bf16 v[240:243], v[32:35], v[76:79], v[240:243]
    ds_read_b128 v[60:63], v2 offset:55296
    v_mfma_f32_16x16x32_bf16 v[244:247], v[36:39], v[76:79], v[244:247]
    ds_read_b64_tr_b16 v[16:17], v4 offset:0
    v_mfma_f32_16x16x32_bf16 v[228:231], v[36:39], v[72:75], v[228:231]
    ds_read_b64_tr_b16 v[18:19], v4 offset:1024
    v_mfma_f32_16x16x32_bf16 v[212:215], v[36:39], v[68:71], v[212:215]
    ds_read_b64_tr_b16 v[20:21], v5 offset:0
    v_mfma_f32_16x16x32_bf16 v[196:199], v[36:39], v[64:67], v[196:199]
    ds_read_b64_tr_b16 v[22:23], v5 offset:1024
    v_mfma_f32_16x16x32_bf16 v[200:203], v[40:43], v[64:67], v[200:203]
    ds_read_b64_tr_b16 v[24:25], v112 offset:0
    v_mfma_f32_16x16x32_bf16 v[216:219], v[40:43], v[68:71], v[216:219]
    ds_read_b64_tr_b16 v[26:27], v112 offset:1024
    v_mfma_f32_16x16x32_bf16 v[232:235], v[40:43], v[72:75], v[232:235]
    ds_read_b64_tr_b16 v[28:29], v113 offset:0
    v_mfma_f32_16x16x32_bf16 v[248:251], v[40:43], v[76:79], v[248:251]
    ds_read_b64_tr_b16 v[30:31], v113 offset:1024
    v_mfma_f32_16x16x32_bf16 v[252:255], v[44:47], v[76:79], v[252:255]
    v_mfma_f32_16x16x32_bf16 v[236:239], v[44:47], v[72:75], v[236:239]
    v_mfma_f32_16x16x32_bf16 v[220:223], v[44:47], v[68:71], v[220:223]
    v_mfma_f32_16x16x32_bf16 v[204:207], v[44:47], v[64:67], v[204:207]
    s_waitcnt lgkmcnt(0)
    v_mfma_f32_16x16x32_bf16 v[128:131], v[16:19], v[48:51], v[128:131]
    ds_read_b64_tr_b16 v[32:33], v6 offset:0
    v_mfma_f32_16x16x32_bf16 v[144:147], v[16:19], v[52:55], v[144:147]
    ds_read_b64_tr_b16 v[34:35], v6 offset:1024
    v_mfma_f32_16x16x32_bf16 v[160:163], v[16:19], v[56:59], v[160:163]
    ds_read_b64_tr_b16 v[36:37], v7 offset:0
    v_mfma_f32_16x16x32_bf16 v[176:179], v[16:19], v[60:63], v[176:179]
    ds_read_b64_tr_b16 v[38:39], v7 offset:1024
    v_mfma_f32_16x16x32_bf16 v[180:183], v[20:23], v[60:63], v[180:183]
    ds_read_b64_tr_b16 v[40:41], v114 offset:0
    v_mfma_f32_16x16x32_bf16 v[164:167], v[20:23], v[56:59], v[164:167]
    ds_read_b64_tr_b16 v[42:43], v114 offset:1024
    v_mfma_f32_16x16x32_bf16 v[148:151], v[20:23], v[52:55], v[148:151]
    ds_read_b64_tr_b16 v[44:45], v115 offset:0
    v_mfma_f32_16x16x32_bf16 v[132:135], v[20:23], v[48:51], v[132:135]
    ds_read_b64_tr_b16 v[46:47], v115 offset:1024
    v_mfma_f32_16x16x32_bf16 v[136:139], v[24:27], v[48:51], v[136:139]
    v_mfma_f32_16x16x32_bf16 v[152:155], v[24:27], v[52:55], v[152:155]
    v_mfma_f32_16x16x32_bf16 v[168:171], v[24:27], v[56:59], v[168:171]
    v_mfma_f32_16x16x32_bf16 v[184:187], v[24:27], v[60:63], v[184:187]
    v_mfma_f32_16x16x32_bf16 v[188:191], v[28:31], v[60:63], v[188:191]
    v_mfma_f32_16x16x32_bf16 v[172:175], v[28:31], v[56:59], v[172:175]
    v_mfma_f32_16x16x32_bf16 v[156:159], v[28:31], v[52:55], v[156:159]
    v_mfma_f32_16x16x32_bf16 v[140:143], v[28:31], v[48:51], v[140:143]
    s_waitcnt lgkmcnt(0)
    v_mfma_f32_16x16x32_bf16 v[192:195], v[32:35], v[48:51], v[192:195]
    s_barrier
    ds_read_b128 v[64:67], v3 offset:49152
    v_mfma_f32_16x16x32_bf16 v[208:211], v[32:35], v[52:55], v[208:211]
    ds_read_b128 v[68:71], v3 offset:51200
    v_mfma_f32_16x16x32_bf16 v[224:227], v[32:35], v[56:59], v[224:227]
    ds_read_b128 v[72:75], v3 offset:53248
    v_mfma_f32_16x16x32_bf16 v[240:243], v[32:35], v[60:63], v[240:243]
    ds_read_b128 v[76:79], v3 offset:55296
    v_mfma_f32_16x16x32_bf16 v[244:247], v[36:39], v[60:63], v[244:247]
    ds_read_b64_tr_b16 v[16:17], v4 offset:8192
    v_mfma_f32_16x16x32_bf16 v[228:231], v[36:39], v[56:59], v[228:231]
    ds_read_b64_tr_b16 v[18:19], v4 offset:9216
    v_mfma_f32_16x16x32_bf16 v[212:215], v[36:39], v[52:55], v[212:215]
    ds_read_b64_tr_b16 v[20:21], v5 offset:8192
    v_mfma_f32_16x16x32_bf16 v[196:199], v[36:39], v[48:51], v[196:199]
    ds_read_b64_tr_b16 v[22:23], v5 offset:9216
    v_mfma_f32_16x16x32_bf16 v[200:203], v[40:43], v[48:51], v[200:203]
    ds_read_b64_tr_b16 v[24:25], v112 offset:8192
    v_mfma_f32_16x16x32_bf16 v[216:219], v[40:43], v[52:55], v[216:219]
    ds_read_b64_tr_b16 v[26:27], v112 offset:9216
    v_mfma_f32_16x16x32_bf16 v[232:235], v[40:43], v[56:59], v[232:235]
    ds_read_b64_tr_b16 v[28:29], v113 offset:8192
    v_mfma_f32_16x16x32_bf16 v[248:251], v[40:43], v[60:63], v[248:251]
    ds_read_b64_tr_b16 v[30:31], v113 offset:9216
    v_mfma_f32_16x16x32_bf16 v[252:255], v[44:47], v[60:63], v[252:255]
    v_mfma_f32_16x16x32_bf16 v[236:239], v[44:47], v[56:59], v[236:239]
    v_mfma_f32_16x16x32_bf16 v[220:223], v[44:47], v[52:55], v[220:223]
    v_mfma_f32_16x16x32_bf16 v[204:207], v[44:47], v[48:51], v[204:207]
    s_waitcnt lgkmcnt(0)
    v_mfma_f32_16x16x32_bf16 v[128:131], v[16:19], v[64:67], v[128:131]
    ds_read_b64_tr_b16 v[32:33], v6 offset:8192
    v_mfma_f32_16x16x32_bf16 v[144:147], v[16:19], v[68:71], v[144:147]
    ds_read_b64_tr_b16 v[34:35], v6 offset:9216
    v_mfma_f32_16x16x32_bf16 v[160:163], v[16:19], v[72:75], v[160:163]
    ds_read_b64_tr_b16 v[36:37], v7 offset:8192
    v_mfma_f32_16x16x32_bf16 v[176:179], v[16:19], v[76:79], v[176:179]
    ds_read_b64_tr_b16 v[38:39], v7 offset:9216
    v_mfma_f32_16x16x32_bf16 v[180:183], v[20:23], v[76:79], v[180:183]
    ds_read_b64_tr_b16 v[40:41], v114 offset:8192
    v_mfma_f32_16x16x32_bf16 v[164:167], v[20:23], v[72:75], v[164:167]
    ds_read_b64_tr_b16 v[42:43], v114 offset:9216
    v_mfma_f32_16x16x32_bf16 v[148:151], v[20:23], v[68:71], v[148:151]
    ds_read_b64_tr_b16 v[44:45], v115 offset:8192
    v_mfma_f32_16x16x32_bf16 v[132:135], v[20:23], v[64:67], v[132:135]
    ds_read_b64_tr_b16 v[46:47], v115 offset:9216
    v_mfma_f32_16x16x32_bf16 v[136:139], v[24:27], v[64:67], v[136:139]
    v_mfma_f32_16x16x32_bf16 v[152:155], v[24:27], v[68:71], v[152:155]
    v_mfma_f32_16x16x32_bf16 v[168:171], v[24:27], v[72:75], v[168:171]
    v_mfma_f32_16x16x32_bf16 v[184:187], v[24:27], v[76:79], v[184:187]
    v_mfma_f32_16x16x32_bf16 v[188:191], v[28:31], v[76:79], v[188:191]
    v_mfma_f32_16x16x32_bf16 v[172:175], v[28:31], v[72:75], v[172:175]
    v_mfma_f32_16x16x32_bf16 v[156:159], v[28:31], v[68:71], v[156:159]
    v_mfma_f32_16x16x32_bf16 v[140:143], v[28:31], v[64:67], v[140:143]
    s_waitcnt lgkmcnt(0)
    v_mfma_f32_16x16x32_bf16 v[192:195], v[32:35], v[64:67], v[192:195]
    s_barrier
    ds_read_b128 v[48:51], v2 offset:0
    v_mfma_f32_16x16x32_bf16 v[208:211], v[32:35], v[68:71], v[208:211]
    ds_read_b128 v[52:55], v2 offset:2048
    v_mfma_f32_16x16x32_bf16 v[224:227], v[32:35], v[72:75], v[224:227]
    ds_read_b128 v[56:59], v2 offset:4096
    v_mfma_f32_16x16x32_bf16 v[240:243], v[32:35], v[76:79], v[240:243]
    ds_read_b128 v[60:63], v2 offset:6144
    v_mfma_f32_16x16x32_bf16 v[244:247], v[36:39], v[76:79], v[244:247]
    ds_read_b64_tr_b16 v[16:17], v4 offset:16384
    v_mfma_f32_16x16x32_bf16 v[228:231], v[36:39], v[72:75], v[228:231]
    ds_read_b64_tr_b16 v[18:19], v4 offset:17408
    v_mfma_f32_16x16x32_bf16 v[212:215], v[36:39], v[68:71], v[212:215]
    ds_read_b64_tr_b16 v[20:21], v5 offset:16384
    v_mfma_f32_16x16x32_bf16 v[196:199], v[36:39], v[64:67], v[196:199]
    ds_read_b64_tr_b16 v[22:23], v5 offset:17408
    v_mfma_f32_16x16x32_bf16 v[200:203], v[40:43], v[64:67], v[200:203]
    ds_read_b64_tr_b16 v[24:25], v112 offset:16384
    v_mfma_f32_16x16x32_bf16 v[216:219], v[40:43], v[68:71], v[216:219]
    ds_read_b64_tr_b16 v[26:27], v112 offset:17408
    v_mfma_f32_16x16x32_bf16 v[232:235], v[40:43], v[72:75], v[232:235]
    ds_read_b64_tr_b16 v[28:29], v113 offset:16384
    v_mfma_f32_16x16x32_bf16 v[248:251], v[40:43], v[76:79], v[248:251]
    ds_read_b64_tr_b16 v[30:31], v113 offset:17408
    v_mfma_f32_16x16x32_bf16 v[252:255], v[44:47], v[76:79], v[252:255]
    v_mfma_f32_16x16x32_bf16 v[236:239], v[44:47], v[72:75], v[236:239]
    v_mfma_f32_16x16x32_bf16 v[220:223], v[44:47], v[68:71], v[220:223]
    v_mfma_f32_16x16x32_bf16 v[204:207], v[44:47], v[64:67], v[204:207]
    s_waitcnt lgkmcnt(0)
    v_mfma_f32_16x16x32_bf16 v[128:131], v[16:19], v[48:51], v[128:131]
    ds_read_b64_tr_b16 v[32:33], v6 offset:16384
    v_mfma_f32_16x16x32_bf16 v[144:147], v[16:19], v[52:55], v[144:147]
    ds_read_b64_tr_b16 v[34:35], v6 offset:17408
    v_mfma_f32_16x16x32_bf16 v[160:163], v[16:19], v[56:59], v[160:163]
    ds_read_b64_tr_b16 v[36:37], v7 offset:16384
    v_mfma_f32_16x16x32_bf16 v[176:179], v[16:19], v[60:63], v[176:179]
    ds_read_b64_tr_b16 v[38:39], v7 offset:17408
    v_mfma_f32_16x16x32_bf16 v[180:183], v[20:23], v[60:63], v[180:183]
    ds_read_b64_tr_b16 v[40:41], v114 offset:16384
    v_mfma_f32_16x16x32_bf16 v[164:167], v[20:23], v[56:59], v[164:167]
    ds_read_b64_tr_b16 v[42:43], v114 offset:17408
    v_mfma_f32_16x16x32_bf16 v[148:151], v[20:23], v[52:55], v[148:151]
    ds_read_b64_tr_b16 v[44:45], v115 offset:16384
    v_mfma_f32_16x16x32_bf16 v[132:135], v[20:23], v[48:51], v[132:135]
    ds_read_b64_tr_b16 v[46:47], v115 offset:17408
    v_mfma_f32_16x16x32_bf16 v[136:139], v[24:27], v[48:51], v[136:139]
    v_mfma_f32_16x16x32_bf16 v[152:155], v[24:27], v[52:55], v[152:155]
    v_mfma_f32_16x16x32_bf16 v[168:171], v[24:27], v[56:59], v[168:171]
    v_mfma_f32_16x16x32_bf16 v[184:187], v[24:27], v[60:63], v[184:187]
    v_mfma_f32_16x16x32_bf16 v[188:191], v[28:31], v[60:63], v[188:191]
    v_mfma_f32_16x16x32_bf16 v[172:175], v[28:31], v[56:59], v[172:175]
    v_mfma_f32_16x16x32_bf16 v[156:159], v[28:31], v[52:55], v[156:159]
    v_mfma_f32_16x16x32_bf16 v[140:143], v[28:31], v[48:51], v[140:143]
    s_waitcnt lgkmcnt(0)
    v_mfma_f32_16x16x32_bf16 v[192:195], v[32:35], v[48:51], v[192:195]
    s_barrier
    ds_read_b128 v[64:67], v3 offset:0
    v_mfma_f32_16x16x32_bf16 v[208:211], v[32:35], v[52:55], v[208:211]
    ds_read_b128 v[68:71], v3 offset:2048
    v_mfma_f32_16x16x32_bf16 v[224:227], v[32:35], v[56:59], v[224:227]
    ds_read_b128 v[72:75], v3 offset:4096
    v_mfma_f32_16x16x32_bf16 v[240:243], v[32:35], v[60:63], v[240:243]
    ds_read_b128 v[76:79], v3 offset:6144
    v_mfma_f32_16x16x32_bf16 v[244:247], v[36:39], v[60:63], v[244:247]
    ds_read_b64_tr_b16 v[16:17], v4 offset:24576
    v_mfma_f32_16x16x32_bf16 v[228:231], v[36:39], v[56:59], v[228:231]
    ds_read_b64_tr_b16 v[18:19], v4 offset:25600
    v_mfma_f32_16x16x32_bf16 v[212:215], v[36:39], v[52:55], v[212:215]
    ds_read_b64_tr_b16 v[20:21], v5 offset:24576
    v_mfma_f32_16x16x32_bf16 v[196:199], v[36:39], v[48:51], v[196:199]
    ds_read_b64_tr_b16 v[22:23], v5 offset:25600
    v_mfma_f32_16x16x32_bf16 v[200:203], v[40:43], v[48:51], v[200:203]
    ds_read_b64_tr_b16 v[24:25], v112 offset:24576
    v_mfma_f32_16x16x32_bf16 v[216:219], v[40:43], v[52:55], v[216:219]
    ds_read_b64_tr_b16 v[26:27], v112 offset:25600
    v_mfma_f32_16x16x32_bf16 v[232:235], v[40:43], v[56:59], v[232:235]
    ds_read_b64_tr_b16 v[28:29], v113 offset:24576
    v_mfma_f32_16x16x32_bf16 v[248:251], v[40:43], v[60:63], v[248:251]
    ds_read_b64_tr_b16 v[30:31], v113 offset:25600
    v_mfma_f32_16x16x32_bf16 v[252:255], v[44:47], v[60:63], v[252:255]
    v_mfma_f32_16x16x32_bf16 v[236:239], v[44:47], v[56:59], v[236:239]
    v_mfma_f32_16x16x32_bf16 v[220:223], v[44:47], v[52:55], v[220:223]
    v_mfma_f32_16x16x32_bf16 v[204:207], v[44:47], v[48:51], v[204:207]
    s_waitcnt lgkmcnt(0)
    v_mfma_f32_16x16x32_bf16 v[128:131], v[16:19], v[64:67], v[128:131]
    ds_read_b64_tr_b16 v[32:33], v6 offset:24576
    v_mfma_f32_16x16x32_bf16 v[144:147], v[16:19], v[68:71], v[144:147]
    ds_read_b64_tr_b16 v[34:35], v6 offset:25600
    v_mfma_f32_16x16x32_bf16 v[160:163], v[16:19], v[72:75], v[160:163]
    ds_read_b64_tr_b16 v[36:37], v7 offset:24576
    v_mfma_f32_16x16x32_bf16 v[176:179], v[16:19], v[76:79], v[176:179]
    ds_read_b64_tr_b16 v[38:39], v7 offset:25600
    v_mfma_f32_16x16x32_bf16 v[180:183], v[20:23], v[76:79], v[180:183]
    ds_read_b64_tr_b16 v[40:41], v114 offset:24576
    v_mfma_f32_16x16x32_bf16 v[164:167], v[20:23], v[72:75], v[164:167]
    ds_read_b64_tr_b16 v[42:43], v114 offset:25600
    v_mfma_f32_16x16x32_bf16 v[148:151], v[20:23], v[68:71], v[148:151]
    ds_read_b64_tr_b16 v[44:45], v115 offset:24576
    v_mfma_f32_16x16x32_bf16 v[132:135], v[20:23], v[64:67], v[132:135]
    ds_read_b64_tr_b16 v[46:47], v115 offset:25600
    v_mfma_f32_16x16x32_bf16 v[136:139], v[24:27], v[64:67], v[136:139]
    v_mfma_f32_16x16x32_bf16 v[152:155], v[24:27], v[68:71], v[152:155]
    v_mfma_f32_16x16x32_bf16 v[168:171], v[24:27], v[72:75], v[168:171]
    v_mfma_f32_16x16x32_bf16 v[184:187], v[24:27], v[76:79], v[184:187]
    v_mfma_f32_16x16x32_bf16 v[188:191], v[28:31], v[76:79], v[188:191]
    v_mfma_f32_16x16x32_bf16 v[172:175], v[28:31], v[72:75], v[172:175]
    v_mfma_f32_16x16x32_bf16 v[156:159], v[28:31], v[68:71], v[156:159]
    v_mfma_f32_16x16x32_bf16 v[140:143], v[28:31], v[64:67], v[140:143]
    s_waitcnt lgkmcnt(0)
    v_mfma_f32_16x16x32_bf16 v[192:195], v[32:35], v[64:67], v[192:195]
    s_barrier
    ds_read_b128 v[48:51], v2 offset:16384
    v_mfma_f32_16x16x32_bf16 v[208:211], v[32:35], v[68:71], v[208:211]
    ds_read_b128 v[52:55], v2 offset:18432
    v_mfma_f32_16x16x32_bf16 v[224:227], v[32:35], v[72:75], v[224:227]
    ds_read_b128 v[56:59], v2 offset:20480
    v_mfma_f32_16x16x32_bf16 v[240:243], v[32:35], v[76:79], v[240:243]
    ds_read_b128 v[60:63], v2 offset:22528
    v_mfma_f32_16x16x32_bf16 v[244:247], v[36:39], v[76:79], v[244:247]
    ds_read_b64_tr_b16 v[16:17], v4 offset:32768
    v_mfma_f32_16x16x32_bf16 v[228:231], v[36:39], v[72:75], v[228:231]
    ds_read_b64_tr_b16 v[18:19], v4 offset:33792
    v_mfma_f32_16x16x32_bf16 v[212:215], v[36:39], v[68:71], v[212:215]
    ds_read_b64_tr_b16 v[20:21], v5 offset:32768
    v_mfma_f32_16x16x32_bf16 v[196:199], v[36:39], v[64:67], v[196:199]
    ds_read_b64_tr_b16 v[22:23], v5 offset:33792
    v_mfma_f32_16x16x32_bf16 v[200:203], v[40:43], v[64:67], v[200:203]
    ds_read_b64_tr_b16 v[24:25], v112 offset:32768
    v_mfma_f32_16x16x32_bf16 v[216:219], v[40:43], v[68:71], v[216:219]
    ds_read_b64_tr_b16 v[26:27], v112 offset:33792
    v_mfma_f32_16x16x32_bf16 v[232:235], v[40:43], v[72:75], v[232:235]
    ds_read_b64_tr_b16 v[28:29], v113 offset:32768
    v_mfma_f32_16x16x32_bf16 v[248:251], v[40:43], v[76:79], v[248:251]
    ds_read_b64_tr_b16 v[30:31], v113 offset:33792
    v_mfma_f32_16x16x32_bf16 v[252:255], v[44:47], v[76:79], v[252:255]
    v_mfma_f32_16x16x32_bf16 v[236:239], v[44:47], v[72:75], v[236:239]
    v_mfma_f32_16x16x32_bf16 v[220:223], v[44:47], v[68:71], v[220:223]
    v_mfma_f32_16x16x32_bf16 v[204:207], v[44:47], v[64:67], v[204:207]
    s_waitcnt vmcnt(0) lgkmcnt(0)
    v_mfma_f32_16x16x32_bf16 v[128:131], v[16:19], v[48:51], v[128:131]
    ds_read_b64_tr_b16 v[32:33], v6 offset:32768
    v_mfma_f32_16x16x32_bf16 v[144:147], v[16:19], v[52:55], v[144:147]
    ds_read_b64_tr_b16 v[34:35], v6 offset:33792
    v_mfma_f32_16x16x32_bf16 v[160:163], v[16:19], v[56:59], v[160:163]
    ds_read_b64_tr_b16 v[36:37], v7 offset:32768
    v_mfma_f32_16x16x32_bf16 v[176:179], v[16:19], v[60:63], v[176:179]
    ds_read_b64_tr_b16 v[38:39], v7 offset:33792
    v_mfma_f32_16x16x32_bf16 v[180:183], v[20:23], v[60:63], v[180:183]
    ds_read_b64_tr_b16 v[40:41], v114 offset:32768
    v_mfma_f32_16x16x32_bf16 v[164:167], v[20:23], v[56:59], v[164:167]
    ds_read_b64_tr_b16 v[42:43], v114 offset:33792
    v_mfma_f32_16x16x32_bf16 v[148:151], v[20:23], v[52:55], v[148:151]
    ds_read_b64_tr_b16 v[44:45], v115 offset:32768
    v_mfma_f32_16x16x32_bf16 v[132:135], v[20:23], v[48:51], v[132:135]
    ds_read_b64_tr_b16 v[46:47], v115 offset:33792
    v_mfma_f32_16x16x32_bf16 v[136:139], v[24:27], v[48:51], v[136:139]
    v_mfma_f32_16x16x32_bf16 v[152:155], v[24:27], v[52:55], v[152:155]
    v_mfma_f32_16x16x32_bf16 v[168:171], v[24:27], v[56:59], v[168:171]
    v_mfma_f32_16x16x32_bf16 v[184:187], v[24:27], v[60:63], v[184:187]
    v_mfma_f32_16x16x32_bf16 v[188:191], v[28:31], v[60:63], v[188:191]
    v_mfma_f32_16x16x32_bf16 v[172:175], v[28:31], v[56:59], v[172:175]
    v_mfma_f32_16x16x32_bf16 v[156:159], v[28:31], v[52:55], v[156:159]
    v_mfma_f32_16x16x32_bf16 v[140:143], v[28:31], v[48:51], v[140:143]
    s_waitcnt lgkmcnt(0)
    v_mfma_f32_16x16x32_bf16 v[192:195], v[32:35], v[48:51], v[192:195]
    s_barrier
    ds_read_b128 v[64:67], v3 offset:16384
    v_mfma_f32_16x16x32_bf16 v[208:211], v[32:35], v[52:55], v[208:211]
    ds_read_b128 v[68:71], v3 offset:18432
    v_mfma_f32_16x16x32_bf16 v[224:227], v[32:35], v[56:59], v[224:227]
    ds_read_b128 v[72:75], v3 offset:20480
    v_mfma_f32_16x16x32_bf16 v[240:243], v[32:35], v[60:63], v[240:243]
    ds_read_b128 v[76:79], v3 offset:22528
    v_mfma_f32_16x16x32_bf16 v[244:247], v[36:39], v[60:63], v[244:247]
    ds_read_b64_tr_b16 v[16:17], v4 offset:0
    v_mfma_f32_16x16x32_bf16 v[228:231], v[36:39], v[56:59], v[228:231]
    ds_read_b64_tr_b16 v[18:19], v4 offset:1024
    v_mfma_f32_16x16x32_bf16 v[212:215], v[36:39], v[52:55], v[212:215]
    ds_read_b64_tr_b16 v[20:21], v5 offset:0
    v_mfma_f32_16x16x32_bf16 v[196:199], v[36:39], v[48:51], v[196:199]
    ds_read_b64_tr_b16 v[22:23], v5 offset:1024
    v_mfma_f32_16x16x32_bf16 v[200:203], v[40:43], v[48:51], v[200:203]
    ds_read_b64_tr_b16 v[24:25], v112 offset:0
    v_mfma_f32_16x16x32_bf16 v[216:219], v[40:43], v[52:55], v[216:219]
    ds_read_b64_tr_b16 v[26:27], v112 offset:1024
    v_mfma_f32_16x16x32_bf16 v[232:235], v[40:43], v[56:59], v[232:235]
    ds_read_b64_tr_b16 v[28:29], v113 offset:0
    v_mfma_f32_16x16x32_bf16 v[248:251], v[40:43], v[60:63], v[248:251]
    ds_read_b64_tr_b16 v[30:31], v113 offset:1024
    v_mfma_f32_16x16x32_bf16 v[252:255], v[44:47], v[60:63], v[252:255]
    v_mfma_f32_16x16x32_bf16 v[236:239], v[44:47], v[56:59], v[236:239]
    v_mfma_f32_16x16x32_bf16 v[220:223], v[44:47], v[52:55], v[220:223]
    v_mfma_f32_16x16x32_bf16 v[204:207], v[44:47], v[48:51], v[204:207]
    s_waitcnt lgkmcnt(0)
    v_mfma_f32_16x16x32_bf16 v[128:131], v[16:19], v[64:67], v[128:131]
    ds_read_b64_tr_b16 v[32:33], v6 offset:0
    v_mfma_f32_16x16x32_bf16 v[144:147], v[16:19], v[68:71], v[144:147]
    ds_read_b64_tr_b16 v[34:35], v6 offset:1024
    v_mfma_f32_16x16x32_bf16 v[160:163], v[16:19], v[72:75], v[160:163]
    ds_read_b64_tr_b16 v[36:37], v7 offset:0
    v_mfma_f32_16x16x32_bf16 v[176:179], v[16:19], v[76:79], v[176:179]
    ds_read_b64_tr_b16 v[38:39], v7 offset:1024
    v_mfma_f32_16x16x32_bf16 v[180:183], v[20:23], v[76:79], v[180:183]
    ds_read_b64_tr_b16 v[40:41], v114 offset:0
    v_mfma_f32_16x16x32_bf16 v[164:167], v[20:23], v[72:75], v[164:167]
    ds_read_b64_tr_b16 v[42:43], v114 offset:1024
    v_mfma_f32_16x16x32_bf16 v[148:151], v[20:23], v[68:71], v[148:151]
    ds_read_b64_tr_b16 v[44:45], v115 offset:0
    v_mfma_f32_16x16x32_bf16 v[132:135], v[20:23], v[64:67], v[132:135]
    ds_read_b64_tr_b16 v[46:47], v115 offset:1024
    v_mfma_f32_16x16x32_bf16 v[136:139], v[24:27], v[64:67], v[136:139]
    v_mfma_f32_16x16x32_bf16 v[152:155], v[24:27], v[68:71], v[152:155]
    v_mfma_f32_16x16x32_bf16 v[168:171], v[24:27], v[72:75], v[168:171]
    v_mfma_f32_16x16x32_bf16 v[184:187], v[24:27], v[76:79], v[184:187]
    v_mfma_f32_16x16x32_bf16 v[188:191], v[28:31], v[76:79], v[188:191]
    s_branch Lw1o
Lw1:
    s_branch Lw1r
Lw1o:
    v_mfma_f32_16x16x32_bf16 v[172:175], v[28:31], v[72:75], v[172:175]
    v_mfma_f32_16x16x32_bf16 v[156:159], v[28:31], v[68:71], v[156:159]
    v_mfma_f32_16x16x32_bf16 v[140:143], v[28:31], v[64:67], v[140:143]
    s_waitcnt lgkmcnt(0)
    v_mfma_f32_16x16x32_bf16 v[192:195], v[32:35], v[64:67], v[192:195]
    s_barrier
    ds_read_b64 v[80:81], v9 offset:0
    ds_read_b64 v[82:83], v9 offset:128
    v_mfma_f32_16x16x32_bf16 v[208:211], v[32:35], v[68:71], v[208:211]
    ds_read_b64 v[84:85], v9 offset:256
    ds_read_b64 v[86:87], v9 offset:384
    v_mfma_f32_16x16x32_bf16 v[224:227], v[32:35], v[72:75], v[224:227]
    ds_read_b64 v[12:13], v121
    ds_read_b64_tr_b16 v[16:17], v116 offset:0
    v_mfma_f32_16x16x32_bf16 v[240:243], v[32:35], v[76:79], v[240:243]
    ds_read_b64_tr_b16 v[24:25], v116 offset:4096
    ds_read_b64_tr_b16 v[18:19], v117 offset:0
    v_mfma_f32_16x16x32_bf16 v[244:247], v[36:39], v[76:79], v[244:247]
    ds_read_b64_tr_b16 v[26:27], v117 offset:4096
    ds_read_b64_tr_b16 v[20:21], v118 offset:0
    v_mfma_f32_16x16x32_bf16 v[228:231], v[36:39], v[72:75], v[228:231]
    ds_read_b64_tr_b16 v[28:29], v118 offset:4096
    ds_read_b64_tr_b16 v[22:23], v119 offset:0
    v_mfma_f32_16x16x32_bf16 v[212:215], v[36:39], v[68:71], v[212:215]
    ds_read_b64_tr_b16 v[30:31], v119 offset:4096
    v_mfma_f32_16x16x32_bf16 v[196:199], v[36:39], v[64:67], v[196:199]
    v_mfma_f32_16x16x32_bf16 v[200:203], v[40:43], v[64:67], v[200:203]
    v_mfma_f32_16x16x32_bf16 v[216:219], v[40:43], v[68:71], v[216:219]
    s_waitcnt lgkmcnt(0)
    ds_write_b32 v120, v120
    v_mov_b32 v88, v80
    v_mov_b32 v89, v80
    v_mfma_f32_16x16x32_bf16 v[232:235], v[40:43], v[72:75], v[232:235]
    v_mov_b32 v90, v82
    v_mov_b32 v91, v82
    v_mfma_f32_16x16x32_bf16 v[248:251], v[40:43], v[76:79], v[248:251]
    v_mov_b32 v92, v84
    v_mov_b32 v93, v84
    v_mfma_f32_16x16x32_bf16 v[252:255], v[44:47], v[76:79], v[252:255]
    v_mov_b32 v94, v86
    v_mov_b32 v95, v86
    v_mfma_f32_16x16x32_bf16 v[236:239], v[44:47], v[72:75], v[236:239]
    v_rcp_f32 v99, v81
    v_mul_f32 v98, v81, v81
    v_mfma_f32_16x16x32_bf16 v[220:223], v[44:47], v[68:71], v[220:223]
    v_mul_f32 v96, 3222493025, v99
    v_mul_f32 v97, v99, v99
    v_mfma_f32_16x16x32_bf16 v[204:207], v[44:47], v[64:67], v[204:207]
    v_mfma_f32_16x16x16_bf16 v[128:131], v[16:17], v[88:89], v[128:131]
    v_mul_f32 v97, v97, v99
    v_mul_f32 v97, 3184710632, v97
    v_mfma_f32_16x16x16_bf16 v[132:135], v[18:19], v[88:89], v[132:135]
    v_rcp_f32 v103, v83
    v_mul_f32 v102, v83, v83
    v_mfma_f32_16x16x16_bf16 v[136:139], v[24:25], v[88:89], v[136:139]
    v_mul_f32 v100, 3222493025, v103
    v_mul_f32 v101, v103, v103
    v_mfma_f32_16x16x16_bf16 v[140:143], v[26:27], v[88:89], v[140:143]
    v_mul_f32 v101, v101, v103
    v_mul_f32 v101, 3184710632, v101
    v_rcp_f32 v107, v85
    v_mul_f32 v106, v85, v85
    v_mul_f32 v104, 3222493025, v107
    v_mul_f32 v105, v107, v107
    v_mul_f32 v105, v105, v107
    v_mul_f32 v105, 3184710632, v105
    v_rcp_f32 v111, v87
    v_mul_f32 v110, v87, v87
    v_mul_f32 v108, 3222493025, v111
    v_mul_f32 v109, v111, v111
    v_mul_f32 v109, v109, v111
    v_mul_f32 v109, 3184710632, v109
    v_readfirstlane_b32 s36, v12
    v_readfirstlane_b32 s37, v13
Lepi:
    s_mov_b32 s41, 0
    v_pk_mul_f32 v[48:49], v[128:129], v[128:129]
    v_pk_mul_f32 v[50:51], v[130:131], v[130:131]
    v_pk_mul_f32 v[52:53], v[132:133], v[132:133]
    v_pk_mul_f32 v[54:55], v[134:135], v[134:135]
    v_pk_fma_f32 v[48:49], v[48:49], v[96:97], v[96:97] op_sel:[0,1,0] op_sel_hi:[1,1,0]
    v_pk_fma_f32 v[50:51], v[50:51], v[96:97], v[96:97] op_sel:[0,1,0] op_sel_hi:[1,1,0]
    v_pk_fma_f32 v[52:53], v[52:53], v[96:97], v[96:97] op_sel:[0,1,0] op_sel_hi:[1,1,0]
    v_pk_fma_f32 v[54:55], v[54:55], v[96:97], v[96:97] op_sel:[0,1,0] op_sel_hi:[1,1,0]
    v_pk_mul_f32 v[48:49], v[48:49], v[128:129]
    v_pk_mul_f32 v[50:51], v[50:51], v[130:131]
    v_pk_mul_f32 v[52:53], v[52:53], v[132:133]
    v_pk_mul_f32 v[54:55], v[54:55], v[134:135]
    v_exp_f32 v48, v48
    v_exp_f32 v49, v49
    v_pk_mul_f32 v[56:57], v[128:129], v[136:137]
    v_exp_f32 v50, v50
    v_exp_f32 v51, v51
    v_pk_mul_f32 v[58:59], v[130:131], v[138:139]
    v_exp_f32 v52, v52
    v_exp_f32 v53, v53
    v_pk_mul_f32 v[60:61], v[132:133], v[140:141]
    v_exp_f32 v54, v54
    v_exp_f32 v55, v55
    v_pk_mul_f32 v[62:63], v[134:135], v[142:143]
    v_pk_fma_f32 v[48:49], v[48:49], v[98:99], v[98:99] op_sel_hi:[1,0,0]
    v_pk_fma_f32 v[50:51], v[50:51], v[98:99], v[98:99] op_sel_hi:[1,0,0]
    v_pk_fma_f32 v[52:53], v[52:53], v[98:99], v[98:99] op_sel_hi:[1,0,0]
    v_pk_fma_f32 v[54:55], v[54:55], v[98:99], v[98:99] op_sel_hi:[1,0,0]
    v_mfma_f32_16x16x16_bf16 v[144:147], v[16:17], v[90:91], v[144:147]
    v_rcp_f32 v48, v48
    v_rcp_f32 v49, v49
    v_mfma_f32_16x16x16_bf16 v[148:151], v[18:19], v[90:91], v[148:151]
    v_rcp_f32 v50, v50
    v_rcp_f32 v51, v51
    v_mfma_f32_16x16x16_bf16 v[152:155], v[24:25], v[90:91], v[152:155]
    v_rcp_f32 v52, v52
    v_rcp_f32 v53, v53
    v_mfma_f32_16x16x16_bf16 v[156:159], v[26:27], v[90:91], v[156:159]
    v_rcp_f32 v54, v54
    v_rcp_f32 v55, v55
    v_pk_mul_f32 v[48:49], v[48:49], v[56:57]
    v_pk_mul_f32 v[50:51], v[50:51], v[58:59]
    v_pk_mul_f32 v[52:53], v[52:53], v[60:61]
    v_pk_mul_f32 v[54:55], v[54:55], v[62:63]
    v_cvt_pk_bf16_f32 v32, v48, v49
    v_cvt_pk_bf16_f32 v33, v50, v51
    v_cvt_pk_bf16_f32 v34, v52, v53
    v_cvt_pk_bf16_f32 v35, v54, v55
    buffer_store_dwordx4 v[32:35], v8, s[44:47], s84 offen offset:0 sc1
    v_pk_mul_f32 v[48:49], v[144:145], v[144:145]
    v_pk_mul_f32 v[50:51], v[146:147], v[146:147]
    v_pk_mul_f32 v[52:53], v[148:149], v[148:149]
    v_pk_mul_f32 v[54:55], v[150:151], v[150:151]
    v_pk_fma_f32 v[48:49], v[48:49], v[100:101], v[100:101] op_sel:[0,1,0] op_sel_hi:[1,1,0]
    v_pk_fma_f32 v[50:51], v[50:51], v[100:101], v[100:101] op_sel:[0,1,0] op_sel_hi:[1,1,0]
    v_pk_fma_f32 v[52:53], v[52:53], v[100:101], v[100:101] op_sel:[0,1,0] op_sel_hi:[1,1,0]
    v_pk_fma_f32 v[54:55], v[54:55], v[100:101], v[100:101] op_sel:[0,1,0] op_sel_hi:[1,1,0]
    v_pk_mul_f32 v[48:49], v[48:49], v[144:145]
    v_pk_mul_f32 v[50:51], v[50:51], v[146:147]
    v_pk_mul_f32 v[52:53], v[52:53], v[148:149]
    v_pk_mul_f32 v[54:55], v[54:55], v[150:151]
    v_exp_f32 v48, v48
    v_exp_f32 v49, v49
    v_pk_mul_f32 v[56:57], v[144:145], v[152:153]
    v_exp_f32 v50, v50
    v_exp_f32 v51, v51
    v_pk_mul_f32 v[58:59], v[146:147], v[154:155]
    v_exp_f32 v52, v52
    v_exp_f32 v53, v53
    v_pk_mul_f32 v[60:61], v[148:149], v[156:157]
    v_exp_f32 v54, v54
    v_exp_f32 v55, v55
    v_pk_mul_f32 v[62:63], v[150:151], v[158:159]
    v_pk_fma_f32 v[48:49], v[48:49], v[102:103], v[102:103] op_sel_hi:[1,0,0]
    v_pk_fma_f32 v[50:51], v[50:51], v[102:103], v[102:103] op_sel_hi:[1,0,0]
    v_pk_fma_f32 v[52:53], v[52:53], v[102:103], v[102:103] op_sel_hi:[1,0,0]
    v_pk_fma_f32 v[54:55], v[54:55], v[102:103], v[102:103] op_sel_hi:[1,0,0]
    v_mfma_f32_16x16x16_bf16 v[160:163], v[16:17], v[92:93], v[160:163]
    v_rcp_f32 v48, v48
    v_rcp_f32 v49, v49
    v_mfma_f32_16x16x16_bf16 v[164:167], v[18:19], v[92:93], v[164:167]
    v_rcp_f32 v50, v50
    v_rcp_f32 v51, v51
    v_mfma_f32_16x16x16_bf16 v[168:171], v[24:25], v[92:93], v[168:171]
    v_rcp_f32 v52, v52
    v_rcp_f32 v53, v53
    v_mfma_f32_16x16x16_bf16 v[172:175], v[26:27], v[92:93], v[172:175]
    v_rcp_f32 v54, v54
    v_rcp_f32 v55, v55
    v_pk_mul_f32 v[48:49], v[48:49], v[56:57]
    v_pk_mul_f32 v[50:51], v[50:51], v[58:59]
    v_pk_mul_f32 v[52:53], v[52:53], v[60:61]
    v_pk_mul_f32 v[54:55], v[54:55], v[62:63]
    v_cvt_pk_bf16_f32 v36, v48, v49
    v_cvt_pk_bf16_f32 v37, v50, v51
    v_cvt_pk_bf16_f32 v38, v52, v53
    v_cvt_pk_bf16_f32 v39, v54, v55
    buffer_store_dwordx4 v[36:39], v8, s[44:47], s85 offen offset:0 sc1
    v_pk_mul_f32 v[48:49], v[160:161], v[160:161]
    v_pk_mul_f32 v[50:51], v[162:163], v[162:163]
    v_pk_mul_f32 v[52:53], v[164:165], v[164:165]
    v_pk_mul_f32 v[54:55], v[166:167], v[166:167]
    v_pk_fma_f32 v[48:49], v[48:49], v[104:105], v[104:105] op_sel:[0,1,0] op_sel_hi:[1,1,0]
    v_pk_fma_f32 v[50:51], v[50:51], v[104:105], v[104:105] op_sel:[0,1,0] op_sel_hi:[1,1,0]
    v_pk_fma_f32 v[52:53], v[52:53], v[104:105], v[104:105] op_sel:[0,1,0] op_sel_hi:[1,1,0]
    v_pk_fma_f32 v[54:55], v[54:55], v[104:105], v[104:105] op_sel:[0,1,0] op_sel_hi:[1,1,0]
    v_pk_mul_f32 v[48:49], v[48:49], v[160:161]
    v_pk_mul_f32 v[50:51], v[50:51], v[162:163]
    v_pk_mul_f32 v[52:53], v[52:53], v[164:165]
    v_pk_mul_f32 v[54:55], v[54:55], v[166:167]
    v_exp_f32 v48, v48
    v_exp_f32 v49, v49
    v_pk_mul_f32 v[56:57], v[160:161], v[168:169]
    v_exp_f32 v50, v50
    v_exp_f32 v51, v51
    v_pk_mul_f32 v[58:59], v[162:163], v[170:171]
    v_exp_f32 v52, v52
    v_exp_f32 v53, v53
    v_pk_mul_f32 v[60:61], v[164:165], v[172:173]
    v_exp_f32 v54, v54
    v_exp_f32 v55, v55
    v_pk_mul_f32 v[62:63], v[166:167], v[174:175]
    v_pk_fma_f32 v[48:49], v[48:49], v[106:107], v[106:107] op_sel_hi:[1,0,0]
    v_pk_fma_f32 v[50:51], v[50:51], v[106:107], v[106:107] op_sel_hi:[1,0,0]
    v_pk_fma_f32 v[52:53], v[52:53], v[106:107], v[106:107] op_sel_hi:[1,0,0]
    v_pk_fma_f32 v[54:55], v[54:55], v[106:107], v[106:107] op_sel_hi:[1,0,0]
    v_mfma_f32_16x16x16_bf16 v[176:179], v[16:17], v[94:95], v[176:179]
    v_rcp_f32 v48, v48
    v_rcp_f32 v49, v49
    v_mfma_f32_16x16x16_bf16 v[180:183], v[18:19], v[94:95], v[180:183]
    v_rcp_f32 v50, v50
    v_rcp_f32 v51, v51
    v_mfma_f32_16x16x16_bf16 v[184:187], v[24:25], v[94:95], v[184:187]
    v_rcp_f32 v52, v52
    v_rcp_f32 v53, v53
    v_mfma_f32_16x16x16_bf16 v[188:191], v[26:27], v[94:95], v[188:191]
    v_rcp_f32 v54, v54
    v_rcp_f32 v55, v55
    v_pk_mul_f32 v[48:49], v[48:49], v[56:57]
    v_pk_mul_f32 v[50:51], v[50:51], v[58:59]
    v_pk_mul_f32 v[52:53], v[52:53], v[60:61]
    v_pk_mul_f32 v[54:55], v[54:55], v[62:63]
    v_cvt_pk_bf16_f32 v40, v48, v49
    v_cvt_pk_bf16_f32 v41, v50, v51
    v_cvt_pk_bf16_f32 v42, v52, v53
    v_cvt_pk_bf16_f32 v43, v54, v55
    buffer_store_dwordx4 v[40:43], v8, s[44:47], s86 offen offset:0 sc1
    v_pk_mul_f32 v[48:49], v[176:177], v[176:177]
    v_pk_mul_f32 v[50:51], v[178:179], v[178:179]
    v_pk_mul_f32 v[52:53], v[180:181], v[180:181]
    v_pk_mul_f32 v[54:55], v[182:183], v[182:183]
    v_pk_fma_f32 v[48:49], v[48:49], v[108:109], v[108:109] op_sel:[0,1,0] op_sel_hi:[1,1,0]
    v_pk_fma_f32 v[50:51], v[50:51], v[108:109], v[108:109] op_sel:[0,1,0] op_sel_hi:[1,1,0]
    v_pk_fma_f32 v[52:53], v[52:53], v[108:109], v[108:109] op_sel:[0,1,0] op_sel_hi:[1,1,0]
    v_pk_fma_f32 v[54:55], v[54:55], v[108:109], v[108:109] op_sel:[0,1,0] op_sel_hi:[1,1,0]
    v_pk_mul_f32 v[48:49], v[48:49], v[176:177]
    v_pk_mul_f32 v[50:51], v[50:51], v[178:179]
    v_pk_mul_f32 v[52:53], v[52:53], v[180:181]
    v_pk_mul_f32 v[54:55], v[54:55], v[182:183]
    v_exp_f32 v48, v48
    v_exp_f32 v49, v49
    v_pk_mul_f32 v[56:57], v[176:177], v[184:185]
    v_exp_f32 v50, v50
    v_exp_f32 v51, v51
    v_pk_mul_f32 v[58:59], v[178:179], v[186:187]
    v_exp_f32 v52, v52
    v_exp_f32 v53, v53
    v_pk_mul_f32 v[60:61], v[180:181], v[188:189]
    v_exp_f32 v54, v54
    v_exp_f32 v55, v55
    v_pk_mul_f32 v[62:63], v[182:183], v[190:191]
    v_pk_fma_f32 v[48:49], v[48:49], v[110:111], v[110:111] op_sel_hi:[1,0,0]
    v_pk_fma_f32 v[50:51], v[50:51], v[110:111], v[110:111] op_sel_hi:[1,0,0]
    v_pk_fma_f32 v[52:53], v[52:53], v[110:111], v[110:111] op_sel_hi:[1,0,0]
    v_pk_fma_f32 v[54:55], v[54:55], v[110:111], v[110:111] op_sel_hi:[1,0,0]
    v_mfma_f32_16x16x16_bf16 v[192:195], v[20:21], v[88:89], v[192:195]
    v_rcp_f32 v48, v48
    v_rcp_f32 v49, v49
    v_mfma_f32_16x16x16_bf16 v[196:199], v[22:23], v[88:89], v[196:199]
    v_rcp_f32 v50, v50
    v_rcp_f32 v51, v51
    v_mfma_f32_16x16x16_bf16 v[200:203], v[28:29], v[88:89], v[200:203]
    v_rcp_f32 v52, v52
    v_rcp_f32 v53, v53
    v_mfma_f32_16x16x16_bf16 v[204:207], v[30:31], v[88:89], v[204:207]
    v_rcp_f32 v54, v54
    v_rcp_f32 v55, v55
    v_pk_mul_f32 v[48:49], v[48:49], v[56:57]
    v_pk_mul_f32 v[50:51], v[50:51], v[58:59]
    v_pk_mul_f32 v[52:53], v[52:53], v[60:61]
    v_pk_mul_f32 v[54:55], v[54:55], v[62:63]
    v_cvt_pk_bf16_f32 v44, v48, v49
    v_cvt_pk_bf16_f32 v45, v50, v51
    v_cvt_pk_bf16_f32 v46, v52, v53
    v_cvt_pk_bf16_f32 v47, v54, v55
    buffer_store_dwordx4 v[44:47], v8, s[44:47], s87 offen offset:0 sc1
    v_pk_mul_f32 v[48:49], v[192:193], v[192:193]
    v_pk_mul_f32 v[50:51], v[194:195], v[194:195]
    v_pk_mul_f32 v[52:53], v[196:197], v[196:197]
    v_pk_mul_f32 v[54:55], v[198:199], v[198:199]
    v_pk_fma_f32 v[48:49], v[48:49], v[96:97], v[96:97] op_sel:[0,1,0] op_sel_hi:[1,1,0]
    v_pk_fma_f32 v[50:51], v[50:51], v[96:97], v[96:97] op_sel:[0,1,0] op_sel_hi:[1,1,0]
    v_pk_fma_f32 v[52:53], v[52:53], v[96:97], v[96:97] op_sel:[0,1,0] op_sel_hi:[1,1,0]
    v_pk_fma_f32 v[54:55], v[54:55], v[96:97], v[96:97] op_sel:[0,1,0] op_sel_hi:[1,1,0]
    v_pk_mul_f32 v[48:49], v[48:49], v[192:193]
    v_pk_mul_f32 v[50:51], v[50:51], v[194:195]
    v_pk_mul_f32 v[52:53], v[52:53], v[196:197]
    v_pk_mul_f32 v[54:55], v[54:55], v[198:199]
    v_exp_f32 v48, v48
    v_exp_f32 v49, v49
    v_pk_mul_f32 v[56:57], v[192:193], v[200:201]
    v_exp_f32 v50, v50
    v_exp_f32 v51, v51
    v_pk_mul_f32 v[58:59], v[194:195], v[202:203]
    v_exp_f32 v52, v52
    v_exp_f32 v53, v53
    v_pk_mul_f32 v[60:61], v[196:197], v[204:205]
    v_exp_f32 v54, v54
    v_exp_f32 v55, v55
    v_pk_mul_f32 v[62:63], v[198:199], v[206:207]
    v_pk_fma_f32 v[48:49], v[48:49], v[98:99], v[98:99] op_sel_hi:[1,0,0]
    v_pk_fma_f32 v[50:51], v[50:51], v[98:99], v[98:99] op_sel_hi:[1,0,0]
    v_pk_fma_f32 v[52:53], v[52:53], v[98:99], v[98:99] op_sel_hi:[1,0,0]
    v_pk_fma_f32 v[54:55], v[54:55], v[98:99], v[98:99] op_sel_hi:[1,0,0]
    v_mfma_f32_16x16x16_bf16 v[208:211], v[20:21], v[90:91], v[208:211]
    v_rcp_f32 v48, v48
    v_rcp_f32 v49, v49
    v_mfma_f32_16x16x16_bf16 v[212:215], v[22:23], v[90:91], v[212:215]
    v_rcp_f32 v50, v50
    v_rcp_f32 v51, v51
    v_mfma_f32_16x16x16_bf16 v[216:219], v[28:29], v[90:91], v[216:219]
    v_rcp_f32 v52, v52
    v_rcp_f32 v53, v53
    v_mfma_f32_16x16x16_bf16 v[220:223], v[30:31], v[90:91], v[220:223]
    v_rcp_f32 v54, v54
    v_rcp_f32 v55, v55
    v_pk_mul_f32 v[48:49], v[48:49], v[56:57]
    v_pk_mul_f32 v[50:51], v[50:51], v[58:59]
    v_pk_mul_f32 v[52:53], v[52:53], v[60:61]
    v_pk_mul_f32 v[54:55], v[54:55], v[62:63]
    v_cvt_pk_bf16_f32 v32, v48, v49
    v_cvt_pk_bf16_f32 v33, v50, v51
    v_cvt_pk_bf16_f32 v34, v52, v53
    v_cvt_pk_bf16_f32 v35, v54, v55
    buffer_store_dwordx4 v[32:35], v8, s[44:47], s84 offen offset:1024 sc1
    v_pk_mul_f32 v[48:49], v[208:209], v[208:209]
    v_pk_mul_f32 v[50:51], v[210:211], v[210:211]
    v_pk_mul_f32 v[52:53], v[212:213], v[212:213]
    v_pk_mul_f32 v[54:55], v[214:215], v[214:215]
    v_pk_fma_f32 v[48:49], v[48:49], v[100:101], v[100:101] op_sel:[0,1,0] op_sel_hi:[1,1,0]
    v_pk_fma_f32 v[50:51], v[50:51], v[100:101], v[100:101] op_sel:[0,1,0] op_sel_hi:[1,1,0]
    v_pk_fma_f32 v[52:53], v[52:53], v[100:101], v[100:101] op_sel:[0,1,0] op_sel_hi:[1,1,0]
    v_pk_fma_f32 v[54:55], v[54:55], v[100:101], v[100:101] op_sel:[0,1,0] op_sel_hi:[1,1,0]
    v_pk_mul_f32 v[48:49], v[48:49], v[208:209]
    v_pk_mul_f32 v[50:51], v[50:51], v[210:211]
    v_pk_mul_f32 v[52:53], v[52:53], v[212:213]
    v_pk_mul_f32 v[54:55], v[54:55], v[214:215]
    v_exp_f32 v48, v48
    v_exp_f32 v49, v49
    v_pk_mul_f32 v[56:57], v[208:209], v[216:217]
    v_exp_f32 v50, v50
    v_exp_f32 v51, v51
    v_pk_mul_f32 v[58:59], v[210:211], v[218:219]
    v_exp_f32 v52, v52
    v_exp_f32 v53, v53
    v_pk_mul_f32 v[60:61], v[212:213], v[220:221]
    v_exp_f32 v54, v54
    v_exp_f32 v55, v55
    v_pk_mul_f32 v[62:63], v[214:215], v[222:223]
    v_pk_fma_f32 v[48:49], v[48:49], v[102:103], v[102:103] op_sel_hi:[1,0,0]
    v_pk_fma_f32 v[50:51], v[50:51], v[102:103], v[102:103] op_sel_hi:[1,0,0]
    v_pk_fma_f32 v[52:53], v[52:53], v[102:103], v[102:103] op_sel_hi:[1,0,0]
    v_pk_fma_f32 v[54:55], v[54:55], v[102:103], v[102:103] op_sel_hi:[1,0,0]
    v_mfma_f32_16x16x16_bf16 v[224:227], v[20:21], v[92:93], v[224:227]
    v_rcp_f32 v48, v48
    v_rcp_f32 v49, v49
    v_mfma_f32_16x16x16_bf16 v[228:231], v[22:23], v[92:93], v[228:231]
    v_rcp_f32 v50, v50
    v_rcp_f32 v51, v51
    v_mfma_f32_16x16x16_bf16 v[232:235], v[28:29], v[92:93], v[232:235]
    v_rcp_f32 v52, v52
    v_rcp_f32 v53, v53
    v_mfma_f32_16x16x16_bf16 v[236:239], v[30:31], v[92:93], v[236:239]
    v_rcp_f32 v54, v54
    v_rcp_f32 v55, v55
    v_pk_mul_f32 v[48:49], v[48:49], v[56:57]
    v_pk_mul_f32 v[50:51], v[50:51], v[58:59]
    v_pk_mul_f32 v[52:53], v[52:53], v[60:61]
    v_pk_mul_f32 v[54:55], v[54:55], v[62:63]
    v_cvt_pk_bf16_f32 v36, v48, v49
    v_cvt_pk_bf16_f32 v37, v50, v51
    v_cvt_pk_bf16_f32 v38, v52, v53
    v_cvt_pk_bf16_f32 v39, v54, v55
    buffer_store_dwordx4 v[36:39], v8, s[44:47], s85 offen offset:1024 sc1
    ds_read_b32 v10, v121 offset:36
    ds_read_b128 v[64:67], v121 offset:48
    v_pk_mul_f32 v[48:49], v[224:225], v[224:225]
    v_pk_mul_f32 v[50:51], v[226:227], v[226:227]
    v_pk_mul_f32 v[52:53], v[228:229], v[228:229]
    v_pk_mul_f32 v[54:55], v[230:231], v[230:231]
    v_pk_fma_f32 v[48:49], v[48:49], v[104:105], v[104:105] op_sel:[0,1,0] op_sel_hi:[1,1,0]
    v_pk_fma_f32 v[50:51], v[50:51], v[104:105], v[104:105] op_sel:[0,1,0] op_sel_hi:[1,1,0]
    v_pk_fma_f32 v[52:53], v[52:53], v[104:105], v[104:105] op_sel:[0,1,0] op_sel_hi:[1,1,0]
    v_pk_fma_f32 v[54:55], v[54:55], v[104:105], v[104:105] op_sel:[0,1,0] op_sel_hi:[1,1,0]
    v_pk_mul_f32 v[48:49], v[48:49], v[224:225]
    v_pk_mul_f32 v[50:51], v[50:51], v[226:227]
    v_pk_mul_f32 v[52:53], v[52:53], v[228:229]
    v_pk_mul_f32 v[54:55], v[54:55], v[230:231]
    v_exp_f32 v48, v48
    v_exp_f32 v49, v49
    v_pk_mul_f32 v[56:57], v[224:225], v[232:233]
    v_exp_f32 v50, v50
    v_exp_f32 v51, v51
    v_pk_mul_f32 v[58:59], v[226:227], v[234:235]
    v_exp_f32 v52, v52
    v_exp_f32 v53, v53
    v_pk_mul_f32 v[60:61], v[228:229], v[236:237]
    v_exp_f32 v54, v54
    v_exp_f32 v55, v55
    v_pk_mul_f32 v[62:63], v[230:231], v[238:239]
    v_pk_fma_f32 v[48:49], v[48:49], v[106:107], v[106:107] op_sel_hi:[1,0,0]
    v_pk_fma_f32 v[50:51], v[50:51], v[106:107], v[106:107] op_sel_hi:[1,0,0]
    v_pk_fma_f32 v[52:53], v[52:53], v[106:107], v[106:107] op_sel_hi:[1,0,0]
    v_pk_fma_f32 v[54:55], v[54:55], v[106:107], v[106:107] op_sel_hi:[1,0,0]
    v_mfma_f32_16x16x16_bf16 v[240:243], v[20:21], v[94:95], v[240:243]
    v_rcp_f32 v48, v48
    v_rcp_f32 v49, v49
    v_mfma_f32_16x16x16_bf16 v[244:247], v[22:23], v[94:95], v[244:247]
    v_rcp_f32 v50, v50
    v_rcp_f32 v51, v51
    v_mfma_f32_16x16x16_bf16 v[248:251], v[28:29], v[94:95], v[248:251]
    v_rcp_f32 v52, v52
    v_rcp_f32 v53, v53
    v_mfma_f32_16x16x16_bf16 v[252:255], v[30:31], v[94:95], v[252:255]
    v_rcp_f32 v54, v54
    v_rcp_f32 v55, v55
    v_pk_mul_f32 v[48:49], v[48:49], v[56:57]
    v_pk_mul_f32 v[50:51], v[50:51], v[58:59]
    v_pk_mul_f32 v[52:53], v[52:53], v[60:61]
    v_pk_mul_f32 v[54:55], v[54:55], v[62:63]
    v_cvt_pk_bf16_f32 v40, v48, v49
    v_cvt_pk_bf16_f32 v41, v50, v51
    v_cvt_pk_bf16_f32 v42, v52, v53
    v_cvt_pk_bf16_f32 v43, v54, v55
    buffer_store_dwordx4 v[40:43], v8, s[44:47], s86 offen offset:1024 sc1
    s_cmp_lg_u32 s41, 0
    s_cbranch_scc1 Lpa_2
    s_waitcnt vmcnt(3)
    v_mov_b32 v12, s36
    v_mov_b32 v13, s37
    s_mov_b64 exec, 1
    buffer_store_dwordx2 v[12:13], off, s[44:47], s81 sc1
    s_mov_b64 exec, -1
    s_mov_b32 s41, 64
Lpa_2:
    s_waitcnt lgkmcnt(0)
    v_min3_u32 v10, v10, v64, v65
    v_min3_u32 v10, v10, v66, v67
    s_nop 0
    v_readfirstlane_b32 s68, v10
    v_pk_mul_f32 v[48:49], v[240:241], v[240:241]
    v_pk_mul_f32 v[50:51], v[242:243], v[242:243]
    v_pk_mul_f32 v[52:53], v[244:245], v[244:245]
    v_pk_mul_f32 v[54:55], v[246:247], v[246:247]
    v_pk_fma_f32 v[48:49], v[48:49], v[108:109], v[108:109] op_sel:[0,1,0] op_sel_hi:[1,1,0]
    v_pk_fma_f32 v[50:51], v[50:51], v[108:109], v[108:109] op_sel:[0,1,0] op_sel_hi:[1,1,0]
    v_pk_fma_f32 v[52:53], v[52:53], v[108:109], v[108:109] op_sel:[0,1,0] op_sel_hi:[1,1,0]
    v_pk_fma_f32 v[54:55], v[54:55], v[108:109], v[108:109] op_sel:[0,1,0] op_sel_hi:[1,1,0]
    v_pk_mul_f32 v[48:49], v[48:49], v[240:241]
    v_pk_mul_f32 v[50:51], v[50:51], v[242:243]
    v_pk_mul_f32 v[52:53], v[52:53], v[244:245]
    v_pk_mul_f32 v[54:55], v[54:55], v[246:247]
    v_exp_f32 v48, v48
    ds_read_b128 v[128:131], v122 offset:0
    ds_read_b128 v[144:147], v122 offset:512
    v_exp_f32 v49, v49
    ds_read_b128 v[160:163], v122 offset:1024
    ds_read_b128 v[176:179], v122 offset:1536
    v_pk_mul_f32 v[56:57], v[240:241], v[248:249]
    v_exp_f32 v50, v50
    ds_read_b128 v[192:195], v122 offset:2048
    ds_read_b128 v[208:211], v122 offset:2560
    v_exp_f32 v51, v51
    ds_read_b128 v[224:227], v122 offset:3072
    ds_read2_b32 v[68:69], v123 offset0:0 offset1:1
    v_pk_mul_f32 v[58:59], v[242:243], v[250:251]
    v_exp_f32 v52, v52
    ds_read2_b32 v[70:71], v123 offset0:2 offset1:3
    ds_read_b128 v[132:135], v122 offset:128
    v_exp_f32 v53, v53
    ds_read_b128 v[148:151], v122 offset:640
    ds_read_b128 v[164:167], v122 offset:1152
    v_pk_mul_f32 v[60:61], v[244:245], v[252:253]
    v_exp_f32 v54, v54
    ds_read_b128 v[180:183], v122 offset:1664
    ds_read_b128 v[196:199], v122 offset:2176
    v_exp_f32 v55, v55
    ds_read_b128 v[212:215], v122 offset:2688
    ds_read_b128 v[228:231], v122 offset:3200
    v_pk_mul_f32 v[62:63], v[246:247], v[254:255]
    v_pk_fma_f32 v[48:49], v[48:49], v[110:111], v[110:111] op_sel_hi:[1,0,0]
    v_pk_fma_f32 v[50:51], v[50:51], v[110:111], v[110:111] op_sel_hi:[1,0,0]
    v_pk_fma_f32 v[52:53], v[52:53], v[110:111], v[110:111] op_sel_hi:[1,0,0]
    v_pk_fma_f32 v[54:55], v[54:55], v[110:111], v[110:111] op_sel_hi:[1,0,0]
    v_rcp_f32 v48, v48
    ds_read2_b32 v[72:73], v123 offset0:32 offset1:33
    ds_read2_b32 v[74:75], v123 offset0:34 offset1:35
    v_rcp_f32 v49, v49
    v_rcp_f32 v50, v50
    v_rcp_f32 v51, v51
    v_rcp_f32 v52, v52
    v_rcp_f32 v53, v53
    v_rcp_f32 v54, v54
    v_rcp_f32 v55, v55
    v_pk_mul_f32 v[48:49], v[48:49], v[56:57]
    v_pk_mul_f32 v[50:51], v[50:51], v[58:59]
    v_pk_mul_f32 v[52:53], v[52:53], v[60:61]
    v_pk_mul_f32 v[54:55], v[54:55], v[62:63]
    v_cvt_pk_bf16_f32 v44, v48, v49
    v_cvt_pk_bf16_f32 v45, v50, v51
    v_cvt_pk_bf16_f32 v46, v52, v53
    v_cvt_pk_bf16_f32 v47, v54, v55
    buffer_store_dwordx4 v[44:47], v8, s[44:47], s87 offen offset:1024 sc1
    ds_write_b32 v120, v120 offset:4176
    s_cmp_lg_u32 s68, 0
    s_cbranch_scc1 Lkvok
    ds_read_b32 v10, v121 offset:36
    ds_read_b128 v[64:67], v121 offset:48
    s_waitcnt lgkmcnt(0)
    v_min3_u32 v10, v10, v64, v65
    v_min3_u32 v10, v10, v66, v67
    v_cmp_ne_u32 vcc, 0, v10
    s_cbranch_vccnz Lkvre
Lconv:
    s_cmp_eq_u32 s35, 0
    s_cbranch_scc1 Lnb_3
    s_waitcnt vmcnt(0)
    v_mov_b32 v12, s36
    v_mov_b32 v13, s37
    s_mov_b64 exec, 1
    buffer_store_dwordx2 v[12:13], off, s[44:47], s82 sc1
    s_mov_b64 exec, -1
    s_mov_b32 s35, 0
Lnb_3:
    v_mov_b32 v6, 156708
    s_mov_b32 s42, 262144
Llw_4:
    s_sleep 1
    ds_read_b32 v7, v6
    s_waitcnt lgkmcnt(0)
    v_readfirstlane_b32 s68, v7
    s_sub_u32 s42, s42, 1
    s_cmp_eq_u32 s42, 0
    s_cbranch_scc1 Llw_4d
    s_cmp_eq_u32 s68, 0
    s_cbranch_scc1 Llw_4
Llw_4d:
    v_mov_b32 v7, 156720
    s_mov_b32 s42, 262144
Llw_5:
    ds_read_b128 v[8:11], v7
    s_waitcnt lgkmcnt(0)
    v_min_u32 v8, v8, v9
    v_min3_u32 v8, v8, v10, v11
    s_nop 0
    v_readfirstlane_b32 s68, v8
    s_sub_u32 s42, s42, 1
    s_cmp_eq_u32 s42, 0
    s_cbranch_scc1 Llw_5d
    s_cmp_eq_u32 s68, 0
    s_cbranch_scc1 Llw_5
Llw_5d:
Lkvre:
    ds_read_b128 v[128:131], v122 offset:0
    ds_read_b128 v[144:147], v122 offset:512
    ds_read_b128 v[160:163], v122 offset:1024
    ds_read_b128 v[176:179], v122 offset:1536
    ds_read_b128 v[192:195], v122 offset:2048
    ds_read_b128 v[208:211], v122 offset:2560
    ds_read_b128 v[224:227], v122 offset:3072
    ds_read2_b32 v[68:69], v123 offset0:0 offset1:1
    ds_read2_b32 v[70:71], v123 offset0:2 offset1:3
    ds_read_b128 v[132:135], v122 offset:128
    ds_read_b128 v[148:151], v122 offset:640
    ds_read_b128 v[164:167], v122 offset:1152
    ds_read_b128 v[180:183], v122 offset:1664
    ds_read_b128 v[196:199], v122 offset:2176
    ds_read_b128 v[212:215], v122 offset:2688
    ds_read_b128 v[228:231], v122 offset:3200
    ds_read2_b32 v[72:73], v123 offset0:32 offset1:33
    ds_read2_b32 v[74:75], v123 offset0:34 offset1:35
    s_branch Lkvok
    .fill ((Lbase - .) & 4095) / 4, 4, 0xBF800000
Lw2:
    s_branch Lw2r
Lkvok:
    s_waitcnt lgkmcnt(0)
    ds_read_b128 v[240:243], v122 offset:3584
    ds_read_b128 v[244:247], v122 offset:3712
    ds_read_b128 v[136:139], v122 offset:256
    ds_read_b128 v[152:155], v122 offset:768
    v_add_u32 v8, 1024, v123
    v_add_u32 v9, 2048, v123
    v_add_u32 v11, 3072, v123
    v_and_b32 v4, 15, v1
    v_lshrrev_b32 v5, 4, v1
    s_nop 1
    v_mfma_f32_16x16x32_bf16 v[108:111], v[124:127], v[128:131], 0
    ds_read_b128 v[168:171], v122 offset:1280
    v_mfma_f32_16x16x32_bf16 v[104:107], v[124:127], v[144:147], 0
    ds_read_b128 v[184:187], v122 offset:1792
    v_mfma_f32_16x16x32_bf16 v[100:103], v[124:127], v[160:163], 0
    ds_read_b128 v[200:203], v122 offset:2304
    v_mfma_f32_16x16x32_bf16 v[96:99], v[124:127], v[176:179], 0
    ds_read_b128 v[216:219], v122 offset:2816
    v_mfma_f32_16x16x32_bf16 v[92:95], v[124:127], v[192:195], 0
    ds_read_b128 v[232:235], v122 offset:3328
    v_mfma_f32_16x16x32_bf16 v[88:91], v[124:127], v[208:211], 0
    ds_read_b128 v[248:251], v122 offset:3840
    v_mfma_f32_16x16x32_bf16 v[84:87], v[124:127], v[224:227], 0
    ds_read2_b32 v[76:77], v123 offset0:64 offset1:65
    s_waitcnt lgkmcnt(10)
    v_mfma_f32_16x16x32_bf16 v[80:83], v[124:127], v[240:243], 0
    ds_read2_b32 v[78:79], v123 offset0:66 offset1:67
    v_mfma_f32_16x16x32_bf16 v[108:111], v[68:71], v[128:131], v[108:111]
    ds_read_b128 v[140:143], v122 offset:384
    v_mfma_f32_16x16x32_bf16 v[104:107], v[68:71], v[144:147], v[104:107]
    ds_read_b128 v[156:159], v122 offset:896
    v_mfma_f32_16x16x32_bf16 v[100:103], v[68:71], v[160:163], v[100:103]
    v_mfma_f32_16x16x32_bf16 v[96:99], v[68:71], v[176:179], v[96:99]
    v_mfma_f32_16x16x32_bf16 v[92:95], v[68:71], v[192:195], v[92:95]
    v_mfma_f32_16x16x32_bf16 v[88:91], v[68:71], v[208:211], v[88:91]
    v_mfma_f32_16x16x32_bf16 v[84:87], v[68:71], v[224:227], v[84:87]
    v_mfma_f32_16x16x32_bf16 v[80:83], v[68:71], v[240:243], v[80:83]
    v_mfma_f32_16x16x32_bf16 v[108:111], v[72:75], v[132:135], v[108:111]
    v_mfma_f32_16x16x32_bf16 v[104:107], v[72:75], v[148:151], v[104:107]
    v_mfma_f32_16x16x32_bf16 v[100:103], v[72:75], v[164:167], v[100:103]
    v_mfma_f32_16x16x32_bf16 v[96:99], v[72:75], v[180:183], v[96:99]
    v_mfma_f32_16x16x32_bf16 v[92:95], v[72:75], v[196:199], v[92:95]
    v_mfma_f32_16x16x32_bf16 v[88:91], v[72:75], v[212:215], v[88:91]
    v_mfma_f32_16x16x32_bf16 v[84:87], v[72:75], v[228:231], v[84:87]
    s_waitcnt lgkmcnt(12)
    v_mfma_f32_16x16x32_bf16 v[80:83], v[72:75], v[244:247], v[80:83]
    ds_read_b128 v[172:175], v122 offset:1408
    s_waitcnt lgkmcnt(3)
    v_mfma_f32_16x16x32_bf16 v[108:111], v[76:79], v[136:139], v[108:111]
    ds_read_b128 v[188:191], v122 offset:1920
    v_mfma_f32_16x16x32_bf16 v[104:107], v[76:79], v[152:155], v[104:107]
    ds_read_b128 v[204:207], v122 offset:2432
    v_mfma_f32_16x16x32_bf16 v[100:103], v[76:79], v[168:171], v[100:103]
    ds_read_b128 v[220:223], v122 offset:2944
    v_mfma_f32_16x16x32_bf16 v[96:99], v[76:79], v[184:187], v[96:99]
    ds_read_b128 v[236:239], v122 offset:3456
    v_mfma_f32_16x16x32_bf16 v[92:95], v[76:79], v[200:203], v[92:95]
    ds_read_b128 v[252:255], v122 offset:3968
    v_mfma_f32_16x16x32_bf16 v[88:91], v[76:79], v[216:219], v[88:91]
    ds_read2_b32 v[48:49], v123 offset0:96 offset1:97
    v_mfma_f32_16x16x32_bf16 v[84:87], v[76:79], v[232:235], v[84:87]
    ds_read2_b32 v[50:51], v123 offset0:98 offset1:99
    v_mfma_f32_16x16x32_bf16 v[80:83], v[76:79], v[248:251], v[80:83]
    ds_read2_b32 v[52:53], v123 offset0:128 offset1:129
    s_waitcnt lgkmcnt(1)
    v_mfma_f32_16x16x32_bf16 v[108:111], v[48:51], v[140:143], v[108:111]
    ds_read2_b32 v[54:55], v123 offset0:130 offset1:131
    v_mfma_f32_16x16x32_bf16 v[104:107], v[48:51], v[156:159], v[104:107]
    ds_read2_b32 v[56:57], v123 offset0:160 offset1:161
    v_mfma_f32_16x16x32_bf16 v[100:103], v[48:51], v[172:175], v[100:103]
    ds_read2_b32 v[58:59], v123 offset0:162 offset1:163
    v_mfma_f32_16x16x32_bf16 v[96:99], v[48:51], v[188:191], v[96:99]
    ds_read2_b32 v[60:61], v123 offset0:192 offset1:193
    v_mfma_f32_16x16x32_bf16 v[92:95], v[48:51], v[204:207], v[92:95]
    ds_read2_b32 v[62:63], v123 offset0:194 offset1:195
    v_mfma_f32_16x16x32_bf16 v[88:91], v[48:51], v[220:223], v[88:91]
    ds_read2_b32 v[64:65], v123 offset0:224 offset1:225
    v_mfma_f32_16x16x32_bf16 v[84:87], v[48:51], v[236:239], v[84:87]
    ds_read2_b32 v[66:67], v123 offset0:226 offset1:227
    v_mfma_f32_16x16x32_bf16 v[80:83], v[48:51], v[252:255], v[80:83]
    ds_read2_b32 v[68:69], v8 offset0:0 offset1:1
    s_waitcnt lgkmcnt(7)
    v_mfma_f32_16x16x32_bf16 v[108:111], v[52:55], v[144:147], v[108:111]
    ds_read2_b32 v[70:71], v8 offset0:2 offset1:3
    v_mfma_f32_16x16x32_bf16 v[104:107], v[52:55], v[160:163], v[104:107]
    ds_read2_b32 v[72:73], v8 offset0:32 offset1:33
    v_mfma_f32_16x16x32_bf16 v[100:103], v[52:55], v[176:179], v[100:103]
    ds_read2_b32 v[74:75], v8 offset0:34 offset1:35
    v_mfma_f32_16x16x32_bf16 v[96:99], v[52:55], v[192:195], v[96:99]
    ds_read2_b32 v[76:77], v8 offset0:64 offset1:65
    v_mfma_f32_16x16x32_bf16 v[92:95], v[52:55], v[208:211], v[92:95]
    ds_read2_b32 v[78:79], v8 offset0:66 offset1:67
    v_mfma_f32_16x16x32_bf16 v[88:91], v[52:55], v[224:227], v[88:91]
    v_mfma_f32_16x16x32_bf16 v[84:87], v[52:55], v[240:243], v[84:87]
    s_waitcnt lgkmcnt(10)
    v_mfma_f32_16x16x32_bf16 v[108:111], v[56:59], v[148:151], v[108:111]
    ds_read2_b32 v[48:49], v8 offset0:96 offset1:97
    v_mfma_f32_16x16x32_bf16 v[104:107], v[56:59], v[164:167], v[104:107]
    ds_read2_b32 v[50:51], v8 offset0:98 offset1:99
    v_mfma_f32_16x16x32_bf16 v[100:103], v[56:59], v[180:183], v[100:103]
    v_mfma_f32_16x16x32_bf16 v[96:99], v[56:59], v[196:199], v[96:99]
    v_mfma_f32_16x16x32_bf16 v[92:95], v[56:59], v[212:215], v[92:95]
    v_mfma_f32_16x16x32_bf16 v[88:91], v[56:59], v[228:231], v[88:91]
    v_mfma_f32_16x16x32_bf16 v[84:87], v[56:59], v[244:247], v[84:87]
    s_cmp_eq_u32 s35, 0
    s_cbranch_scc1 Lnb_6
    s_waitcnt vmcnt(0)
    v_mov_b32 v12, s36
    v_mov_b32 v13, s37
    s_mov_b64 exec, 1
    buffer_store_dwordx2 v[12:13], off, s[44:47], s82 sc1
    s_mov_b64 exec, -1
    s_mov_b32 s35, 0
Lnb_6:
    s_waitcnt lgkmcnt(10)
    v_mfma_f32_16x16x32_bf16 v[108:111], v[60:63], v[152:155], v[108:111]
    s_lshl_b32 s38, s30, 12
    s_add_u32 s38, s38, 139264
    v_lshl_add_u32 v32, v1, 4, s38
    ds_read2_b32 v[52:53], v8 offset0:128 offset1:129
    v_mfma_f32_16x16x32_bf16 v[104:107], v[60:63], v[168:171], v[104:107]
    v_xor_b32 v33, 4096, v32
    ds_read2_b32 v[54:55], v8 offset0:130 offset1:131
    v_mfma_f32_16x16x32_bf16 v[100:103], v[60:63], v[184:187], v[100:103]
    s_lshl_b32 s38, s30, 2
    s_add_u32 s38, s38, 156688
    v_mov_b32 v34, s38
    v_mfma_f32_16x16x32_bf16 v[96:99], v[60:63], v[200:203], v[96:99]
    v_xor_b32 v35, 4, v34
    v_mfma_f32_16x16x32_bf16 v[92:95], v[60:63], v[216:219], v[92:95]
    v_lshlrev_b32 v36, 4, v5
    s_lshl_b32 s40, s2, 2
    s_add_u32 s40, s40, s30
    v_mfma_f32_16x16x32_bf16 v[88:91], v[60:63], v[232:235], v[88:91]
    v_lshl_add_u32 v36, v4, 6, v36
    s_lshl_b32 s40, s40, 12
    s_add_u32 s40, s40, 16777216
    v_mfma_f32_16x16x32_bf16 v[84:87], v[60:63], v[248:251], v[84:87]
    s_mov_b32 s42, 262144
    s_waitcnt lgkmcnt(10)
    v_mfma_f32_16x16x32_bf16 v[108:111], v[64:67], v[156:159], v[108:111]
    v_mov_b32 v17, s36
    ds_read2_b32 v[56:57], v8 offset0:160 offset1:161
    v_mfma_f32_16x16x32_bf16 v[104:107], v[64:67], v[172:175], v[104:107]
    v_mov_b32 v19, s36
    ds_read2_b32 v[58:59], v8 offset0:162 offset1:163
    v_mfma_f32_16x16x32_bf16 v[100:103], v[64:67], v[188:191], v[100:103]
    v_mov_b32 v21, s36
    v_mfma_f32_16x16x32_bf16 v[96:99], v[64:67], v[204:207], v[96:99]
    v_mov_b32 v23, s36
    v_mfma_f32_16x16x32_bf16 v[92:95], v[64:67], v[220:223], v[92:95]
    v_mov_b32 v25, s36
    v_mfma_f32_16x16x32_bf16 v[88:91], v[64:67], v[236:239], v[88:91]
    v_mov_b32 v27, s36
    v_mfma_f32_16x16x32_bf16 v[84:87], v[64:67], v[252:255], v[84:87]
    v_mov_b32 v29, s36
    s_waitcnt lgkmcnt(10)
    v_mfma_f32_16x16x32_bf16 v[108:111], v[68:71], v[160:163], v[108:111]
    v_mov_b32 v31, s36
    ds_read2_b32 v[60:61], v8 offset0:192 offset1:193
    v_mfma_f32_16x16x32_bf16 v[104:107], v[68:71], v[176:179], v[104:107]
    ds_read2_b32 v[62:63], v8 offset0:194 offset1:195
    v_mfma_f32_16x16x32_bf16 v[100:103], v[68:71], v[192:195], v[100:103]
    v_mfma_f32_16x16x32_bf16 v[96:99], v[68:71], v[208:211], v[96:99]
    v_mfma_f32_16x16x32_bf16 v[92:95], v[68:71], v[224:227], v[92:95]
    v_mfma_f32_16x16x32_bf16 v[88:91], v[68:71], v[240:243], v[88:91]
    s_waitcnt lgkmcnt(10)
    v_mfma_f32_16x16x32_bf16 v[108:111], v[72:75], v[164:167], v[108:111]
    ds_read2_b32 v[64:65], v8 offset0:224 offset1:225
    v_mfma_f32_16x16x32_bf16 v[104:107], v[72:75], v[180:183], v[104:107]
    ds_read2_b32 v[66:67], v8 offset0:226 offset1:227
    v_mfma_f32_16x16x32_bf16 v[100:103], v[72:75], v[196:199], v[100:103]
    v_mfma_f32_16x16x32_bf16 v[96:99], v[72:75], v[212:215], v[96:99]
    v_mfma_f32_16x16x32_bf16 v[92:95], v[72:75], v[228:231], v[92:95]
    v_mfma_f32_16x16x32_bf16 v[88:91], v[72:75], v[244:247], v[88:91]
    s_waitcnt lgkmcnt(10)
    v_mfma_f32_16x16x32_bf16 v[108:111], v[76:79], v[168:171], v[108:111]
    ds_read2_b32 v[68:69], v9 offset0:0 offset1:1
    v_mfma_f32_16x16x32_bf16 v[104:107], v[76:79], v[184:187], v[104:107]
    ds_read2_b32 v[70:71], v9 offset0:2 offset1:3
    v_mfma_f32_16x16x32_bf16 v[100:103], v[76:79], v[200:203], v[100:103]
    v_mfma_f32_16x16x32_bf16 v[96:99], v[76:79], v[216:219], v[96:99]
    v_mfma_f32_16x16x32_bf16 v[92:95], v[76:79], v[232:235], v[92:95]
    v_mfma_f32_16x16x32_bf16 v[88:91], v[76:79], v[248:251], v[88:91]
    s_waitcnt lgkmcnt(10)
    v_mfma_f32_16x16x32_bf16 v[108:111], v[48:51], v[172:175], v[108:111]
    ds_read2_b32 v[72:73], v9 offset0:32 offset1:33
    v_mfma_f32_16x16x32_bf16 v[104:107], v[48:51], v[188:191], v[104:107]
    ds_read2_b32 v[74:75], v9 offset0:34 offset1:35
    v_mfma_f32_16x16x32_bf16 v[100:103], v[48:51], v[204:207], v[100:103]
    v_mfma_f32_16x16x32_bf16 v[96:99], v[48:51], v[220:223], v[96:99]
    v_mfma_f32_16x16x32_bf16 v[92:95], v[48:51], v[236:239], v[92:95]
    v_mfma_f32_16x16x32_bf16 v[88:91], v[48:51], v[252:255], v[88:91]
    s_lshl_b32 s38, s30, 2
    s_add_u32 s38, s38, 160896
    v_mov_b32 v6, s38
    ds_write_b32 v6, v6
    s_waitcnt lgkmcnt(11)
    v_mfma_f32_16x16x32_bf16 v[108:111], v[52:55], v[176:179], v[108:111]
    ds_read2_b32 v[76:77], v9 offset0:64 offset1:65
    v_mfma_f32_16x16x32_bf16 v[104:107], v[52:55], v[192:195], v[104:107]
    ds_read2_b32 v[78:79], v9 offset0:66 offset1:67
    v_mfma_f32_16x16x32_bf16 v[100:103], v[52:55], v[208:211], v[100:103]
    v_mfma_f32_16x16x32_bf16 v[96:99], v[52:55], v[224:227], v[96:99]
    v_mfma_f32_16x16x32_bf16 v[92:95], v[52:55], v[240:243], v[92:95]
    s_waitcnt lgkmcnt(11)
    v_mfma_f32_16x16x32_bf16 v[108:111], v[56:59], v[180:183], v[108:111]
    ds_read2_b32 v[48:49], v9 offset0:96 offset1:97
    v_mfma_f32_16x16x32_bf16 v[104:107], v[56:59], v[196:199], v[104:107]
    ds_read2_b32 v[50:51], v9 offset0:98 offset1:99
    v_mfma_f32_16x16x32_bf16 v[100:103], v[56:59], v[212:215], v[100:103]
    v_mfma_f32_16x16x32_bf16 v[96:99], v[56:59], v[228:231], v[96:99]
    v_mfma_f32_16x16x32_bf16 v[92:95], v[56:59], v[244:247], v[92:95]
    s_waitcnt lgkmcnt(11)
    v_mfma_f32_16x16x32_bf16 v[108:111], v[60:63], v[184:187], v[108:111]
    ds_read2_b32 v[52:53], v9 offset0:128 offset1:129
    v_mfma_f32_16x16x32_bf16 v[104:107], v[60:63], v[200:203], v[104:107]
    ds_read2_b32 v[54:55], v9 offset0:130 offset1:131
    v_mfma_f32_16x16x32_bf16 v[100:103], v[60:63], v[216:219], v[100:103]
    v_mfma_f32_16x16x32_bf16 v[96:99], v[60:63], v[232:235], v[96:99]
    v_mfma_f32_16x16x32_bf16 v[92:95], v[60:63], v[248:251], v[92:95]
    s_waitcnt lgkmcnt(11)
    v_mfma_f32_16x16x32_bf16 v[108:111], v[64:67], v[188:191], v[108:111]
    ds_read2_b32 v[56:57], v9 offset0:160 offset1:161
    v_mfma_f32_16x16x32_bf16 v[104:107], v[64:67], v[204:207], v[104:107]
    ds_read2_b32 v[58:59], v9 offset0:162 offset1:163
    v_mfma_f32_16x16x32_bf16 v[100:103], v[64:67], v[220:223], v[100:103]
    v_mfma_f32_16x16x32_bf16 v[96:99], v[64:67], v[236:239], v[96:99]
    v_mfma_f32_16x16x32_bf16 v[92:95], v[64:67], v[252:255], v[92:95]
    s_waitcnt lgkmcnt(11)
    v_mfma_f32_16x16x32_bf16 v[108:111], v[68:71], v[192:195], v[108:111]
    ds_read2_b32 v[60:61], v9 offset0:192 offset1:193
    v_mfma_f32_16x16x32_bf16 v[104:107], v[68:71], v[208:211], v[104:107]
    ds_read2_b32 v[62:63], v9 offset0:194 offset1:195
    v_mfma_f32_16x16x32_bf16 v[100:103], v[68:71], v[224:227], v[100:103]
    v_mfma_f32_16x16x32_bf16 v[96:99], v[68:71], v[240:243], v[96:99]
    s_waitcnt lgkmcnt(11)
    v_mfma_f32_16x16x32_bf16 v[108:111], v[72:75], v[196:199], v[108:111]
    ds_read2_b32 v[64:65], v9 offset0:224 offset1:225
    v_mfma_f32_16x16x32_bf16 v[104:107], v[72:75], v[212:215], v[104:107]
    ds_read2_b32 v[66:67], v9 offset0:226 offset1:227
    v_mfma_f32_16x16x32_bf16 v[100:103], v[72:75], v[228:231], v[100:103]
    v_mfma_f32_16x16x32_bf16 v[96:99], v[72:75], v[244:247], v[96:99]
    s_bitcmp0_b32 s30, 0
    s_cbranch_scc1 Lex0
    ds_write_b128 v32, v[80:83] offset:0
    ds_write_b128 v32, v[84:87] offset:1024
    ds_write_b128 v32, v[88:91] offset:2048
    ds_write_b128 v32, v[92:95] offset:3072
    ds_write_b32 v34, v34
Lex0:
    s_waitcnt lgkmcnt(10)
    v_mfma_f32_16x16x32_bf16 v[108:111], v[76:79], v[200:203], v[108:111]
    ds_read2_b32 v[68:69], v11 offset0:0 offset1:1
    v_mfma_f32_16x16x32_bf16 v[104:107], v[76:79], v[216:219], v[104:107]
    ds_read2_b32 v[70:71], v11 offset0:2 offset1:3
    v_mfma_f32_16x16x32_bf16 v[100:103], v[76:79], v[232:235], v[100:103]
    v_mfma_f32_16x16x32_bf16 v[96:99], v[76:79], v[248:251], v[96:99]
    s_waitcnt lgkmcnt(10)
    v_mfma_f32_16x16x32_bf16 v[108:111], v[48:51], v[204:207], v[108:111]
    ds_read2_b32 v[72:73], v11 offset0:32 offset1:33
    v_mfma_f32_16x16x32_bf16 v[104:107], v[48:51], v[220:223], v[104:107]
    ds_read2_b32 v[74:75], v11 offset0:34 offset1:35
    v_mfma_f32_16x16x32_bf16 v[100:103], v[48:51], v[236:239], v[100:103]
    v_mfma_f32_16x16x32_bf16 v[96:99], v[48:51], v[252:255], v[96:99]
    s_waitcnt lgkmcnt(10)
    v_mfma_f32_16x16x32_bf16 v[108:111], v[52:55], v[208:211], v[108:111]
    ds_read2_b32 v[76:77], v11 offset0:64 offset1:65
    v_mfma_f32_16x16x32_bf16 v[104:107], v[52:55], v[224:227], v[104:107]
    ds_read2_b32 v[78:79], v11 offset0:66 offset1:67
    v_mfma_f32_16x16x32_bf16 v[100:103], v[52:55], v[240:243], v[100:103]
    s_waitcnt lgkmcnt(10)
    v_mfma_f32_16x16x32_bf16 v[108:111], v[56:59], v[212:215], v[108:111]
    ds_read2_b32 v[48:49], v11 offset0:96 offset1:97
    v_mfma_f32_16x16x32_bf16 v[104:107], v[56:59], v[228:231], v[104:107]
    ds_read2_b32 v[50:51], v11 offset0:98 offset1:99
    v_mfma_f32_16x16x32_bf16 v[100:103], v[56:59], v[244:247], v[100:103]
    s_waitcnt lgkmcnt(10)
    v_mfma_f32_16x16x32_bf16 v[108:111], v[60:63], v[216:219], v[108:111]
    ds_read2_b32 v[52:53], v11 offset0:128 offset1:129
    v_mfma_f32_16x16x32_bf16 v[104:107], v[60:63], v[232:235], v[104:107]
    ds_read2_b32 v[54:55], v11 offset0:130 offset1:131
    v_mfma_f32_16x16x32_bf16 v[100:103], v[60:63], v[248:251], v[100:103]
    s_waitcnt lgkmcnt(10)
    v_mfma_f32_16x16x32_bf16 v[108:111], v[64:67], v[220:223], v[108:111]
    ds_read2_b32 v[56:57], v11 offset0:160 offset1:161
    v_mfma_f32_16x16x32_bf16 v[104:107], v[64:67], v[236:239], v[104:107]
    ds_read2_b32 v[58:59], v11 offset0:162 offset1:163
    v_mfma_f32_16x16x32_bf16 v[100:103], v[64:67], v[252:255], v[100:103]
    s_waitcnt lgkmcnt(10)
    v_mfma_f32_16x16x32_bf16 v[108:111], v[68:71], v[224:227], v[108:111]
    ds_read2_b32 v[60:61], v11 offset0:192 offset1:193
    v_mfma_f32_16x16x32_bf16 v[104:107], v[68:71], v[240:243], v[104:107]
    ds_read2_b32 v[62:63], v11 offset0:194 offset1:195
    s_waitcnt lgkmcnt(10)
    v_mfma_f32_16x16x32_bf16 v[108:111], v[72:75], v[228:231], v[108:111]
    ds_read2_b32 v[64:65], v11 offset0:224 offset1:225
    v_mfma_f32_16x16x32_bf16 v[104:107], v[72:75], v[244:247], v[104:107]
    ds_read2_b32 v[66:67], v11 offset0:226 offset1:227
    s_waitcnt lgkmcnt(10)
    v_mfma_f32_16x16x32_bf16 v[108:111], v[76:79], v[232:235], v[108:111]
    v_mfma_f32_16x16x32_bf16 v[104:107], v[76:79], v[248:251], v[104:107]
    s_waitcnt lgkmcnt(8)
    v_mfma_f32_16x16x32_bf16 v[108:111], v[48:51], v[236:239], v[108:111]
    v_mfma_f32_16x16x32_bf16 v[104:107], v[48:51], v[252:255], v[104:107]
    s_waitcnt lgkmcnt(6)
    v_mfma_f32_16x16x32_bf16 v[108:111], v[52:55], v[240:243], v[108:111]
    s_waitcnt lgkmcnt(4)
    v_mfma_f32_16x16x32_bf16 v[108:111], v[56:59], v[244:247], v[108:111]
    s_waitcnt lgkmcnt(2)
    v_mfma_f32_16x16x32_bf16 v[108:111], v[60:63], v[248:251], v[108:111]
    s_waitcnt lgkmcnt(0)
    v_mfma_f32_16x16x32_bf16 v[108:111], v[64:67], v[252:255], v[108:111]
    s_bitcmp1_b32 s30, 0
    s_cbranch_scc1 Lex1
    s_nop 4
    ds_write_b128 v32, v[96:99] offset:0
    ds_write_b128 v32, v[100:103] offset:1024
    ds_write_b128 v32, v[104:107] offset:2048
    ds_write_b128 v32, v[108:111] offset:3072
    ds_write_b32 v34, v34
    s_branch Lex3
Lex1:
    s_nop 4
    v_mov_b32 v80, v96
    v_mov_b32 v81, v97
    v_mov_b32 v82, v98
    v_mov_b32 v83, v99
    v_mov_b32 v84, v100
    v_mov_b32 v85, v101
    v_mov_b32 v86, v102
    v_mov_b32 v87, v103
    v_mov_b32 v88, v104
    v_mov_b32 v89, v105
    v_mov_b32 v90, v106
    v_mov_b32 v91, v107
    v_mov_b32 v92, v108
    v_mov_b32 v93, v109
    v_mov_b32 v94, v110
    v_mov_b32 v95, v111
Lex3:
    ds_read_b32 v12, v35
    s_sub_u32 s42, s42, 1
    s_cbranch_scc1 Lex4
    s_waitcnt lgkmcnt(0)
    v_cmp_eq_u32 vcc, 0, v12
    s_cbranch_vccnz Lex3
Lex4:
    ds_read_b128 v[48:51], v33 offset:0
    ds_read_b128 v[52:55], v33 offset:1024
    ds_read_b128 v[56:59], v33 offset:2048
    ds_read_b128 v[60:63], v33 offset:3072
    s_waitcnt lgkmcnt(3)
    v_add_f32 v80, v80, v48
    v_add_f32 v81, v81, v49
    v_add_f32 v82, v82, v50
    v_add_f32 v83, v83, v51
    v_cvt_pk_bf16_f32 v16, v80, v81
    v_cvt_pk_bf16_f32 v18, v82, v83
    buffer_store_dwordx4 v[16:19], v36, s[44:47], s40 offen offset:0 sc1
    s_waitcnt lgkmcnt(2)
    v_add_f32 v84, v84, v52
    v_add_f32 v85, v85, v53
    v_add_f32 v86, v86, v54
    v_add_f32 v87, v87, v55
    v_cvt_pk_bf16_f32 v20, v84, v85
    v_cvt_pk_bf16_f32 v22, v86, v87
    buffer_store_dwordx4 v[20:23], v36, s[44:47], s40 offen offset:1024 sc1
    s_waitcnt lgkmcnt(1)
    v_add_f32 v88, v88, v56
    v_add_f32 v89, v89, v57
    v_add_f32 v90, v90, v58
    v_add_f32 v91, v91, v59
    v_cvt_pk_bf16_f32 v24, v88, v89
    v_cvt_pk_bf16_f32 v26, v90, v91
    buffer_store_dwordx4 v[24:27], v36, s[44:47], s40 offen offset:2048 sc1
    s_waitcnt lgkmcnt(0)
    v_add_f32 v92, v92, v60
    v_add_f32 v93, v93, v61
    v_add_f32 v94, v94, v62
    v_add_f32 v95, v95, v63
    v_cvt_pk_bf16_f32 v28, v92, v93
    v_cvt_pk_bf16_f32 v30, v94, v95
    buffer_store_dwordx4 v[28:31], v36, s[44:47], s40 offen offset:3072 sc1
    s_endpgm
Lspare:
    v_mov_b32 v4, 0
    s_lshl_b32 s38, s74, 2
    s_add_u32 s38, s38, 156688
    v_mov_b32 v7, s38
    ds_write_b32 v7, v4
    ds_write_b32 v7, v4 offset:16
    ds_write_b32 v7, v7 offset:32
    ds_write_b32 v7, v4 offset:4208
    ds_write_b32 v7, v4 offset:4224
    v_lshrrev_b32 v4, 3, v1
    v_and_b32 v5, 7, v1
    s_lshl_b32 s38, s33, 16
    s_lshl_b32 s39, s30, 7
    s_add_u32 s38, s38, s39
    v_lshlrev_b32 v6, 13, v4
    v_lshl_add_u32 v6, v5, 4, v6
    v_add_u32 v6, s38, v6
    v_subrev_u32 v7, 3072, v6
    v_add_u32 v8, 4096, v6
    s_lshl_b32 s39, s30, 9
    v_lshl_add_u32 v9, v5, 6, s39
    s_waitcnt lgkmcnt(0)
    s_barrier
    s_mov_b32 s44, s28
    s_mov_b32 s45, s29
    s_mov_b32 s46, 20971520
    s_mov_b32 s47, 0x20000
    s_cmp_lt_u32 s30, 4
    s_cbranch_scc0 Lsp1b
    s_and_b32 s39, s2, 7
    s_lshl_b32 s39, s39, 5
    s_lshr_b32 s38, s2, 3
    s_add_u32 s39, s39, s38
    s_lshl_b32 s39, s39, 2
    s_add_u32 s39, s39, s30
    s_lshl_b32 s38, s39, 11
    v_and_b32 v125, 32, v1
    v_add_u32 v124, v125, v1
    v_lshl_add_u32 v124, v124, 4, s38
    s_lshl_b32 s38, s39, 4
    s_add_u32 s83, s38, 7602176
    global_load_dwordx4 v[116:119], v124, s[4:5]
    global_load_dwordx4 v[120:123], v124, s[4:5] offset:512
Lsp1b:
    s_cmp_lg_u32 s30, 6
    s_cbranch_scc1 Lsp2
    s_mov_b32 s60, s4
    s_mov_b32 s61, s5
    s_mov_b32 s62, 2097152
    s_mov_b32 s63, 0x20000
    s_lshl_b32 s38, s31, 17
    s_add_u32 s38, s38, 114688
    v_lshlrev_b32 v10, 7, v1
    buffer_load_dword v0, v10, s[60:63], s38 offen
    s_add_u32 s38, s38, 8192
    buffer_load_dword v0, v10, s[60:63], s38 offen
Lsp2:
    s_mov_b32 s56, s6
    s_mov_b32 s57, s7
    s_mov_b32 s58, 2097152
    s_mov_b32 s59, 0x20000
    s_mov_b32 s48, s8
    s_mov_b32 s49, s9
    s_mov_b32 s50, 2097152
    s_mov_b32 s51, 0x20000
    s_mov_b32 s64, s10
    s_mov_b32 s65, s11
    s_mov_b32 s66, 4096
    s_mov_b32 s67, 0x20000
    buffer_load_dwordx4 v[92:95], v9, s[64:67], 0 offen offset:0
    buffer_load_dwordx4 v[96:99], v9, s[64:67], 0 offen offset:16
    buffer_load_dwordx4 v[100:103], v9, s[64:67], 0 offen offset:32
    buffer_load_dwordx4 v[104:107], v9, s[64:67], 0 offen offset:48
    s_waitcnt vmcnt(0)
    buffer_load_dwordx4 v[28:31], v6, s[56:59], 0 offen offset:0
    buffer_load_dwordx4 v[32:35], v6, s[56:59], 0 offen offset:1024
    buffer_load_dwordx4 v[36:39], v6, s[56:59], 0 offen offset:2048
    buffer_load_dwordx4 v[40:43], v6, s[56:59], 0 offen offset:3072
    v_mov_b32 v10, 0
    global_load_dwordx2 v[2:3], v10, s[26:27] sc1
    buffer_load_dwordx4 v[44:47], v8, s[56:59], 0 offen offset:0
    buffer_load_dwordx4 v[48:51], v8, s[56:59], 0 offen offset:1024
    buffer_load_dwordx4 v[52:55], v8, s[56:59], 0 offen offset:2048
    buffer_load_dwordx4 v[56:59], v8, s[56:59], 0 offen offset:3072
    buffer_load_dwordx4 v[16:19], v7, s[56:59], 0 offen offset:0
    buffer_load_dwordx4 v[20:23], v7, s[56:59], 0 offen offset:1024
    s_cmp_lt_u32 s30, 4
    s_cbranch_scc0 Lsp5
    s_waitcnt vmcnt(15)
    v_lshlrev_b32 v126, 16, v116
    v_and_b32 v127, 0xffff0000, v116
    v_lshlrev_b32 v128, 16, v117
    v_and_b32 v129, 0xffff0000, v117
    v_lshlrev_b32 v130, 16, v118
    v_and_b32 v131, 0xffff0000, v118
    v_lshlrev_b32 v132, 16, v119
    v_and_b32 v133, 0xffff0000, v119
    v_lshlrev_b32 v134, 16, v120
    v_and_b32 v135, 0xffff0000, v120
    v_lshlrev_b32 v136, 16, v121
    v_and_b32 v137, 0xffff0000, v121
    v_lshlrev_b32 v138, 16, v122
    v_and_b32 v139, 0xffff0000, v122
    v_lshlrev_b32 v140, 16, v123
    v_and_b32 v141, 0xffff0000, v123
    v_pk_add_f32 v[142:143], v[126:127], v[128:129]
    v_pk_mul_f32 v[144:145], v[126:127], v[126:127]
    v_pk_fma_f32 v[144:145], v[128:129], v[128:129], v[144:145]
    v_pk_add_f32 v[142:143], v[142:143], v[130:131]
    v_pk_fma_f32 v[144:145], v[130:131], v[130:131], v[144:145]
    v_pk_add_f32 v[142:143], v[142:143], v[132:133]
    v_pk_fma_f32 v[144:145], v[132:133], v[132:133], v[144:145]
    v_pk_add_f32 v[142:143], v[142:143], v[134:135]
    v_pk_fma_f32 v[144:145], v[134:135], v[134:135], v[144:145]
    v_pk_add_f32 v[142:143], v[142:143], v[136:137]
    v_pk_fma_f32 v[144:145], v[136:137], v[136:137], v[144:145]
    v_pk_add_f32 v[142:143], v[142:143], v[138:139]
    v_pk_fma_f32 v[144:145], v[138:139], v[138:139], v[144:145]
    v_pk_add_f32 v[142:143], v[142:143], v[140:141]
    v_pk_fma_f32 v[144:145], v[140:141], v[140:141], v[144:145]
    v_add_f32 v142, v142, v143
    v_add_f32 v144, v144, v145
    s_nop 1
    v_add_f32_dpp v142, v142, v142 quad_perm:[1,0,3,2] row_mask:0xf bank_mask:0xf
    v_add_f32_dpp v144, v144, v144 quad_perm:[1,0,3,2] row_mask:0xf bank_mask:0xf
    s_nop 1
    v_add_f32_dpp v142, v142, v142 quad_perm:[2,3,0,1] row_mask:0xf bank_mask:0xf
    v_add_f32_dpp v144, v144, v144 quad_perm:[2,3,0,1] row_mask:0xf bank_mask:0xf
    s_nop 1
    v_add_f32_dpp v142, v142, v142 row_half_mirror row_mask:0xf bank_mask:0xf
    v_add_f32_dpp v144, v144, v144 row_half_mirror row_mask:0xf bank_mask:0xf
    s_nop 1
    v_add_f32_dpp v142, v142, v142 row_mirror row_mask:0xf bank_mask:0xf
    v_add_f32_dpp v144, v144, v144 row_mirror row_mask:0xf bank_mask:0xf
    v_mov_b32 v143, v142
    v_mov_b32 v145, v144
    s_nop 1
    v_permlane16_swap_b32 v142, v143
    v_permlane16_swap_b32 v144, v145
    v_add_f32 v142, v142, v143
    v_add_f32 v144, v144, v145
    v_mul_f32 v142, 989855744, v142
    v_mul_f32 v144, 989855744, v144
    v_fma_f32 v144, -v142, v142, v144
    v_max_f32 v144, 0, v144
    v_cvt_pk_bf16_f32 v144, v144, v144
    v_lshlrev_b32 v144, 16, v144
    v_add_f32 v144, 925353388, v144
    v_cvt_pk_bf16_f32 v144, v144, v144
    v_lshlrev_b32 v144, 16, v144
    v_sqrt_f32 v144, v144
    v_sub_f32 v142, 0, v142
    v_cvt_pk_bf16_f32 v144, v144, v144
    v_lshlrev_b32 v117, 16, v144
    v_cvt_pk_bf16_f32 v116, v142, v142
    v_lshrrev_b32 v125, 2, v125
    s_mov_b32 exec_lo, 1
    s_mov_b32 exec_hi, 1
    buffer_store_dwordx2 v[116:117], v125, s[44:47], s83 offen sc1
    s_mov_b64 exec, -1
Lsp5:
    buffer_load_dwordx4 v[24:27], v7, s[56:59], 0 offen offset:2048
    buffer_load_dwordx4 v[60:63], v6, s[48:51], 0 offen offset:0
    buffer_load_dwordx4 v[64:67], v6, s[48:51], 0 offen offset:1024
    buffer_load_dwordx4 v[68:71], v6, s[48:51], 0 offen offset:2048
    buffer_load_dwordx4 v[72:75], v6, s[48:51], 0 offen offset:3072
    buffer_load_dwordx4 v[76:79], v8, s[48:51], 0 offen offset:0
    buffer_load_dwordx4 v[80:83], v8, s[48:51], 0 offen offset:1024
    buffer_load_dwordx4 v[84:87], v8, s[48:51], 0 offen offset:2048
    buffer_load_dwordx4 v[88:91], v8, s[48:51], 0 offen offset:3072
    s_lshl_b32 s38, s30, 18
    s_lshl_b32 s39, s33, 7
    s_sub_u32 s38, s38, s39
    s_add_u32 s80, s38, 8396784
    v_lshlrev_b32 v6, 15, v4
    v_lshlrev_b32 v7, 4, v5
    v_sub_u32 v6, v6, v7
    v_add_u32 v6, s80, v6
    s_lshl_b32 s38, s30, 5
    s_add_u32 s38, s38, s33
    s_lshl_b32 s38, s38, 7
    s_add_u32 s81, s38, 7798784
    v_xor_b32 v7, v4, v5
    v_lshlrev_b32 v7, 4, v7
    s_lshl_b32 s38, s74, 12
    s_add_u32 s38, s38, 139264
    s_lshl_b32 s39, s74, 11
    s_add_u32 s39, s39, 106496
    s_cmp_lt_u32 s30, 4
    s_cselect_b32 s38, s38, s39
    v_add_u32 v7, s38, v7
    v_lshl_add_u32 v8, v5, 7, v7
    v_lshl_add_u32 v9, v4, 7, v7
    s_mov_b32 s42, 65536
    s_waitcnt vmcnt(15)
    s_branch Lnp_26c
Lnp_26:
    global_load_dwordx2 v[2:3], v10, s[26:27] sc1
    s_waitcnt vmcnt(0)
Lnp_26c:
    v_readfirstlane_b32 s36, v2
    v_readfirstlane_b32 s37, v3
    s_sub_u32 s42, s42, 1
    s_cmp_eq_u32 s42, 0
    s_cbranch_scc1 Lnp_26d
    s_cmp_eq_u32 s36, 0
    s_cbranch_scc1 Lnp_26
Lnp_26d:
    s_waitcnt vmcnt(0)
    s_cmp_lt_u32 s30, 4
    s_cbranch_scc0 Lsp8
    v_mov_b32 v12, 160912
    v_mov_b32 v13, 1
    s_mov_b64 exec, 1
    ds_add_rtn_u32 v13, v12, v13
    s_mov_b64 exec, -1
    s_waitcnt lgkmcnt(0)
    v_readfirstlane_b32 s40, v13
    s_cmp_eq_u32 s40, 3
    s_cbranch_scc0 Lsp8
    s_and_b32 s39, s2, 7
    s_lshl_b32 s39, s39, 5
    s_lshr_b32 s38, s2, 3
    s_add_u32 s39, s39, s38
    s_lshl_b32 s38, s39, 7
    s_add_u32 s83, s38, 7733248
    v_mov_b32 v12, s36
    v_mov_b32 v13, s37
    s_mov_b64 exec, 1
    buffer_store_dwordx2 v[12:13], off, s[44:47], s83 sc1
    s_mov_b64 exec, -1
Lsp8:
    v_lshlrev_b32 v116, 16, v92
    v_lshlrev_b32 v117, 16, v94
    v_and_b32 v118, 0xffff0000, v92
    v_and_b32 v119, 0xffff0000, v94
    v_lshlrev_b32 v120, 16, v93
    v_lshlrev_b32 v121, 16, v95
    v_and_b32 v122, 0xffff0000, v93
    v_and_b32 v123, 0xffff0000, v95
    v_lshlrev_b32 v124, 16, v16
    v_and_b32 v125, 0xffff0000, v16
    v_lshlrev_b32 v126, 16, v20
    v_and_b32 v127, 0xffff0000, v20
    v_lshlrev_b32 v128, 16, v24
    v_and_b32 v129, 0xffff0000, v24
    v_lshlrev_b32 v130, 16, v28
    v_and_b32 v131, 0xffff0000, v28
    v_lshlrev_b32 v132, 16, v32
    v_and_b32 v133, 0xffff0000, v32
    v_lshlrev_b32 v134, 16, v36
    v_and_b32 v135, 0xffff0000, v36
    v_lshlrev_b32 v136, 16, v40
    v_and_b32 v137, 0xffff0000, v40
    v_lshlrev_b32 v138, 16, v44
    v_and_b32 v139, 0xffff0000, v44
    v_lshlrev_b32 v140, 16, v48
    v_and_b32 v141, 0xffff0000, v48
    v_lshlrev_b32 v142, 16, v52
    v_and_b32 v143, 0xffff0000, v52
    v_lshlrev_b32 v144, 16, v56
    v_and_b32 v145, 0xffff0000, v56
    v_lshlrev_b32 v146, 16, v60
    v_and_b32 v147, 0xffff0000, v60
    v_lshlrev_b32 v148, 16, v64
    v_and_b32 v149, 0xffff0000, v64
    v_lshlrev_b32 v150, 16, v68
    v_and_b32 v151, 0xffff0000, v68
    v_lshlrev_b32 v152, 16, v72
    v_and_b32 v153, 0xffff0000, v72
    v_lshlrev_b32 v154, 16, v76
    v_and_b32 v155, 0xffff0000, v76
    v_lshlrev_b32 v156, 16, v80
    v_and_b32 v157, 0xffff0000, v80
    v_lshlrev_b32 v158, 16, v84
    v_and_b32 v159, 0xffff0000, v84
    v_lshlrev_b32 v160, 16, v88
    v_and_b32 v161, 0xffff0000, v88
    v_pk_mul_f32 v[162:163], v[122:123], v[124:125]
    v_pk_mul_f32 v[164:165], v[122:123], v[126:127]
    v_pk_mul_f32 v[166:167], v[122:123], v[128:129]
    v_pk_mul_f32 v[168:169], v[122:123], v[130:131]
    v_pk_mul_f32 v[170:171], v[122:123], v[132:133]
    v_pk_mul_f32 v[172:173], v[122:123], v[134:135]
    v_pk_mul_f32 v[174:175], v[122:123], v[136:137]
    v_pk_mul_f32 v[176:177], v[122:123], v[138:139]
    v_pk_fma_f32 v[162:163], v[120:121], v[126:127], v[162:163]
    v_pk_fma_f32 v[164:165], v[120:121], v[128:129], v[164:165]
    v_pk_fma_f32 v[166:167], v[120:121], v[130:131], v[166:167]
    v_pk_fma_f32 v[168:169], v[120:121], v[132:133], v[168:169]
    v_pk_fma_f32 v[170:171], v[120:121], v[134:135], v[170:171]
    v_pk_fma_f32 v[172:173], v[120:121], v[136:137], v[172:173]
    v_pk_fma_f32 v[174:175], v[120:121], v[138:139], v[174:175]
    v_pk_fma_f32 v[176:177], v[120:121], v[140:141], v[176:177]
    v_pk_fma_f32 v[162:163], v[118:119], v[128:129], v[162:163]
    v_pk_fma_f32 v[164:165], v[118:119], v[130:131], v[164:165]
    v_pk_fma_f32 v[166:167], v[118:119], v[132:133], v[166:167]
    v_pk_fma_f32 v[168:169], v[118:119], v[134:135], v[168:169]
    v_pk_fma_f32 v[170:171], v[118:119], v[136:137], v[170:171]
    v_pk_fma_f32 v[172:173], v[118:119], v[138:139], v[172:173]
    v_pk_fma_f32 v[174:175], v[118:119], v[140:141], v[174:175]
    v_pk_fma_f32 v[176:177], v[118:119], v[142:143], v[176:177]
    v_pk_fma_f32 v[162:163], v[116:117], v[130:131], v[162:163]
    v_pk_fma_f32 v[164:165], v[116:117], v[132:133], v[164:165]
    v_pk_fma_f32 v[166:167], v[116:117], v[134:135], v[166:167]
    v_pk_fma_f32 v[168:169], v[116:117], v[136:137], v[168:169]
    v_pk_fma_f32 v[170:171], v[116:117], v[138:139], v[170:171]
    v_pk_fma_f32 v[172:173], v[116:117], v[140:141], v[172:173]
    v_pk_fma_f32 v[174:175], v[116:117], v[142:143], v[174:175]
    v_pk_fma_f32 v[176:177], v[116:117], v[144:145], v[176:177]
    v_pk_mul_f32 v[162:163], v[162:163], v[146:147]
    v_pk_mul_f32 v[164:165], v[164:165], v[148:149]
    v_pk_mul_f32 v[166:167], v[166:167], v[150:151]
    v_pk_mul_f32 v[168:169], v[168:169], v[152:153]
    v_pk_mul_f32 v[170:171], v[170:171], v[154:155]
    v_pk_mul_f32 v[172:173], v[172:173], v[156:157]
    v_pk_mul_f32 v[174:175], v[174:175], v[158:159]
    v_pk_mul_f32 v[176:177], v[176:177], v[160:161]
    v_cvt_pk_bf16_f32 v108, v176, v174
    v_cvt_pk_bf16_f32 v109, v172, v170
    v_cvt_pk_bf16_f32 v110, v168, v166
    v_cvt_pk_bf16_f32 v111, v164, v162
    v_cvt_pk_bf16_f32 v112, v177, v175
    v_cvt_pk_bf16_f32 v113, v173, v171
    v_cvt_pk_bf16_f32 v114, v169, v167
    v_cvt_pk_bf16_f32 v115, v165, v163
    ds_write_b128 v8, v[108:111] offset:0
    ds_write_b128 v8, v[112:115] offset:1024
    ds_read_b128 v[180:183], v9 offset:0
    ds_read_b128 v[184:187], v9 offset:1024
    v_lshlrev_b32 v116, 16, v96
    v_lshlrev_b32 v117, 16, v98
    v_and_b32 v118, 0xffff0000, v96
    v_and_b32 v119, 0xffff0000, v98
    v_lshlrev_b32 v120, 16, v97
    v_lshlrev_b32 v121, 16, v99
    v_and_b32 v122, 0xffff0000, v97
    v_and_b32 v123, 0xffff0000, v99
    v_lshlrev_b32 v124, 16, v17
    v_and_b32 v125, 0xffff0000, v17
    v_lshlrev_b32 v126, 16, v21
    v_and_b32 v127, 0xffff0000, v21
    v_lshlrev_b32 v128, 16, v25
    v_and_b32 v129, 0xffff0000, v25
    v_lshlrev_b32 v130, 16, v29
    v_and_b32 v131, 0xffff0000, v29
    v_lshlrev_b32 v132, 16, v33
    v_and_b32 v133, 0xffff0000, v33
    v_lshlrev_b32 v134, 16, v37
    v_and_b32 v135, 0xffff0000, v37
    v_lshlrev_b32 v136, 16, v41
    v_and_b32 v137, 0xffff0000, v41
    v_lshlrev_b32 v138, 16, v45
    v_and_b32 v139, 0xffff0000, v45
    v_lshlrev_b32 v140, 16, v49
    v_and_b32 v141, 0xffff0000, v49
    v_lshlrev_b32 v142, 16, v53
    v_and_b32 v143, 0xffff0000, v53
    v_lshlrev_b32 v144, 16, v57
    v_and_b32 v145, 0xffff0000, v57
    v_lshlrev_b32 v146, 16, v61
    v_and_b32 v147, 0xffff0000, v61
    v_lshlrev_b32 v148, 16, v65
    v_and_b32 v149, 0xffff0000, v65
    v_lshlrev_b32 v150, 16, v69
    v_and_b32 v151, 0xffff0000, v69
    v_lshlrev_b32 v152, 16, v73
    v_and_b32 v153, 0xffff0000, v73
    v_lshlrev_b32 v154, 16, v77
    v_and_b32 v155, 0xffff0000, v77
    v_lshlrev_b32 v156, 16, v81
    v_and_b32 v157, 0xffff0000, v81
    v_lshlrev_b32 v158, 16, v85
    v_and_b32 v159, 0xffff0000, v85
    v_lshlrev_b32 v160, 16, v89
    v_and_b32 v161, 0xffff0000, v89
    v_pk_mul_f32 v[162:163], v[122:123], v[124:125]
    v_pk_mul_f32 v[164:165], v[122:123], v[126:127]
    v_pk_mul_f32 v[166:167], v[122:123], v[128:129]
    v_pk_mul_f32 v[168:169], v[122:123], v[130:131]
    v_pk_mul_f32 v[170:171], v[122:123], v[132:133]
    v_pk_mul_f32 v[172:173], v[122:123], v[134:135]
    v_pk_mul_f32 v[174:175], v[122:123], v[136:137]
    v_pk_mul_f32 v[176:177], v[122:123], v[138:139]
    v_pk_fma_f32 v[162:163], v[120:121], v[126:127], v[162:163]
    v_pk_fma_f32 v[164:165], v[120:121], v[128:129], v[164:165]
    v_pk_fma_f32 v[166:167], v[120:121], v[130:131], v[166:167]
    v_pk_fma_f32 v[168:169], v[120:121], v[132:133], v[168:169]
    v_pk_fma_f32 v[170:171], v[120:121], v[134:135], v[170:171]
    v_pk_fma_f32 v[172:173], v[120:121], v[136:137], v[172:173]
    v_pk_fma_f32 v[174:175], v[120:121], v[138:139], v[174:175]
    v_pk_fma_f32 v[176:177], v[120:121], v[140:141], v[176:177]
    v_pk_fma_f32 v[162:163], v[118:119], v[128:129], v[162:163]
    v_pk_fma_f32 v[164:165], v[118:119], v[130:131], v[164:165]
    v_pk_fma_f32 v[166:167], v[118:119], v[132:133], v[166:167]
    v_pk_fma_f32 v[168:169], v[118:119], v[134:135], v[168:169]
    v_pk_fma_f32 v[170:171], v[118:119], v[136:137], v[170:171]
    v_pk_fma_f32 v[172:173], v[118:119], v[138:139], v[172:173]
    v_pk_fma_f32 v[174:175], v[118:119], v[140:141], v[174:175]
    v_pk_fma_f32 v[176:177], v[118:119], v[142:143], v[176:177]
    v_pk_fma_f32 v[162:163], v[116:117], v[130:131], v[162:163]
    v_pk_fma_f32 v[164:165], v[116:117], v[132:133], v[164:165]
    v_pk_fma_f32 v[166:167], v[116:117], v[134:135], v[166:167]
    v_pk_fma_f32 v[168:169], v[116:117], v[136:137], v[168:169]
    v_pk_fma_f32 v[170:171], v[116:117], v[138:139], v[170:171]
    v_pk_fma_f32 v[172:173], v[116:117], v[140:141], v[172:173]
    v_pk_fma_f32 v[174:175], v[116:117], v[142:143], v[174:175]
    v_pk_fma_f32 v[176:177], v[116:117], v[144:145], v[176:177]
    v_pk_mul_f32 v[162:163], v[162:163], v[146:147]
    v_pk_mul_f32 v[164:165], v[164:165], v[148:149]
    v_pk_mul_f32 v[166:167], v[166:167], v[150:151]
    v_pk_mul_f32 v[168:169], v[168:169], v[152:153]
    v_pk_mul_f32 v[170:171], v[170:171], v[154:155]
    v_pk_mul_f32 v[172:173], v[172:173], v[156:157]
    v_pk_mul_f32 v[174:175], v[174:175], v[158:159]
    v_pk_mul_f32 v[176:177], v[176:177], v[160:161]
    s_waitcnt lgkmcnt(0)
    v_cvt_pk_bf16_f32 v108, v176, v174
    v_cvt_pk_bf16_f32 v109, v172, v170
    v_cvt_pk_bf16_f32 v110, v168, v166
    v_cvt_pk_bf16_f32 v111, v164, v162
    v_cvt_pk_bf16_f32 v112, v177, v175
    v_cvt_pk_bf16_f32 v113, v173, v171
    v_cvt_pk_bf16_f32 v114, v169, v167
    v_cvt_pk_bf16_f32 v115, v165, v163
    s_mov_b32 s43, 0
    buffer_store_dwordx4 v[180:183], v6, s[44:47], s43 offen sc1
    s_mov_b32 s43, 4096
    buffer_store_dwordx4 v[184:187], v6, s[44:47], s43 offen sc1
    ds_write_b128 v8, v[108:111] offset:0
    ds_write_b128 v8, v[112:115] offset:1024
    ds_read_b128 v[188:191], v9 offset:0
    ds_read_b128 v[192:195], v9 offset:1024
    v_lshlrev_b32 v116, 16, v100
    v_lshlrev_b32 v117, 16, v102
    v_and_b32 v118, 0xffff0000, v100
    v_and_b32 v119, 0xffff0000, v102
    v_lshlrev_b32 v120, 16, v101
    v_lshlrev_b32 v121, 16, v103
    v_and_b32 v122, 0xffff0000, v101
    v_and_b32 v123, 0xffff0000, v103
    v_lshlrev_b32 v124, 16, v18
    v_and_b32 v125, 0xffff0000, v18
    v_lshlrev_b32 v126, 16, v22
    v_and_b32 v127, 0xffff0000, v22
    v_lshlrev_b32 v128, 16, v26
    v_and_b32 v129, 0xffff0000, v26
    v_lshlrev_b32 v130, 16, v30
    v_and_b32 v131, 0xffff0000, v30
    v_lshlrev_b32 v132, 16, v34
    v_and_b32 v133, 0xffff0000, v34
    v_lshlrev_b32 v134, 16, v38
    v_and_b32 v135, 0xffff0000, v38
    v_lshlrev_b32 v136, 16, v42
    v_and_b32 v137, 0xffff0000, v42
    v_lshlrev_b32 v138, 16, v46
    v_and_b32 v139, 0xffff0000, v46
    v_lshlrev_b32 v140, 16, v50
    v_and_b32 v141, 0xffff0000, v50
    v_lshlrev_b32 v142, 16, v54
    v_and_b32 v143, 0xffff0000, v54
    v_lshlrev_b32 v144, 16, v58
    v_and_b32 v145, 0xffff0000, v58
    v_lshlrev_b32 v146, 16, v62
    v_and_b32 v147, 0xffff0000, v62
    v_lshlrev_b32 v148, 16, v66
    v_and_b32 v149, 0xffff0000, v66
    v_lshlrev_b32 v150, 16, v70
    v_and_b32 v151, 0xffff0000, v70
    v_lshlrev_b32 v152, 16, v74
    v_and_b32 v153, 0xffff0000, v74
    v_lshlrev_b32 v154, 16, v78
    v_and_b32 v155, 0xffff0000, v78
    v_lshlrev_b32 v156, 16, v82
    v_and_b32 v157, 0xffff0000, v82
    v_lshlrev_b32 v158, 16, v86
    v_and_b32 v159, 0xffff0000, v86
    v_lshlrev_b32 v160, 16, v90
    v_and_b32 v161, 0xffff0000, v90
    v_pk_mul_f32 v[162:163], v[122:123], v[124:125]
    v_pk_mul_f32 v[164:165], v[122:123], v[126:127]
    v_pk_mul_f32 v[166:167], v[122:123], v[128:129]
    v_pk_mul_f32 v[168:169], v[122:123], v[130:131]
    v_pk_mul_f32 v[170:171], v[122:123], v[132:133]
    v_pk_mul_f32 v[172:173], v[122:123], v[134:135]
    v_pk_mul_f32 v[174:175], v[122:123], v[136:137]
    v_pk_mul_f32 v[176:177], v[122:123], v[138:139]
    v_pk_fma_f32 v[162:163], v[120:121], v[126:127], v[162:163]
    v_pk_fma_f32 v[164:165], v[120:121], v[128:129], v[164:165]
    v_pk_fma_f32 v[166:167], v[120:121], v[130:131], v[166:167]
    v_pk_fma_f32 v[168:169], v[120:121], v[132:133], v[168:169]
    v_pk_fma_f32 v[170:171], v[120:121], v[134:135], v[170:171]
    v_pk_fma_f32 v[172:173], v[120:121], v[136:137], v[172:173]
    v_pk_fma_f32 v[174:175], v[120:121], v[138:139], v[174:175]
    v_pk_fma_f32 v[176:177], v[120:121], v[140:141], v[176:177]
    v_pk_fma_f32 v[162:163], v[118:119], v[128:129], v[162:163]
    v_pk_fma_f32 v[164:165], v[118:119], v[130:131], v[164:165]
    v_pk_fma_f32 v[166:167], v[118:119], v[132:133], v[166:167]
    v_pk_fma_f32 v[168:169], v[118:119], v[134:135], v[168:169]
    v_pk_fma_f32 v[170:171], v[118:119], v[136:137], v[170:171]
    v_pk_fma_f32 v[172:173], v[118:119], v[138:139], v[172:173]
    v_pk_fma_f32 v[174:175], v[118:119], v[140:141], v[174:175]
    v_pk_fma_f32 v[176:177], v[118:119], v[142:143], v[176:177]
    v_pk_fma_f32 v[162:163], v[116:117], v[130:131], v[162:163]
    v_pk_fma_f32 v[164:165], v[116:117], v[132:133], v[164:165]
    v_pk_fma_f32 v[166:167], v[116:117], v[134:135], v[166:167]
    v_pk_fma_f32 v[168:169], v[116:117], v[136:137], v[168:169]
    v_pk_fma_f32 v[170:171], v[116:117], v[138:139], v[170:171]
    v_pk_fma_f32 v[172:173], v[116:117], v[140:141], v[172:173]
    v_pk_fma_f32 v[174:175], v[116:117], v[142:143], v[174:175]
    v_pk_fma_f32 v[176:177], v[116:117], v[144:145], v[176:177]
    v_pk_mul_f32 v[162:163], v[162:163], v[146:147]
    v_pk_mul_f32 v[164:165], v[164:165], v[148:149]
    v_pk_mul_f32 v[166:167], v[166:167], v[150:151]
    v_pk_mul_f32 v[168:169], v[168:169], v[152:153]
    v_pk_mul_f32 v[170:171], v[170:171], v[154:155]
    v_pk_mul_f32 v[172:173], v[172:173], v[156:157]
    v_pk_mul_f32 v[174:175], v[174:175], v[158:159]
    v_pk_mul_f32 v[176:177], v[176:177], v[160:161]
    s_waitcnt lgkmcnt(0)
    v_cvt_pk_bf16_f32 v108, v176, v174
    v_cvt_pk_bf16_f32 v109, v172, v170
    v_cvt_pk_bf16_f32 v110, v168, v166
    v_cvt_pk_bf16_f32 v111, v164, v162
    v_cvt_pk_bf16_f32 v112, v177, v175
    v_cvt_pk_bf16_f32 v113, v173, v171
    v_cvt_pk_bf16_f32 v114, v169, v167
    v_cvt_pk_bf16_f32 v115, v165, v163
    s_mov_b32 s43, 8192
    buffer_store_dwordx4 v[188:191], v6, s[44:47], s43 offen sc1
    s_mov_b32 s43, 12288
    buffer_store_dwordx4 v[192:195], v6, s[44:47], s43 offen sc1
    ds_write_b128 v8, v[108:111] offset:0
    ds_write_b128 v8, v[112:115] offset:1024
    ds_read_b128 v[196:199], v9 offset:0
    ds_read_b128 v[200:203], v9 offset:1024
    v_lshlrev_b32 v116, 16, v104
    v_lshlrev_b32 v117, 16, v106
    v_and_b32 v118, 0xffff0000, v104
    v_and_b32 v119, 0xffff0000, v106
    v_lshlrev_b32 v120, 16, v105
    v_lshlrev_b32 v121, 16, v107
    v_and_b32 v122, 0xffff0000, v105
    v_and_b32 v123, 0xffff0000, v107
    v_lshlrev_b32 v124, 16, v19
    v_and_b32 v125, 0xffff0000, v19
    v_lshlrev_b32 v126, 16, v23
    v_and_b32 v127, 0xffff0000, v23
    v_lshlrev_b32 v128, 16, v27
    v_and_b32 v129, 0xffff0000, v27
    v_lshlrev_b32 v130, 16, v31
    v_and_b32 v131, 0xffff0000, v31
    v_lshlrev_b32 v132, 16, v35
    v_and_b32 v133, 0xffff0000, v35
    v_lshlrev_b32 v134, 16, v39
    v_and_b32 v135, 0xffff0000, v39
    v_lshlrev_b32 v136, 16, v43
    v_and_b32 v137, 0xffff0000, v43
    v_lshlrev_b32 v138, 16, v47
    v_and_b32 v139, 0xffff0000, v47
    v_lshlrev_b32 v140, 16, v51
    v_and_b32 v141, 0xffff0000, v51
    v_lshlrev_b32 v142, 16, v55
    v_and_b32 v143, 0xffff0000, v55
    v_lshlrev_b32 v144, 16, v59
    v_and_b32 v145, 0xffff0000, v59
    v_lshlrev_b32 v146, 16, v63
    v_and_b32 v147, 0xffff0000, v63
    v_lshlrev_b32 v148, 16, v67
    v_and_b32 v149, 0xffff0000, v67
    v_lshlrev_b32 v150, 16, v71
    v_and_b32 v151, 0xffff0000, v71
    v_lshlrev_b32 v152, 16, v75
    v_and_b32 v153, 0xffff0000, v75
    v_lshlrev_b32 v154, 16, v79
    v_and_b32 v155, 0xffff0000, v79
    v_lshlrev_b32 v156, 16, v83
    v_and_b32 v157, 0xffff0000, v83
    v_lshlrev_b32 v158, 16, v87
    v_and_b32 v159, 0xffff0000, v87
    v_lshlrev_b32 v160, 16, v91
    v_and_b32 v161, 0xffff0000, v91
    v_pk_mul_f32 v[162:163], v[122:123], v[124:125]
    v_pk_mul_f32 v[164:165], v[122:123], v[126:127]
    v_pk_mul_f32 v[166:167], v[122:123], v[128:129]
    v_pk_mul_f32 v[168:169], v[122:123], v[130:131]
    v_pk_mul_f32 v[170:171], v[122:123], v[132:133]
    v_pk_mul_f32 v[172:173], v[122:123], v[134:135]
    v_pk_mul_f32 v[174:175], v[122:123], v[136:137]
    v_pk_mul_f32 v[176:177], v[122:123], v[138:139]
    v_pk_fma_f32 v[162:163], v[120:121], v[126:127], v[162:163]
    v_pk_fma_f32 v[164:165], v[120:121], v[128:129], v[164:165]
    v_pk_fma_f32 v[166:167], v[120:121], v[130:131], v[166:167]
    v_pk_fma_f32 v[168:169], v[120:121], v[132:133], v[168:169]
    v_pk_fma_f32 v[170:171], v[120:121], v[134:135], v[170:171]
    v_pk_fma_f32 v[172:173], v[120:121], v[136:137], v[172:173]
    v_pk_fma_f32 v[174:175], v[120:121], v[138:139], v[174:175]
    v_pk_fma_f32 v[176:177], v[120:121], v[140:141], v[176:177]
    v_pk_fma_f32 v[162:163], v[118:119], v[128:129], v[162:163]
    v_pk_fma_f32 v[164:165], v[118:119], v[130:131], v[164:165]
    v_pk_fma_f32 v[166:167], v[118:119], v[132:133], v[166:167]
    v_pk_fma_f32 v[168:169], v[118:119], v[134:135], v[168:169]
    v_pk_fma_f32 v[170:171], v[118:119], v[136:137], v[170:171]
    v_pk_fma_f32 v[172:173], v[118:119], v[138:139], v[172:173]
    v_pk_fma_f32 v[174:175], v[118:119], v[140:141], v[174:175]
    v_pk_fma_f32 v[176:177], v[118:119], v[142:143], v[176:177]
    v_pk_fma_f32 v[162:163], v[116:117], v[130:131], v[162:163]
    v_pk_fma_f32 v[164:165], v[116:117], v[132:133], v[164:165]
    v_pk_fma_f32 v[166:167], v[116:117], v[134:135], v[166:167]
    v_pk_fma_f32 v[168:169], v[116:117], v[136:137], v[168:169]
    v_pk_fma_f32 v[170:171], v[116:117], v[138:139], v[170:171]
    v_pk_fma_f32 v[172:173], v[116:117], v[140:141], v[172:173]
    v_pk_fma_f32 v[174:175], v[116:117], v[142:143], v[174:175]
    v_pk_fma_f32 v[176:177], v[116:117], v[144:145], v[176:177]
    v_pk_mul_f32 v[162:163], v[162:163], v[146:147]
    v_pk_mul_f32 v[164:165], v[164:165], v[148:149]
    v_pk_mul_f32 v[166:167], v[166:167], v[150:151]
    v_pk_mul_f32 v[168:169], v[168:169], v[152:153]
    v_pk_mul_f32 v[170:171], v[170:171], v[154:155]
    v_pk_mul_f32 v[172:173], v[172:173], v[156:157]
    v_pk_mul_f32 v[174:175], v[174:175], v[158:159]
    v_pk_mul_f32 v[176:177], v[176:177], v[160:161]
    s_waitcnt lgkmcnt(0)
    v_cvt_pk_bf16_f32 v108, v176, v174
    v_cvt_pk_bf16_f32 v109, v172, v170
    v_cvt_pk_bf16_f32 v110, v168, v166
    v_cvt_pk_bf16_f32 v111, v164, v162
    v_cvt_pk_bf16_f32 v112, v177, v175
    v_cvt_pk_bf16_f32 v113, v173, v171
    v_cvt_pk_bf16_f32 v114, v169, v167
    v_cvt_pk_bf16_f32 v115, v165, v163
    s_mov_b32 s43, 16384
    buffer_store_dwordx4 v[196:199], v6, s[44:47], s43 offen sc1
    s_mov_b32 s43, 20480
    buffer_store_dwordx4 v[200:203], v6, s[44:47], s43 offen sc1
    ds_write_b128 v8, v[108:111] offset:0
    ds_write_b128 v8, v[112:115] offset:1024
    ds_read_b128 v[204:207], v9 offset:0
    ds_read_b128 v[208:211], v9 offset:1024
    s_waitcnt lgkmcnt(0)
    s_mov_b32 s43, 24576
    buffer_store_dwordx4 v[204:207], v6, s[44:47], s43 offen sc1
    s_mov_b32 s43, 28672
    buffer_store_dwordx4 v[208:211], v6, s[44:47], s43 offen sc1
    s_waitcnt vmcnt(0)
    v_mov_b32 v2, s36
    v_mov_b32 v3, s37
    s_mov_b64 exec, 1
    buffer_store_dwordx2 v[2:3], off, s[44:47], s81 sc1
    s_mov_b64 exec, -1
    s_cmp_lg_u32 s30, 2
    s_cbranch_scc1 Lsp4
    s_mov_b32 s56, s12
    s_mov_b32 s57, s13
    s_mov_b32 s58, 2097152
    s_mov_b32 s59, 0x20000
    v_lshlrev_b32 v7, 4, v1
    s_lshl_b32 s80, s2, 13
    s_mov_b32 m0, 114720
    s_add_u32 s43, s80, 0
    buffer_load_dwordx4 v7, s[56:59], s43 offen  lds
    s_mov_b32 m0, 115744
    s_add_u32 s43, s80, 1024
    buffer_load_dwordx4 v7, s[56:59], s43 offen  lds
    s_mov_b32 m0, 116768
    s_add_u32 s43, s80, 2048
    buffer_load_dwordx4 v7, s[56:59], s43 offen  lds
    s_mov_b32 m0, 117792
    s_add_u32 s43, s80, 3072
    buffer_load_dwordx4 v7, s[56:59], s43 offen  lds
    s_mov_b32 m0, 118880
    s_add_u32 s43, s80, 2
    buffer_load_dwordx4 v7, s[56:59], s43 offen  lds
    s_mov_b32 m0, 119904
    s_add_u32 s43, s80, 1026
    buffer_load_dwordx4 v7, s[56:59], s43 offen  lds
    s_mov_b32 m0, 120928
    s_add_u32 s43, s80, 2050
    buffer_load_dwordx4 v7, s[56:59], s43 offen  lds
    s_mov_b32 m0, 121952
    s_add_u32 s43, s80, 3074
    buffer_load_dwordx4 v7, s[56:59], s43 offen  lds
    s_mov_b32 m0, 123040
    s_add_u32 s43, s80, 4096
    buffer_load_dwordx4 v7, s[56:59], s43 offen  lds
    s_mov_b32 m0, 124064
    s_add_u32 s43, s80, 5120
    buffer_load_dwordx4 v7, s[56:59], s43 offen  lds
    s_mov_b32 m0, 125088
    s_add_u32 s43, s80, 6144
    buffer_load_dwordx4 v7, s[56:59], s43 offen  lds
    s_mov_b32 m0, 126112
    s_add_u32 s43, s80, 7168
    buffer_load_dwordx4 v7, s[56:59], s43 offen  lds
    s_mov_b32 m0, 156768
    s_add_u32 s43, s80, 4098
    buffer_load_dwordx4 v7, s[56:59], s43 offen  lds
    s_mov_b32 m0, 157792
    s_add_u32 s43, s80, 5122
    buffer_load_dwordx4 v7, s[56:59], s43 offen  lds
    s_mov_b32 m0, 158816
    s_add_u32 s43, s80, 6146
    buffer_load_dwordx4 v7, s[56:59], s43 offen  lds
    s_mov_b32 m0, 159840
    s_add_u32 s43, s80, 7170
    buffer_load_dwordx4 v7, s[56:59], s43 offen  lds
    v_mov_b32 v8, 0
    v_mov_b32 v9, 0
    v_lshrrev_b32 v4, 3, v1
    v_min_u32 v4, 3, v4
    v_mul_u32_u24 v5, 4160, v4
    v_cmp_eq_u32 vcc, 3, v4
    v_mov_b32 v6, 42048
    v_and_b32 v4, 7, v1
    v_cndmask_b32 v5, v5, v6, vcc
    v_lshl_add_u32 v5, v4, 2, v5
    v_add_u32 v5, 114688, v5
    ds_write_b32 v5, v8
    v_lshlrev_b32 v5, 3, v1
    v_add_u32 v5, 131264, v5
    ds_write_b64 v5, v[8:9]
    ds_write_b64 v5, v[8:9] offset:4608
    s_waitcnt vmcnt(0)
    v_mov_b32 v4, 114688
    ds_read_u16 v5, v4 offset:32
    ds_read_u16 v6, v4 offset:8352
    s_waitcnt lgkmcnt(0)
    ds_write_b16 v4, v5 offset:4190
    ds_write_b16 v4, v6 offset:42078
    s_waitcnt lgkmcnt(0)
Lsp4:
    s_barrier
    s_cmp_lt_u32 s30, 4
    s_cbranch_scc0 Lsp9
    s_lshl_b32 s38, s2, 2
    s_load_dword s42, s[14:15], s38
    s_lshr_b32 s38, s30, 1
    s_and_b32 s39, s30, 1
    s_mul_i32 s40, s38, 4608
    s_lshl_b32 s41, s39, 6
    s_add_u32 s40, s40, s41
    s_add_u32 s40, s40, 127648
    v_and_b32 v10, 15, v1
    v_lshrrev_b32 v11, 4, v1
    v_lshlrev_b32 v12, 5, v10
    v_lshl_add_u32 v13, v11, 4, s40
    v_sub_u32 v122, v13, v12
    s_mul_i32 s40, s38, 8320
    s_add_u32 s40, s40, 114688
    s_mul_i32 s43, s38, 29568
    s_add_u32 s43, s43, 4160
    s_add_u32 s40, s40, s41
    v_lshl_add_u32 v10, v11, 3, v10
    v_add_u32 v12, 1, v10
    v_and_b32 v13, 1, v12
    v_lshrrev_b32 v12, 1, v12
    v_lshl_add_u32 v12, v12, 2, s40
    v_mul_u32_u24 v13, s43, v13
    v_add_u32 v123, v12, v13
    v_sub_u32 v12, 15, v10
    v_and_b32 v13, 1, v12
    v_lshlrev_b32 v13, 4, v13
    v_lshrrev_b32 v12, 1, v12
    s_lshl_b32 s38, s38, 4
    s_waitcnt lgkmcnt(0)
    s_lshr_b32 s40, s42, s38
    s_and_b32 s40, s40, 0xffff
    s_cmp_eq_u32 s39, 0
    s_cselect_b32 s40, s40, 0
    v_lshlrev_b32 v13, v13, s40
    v_cmp_eq_u32 vcc, 0, v12
    s_nop 1
    v_cndmask_b32 v124, 0, v13, vcc
    v_cmp_eq_u32 vcc, 1, v12
    s_nop 1
    v_cndmask_b32 v125, 0, v13, vcc
    v_cmp_eq_u32 vcc, 2, v12
    s_nop 1
    v_cndmask_b32 v126, 0, v13, vcc
    v_cmp_eq_u32 vcc, 3, v12
    s_nop 1
    v_cndmask_b32 v127, 0, v13, vcc
    s_cmp_lg_u32 s30, 0
    s_cbranch_scc1 Lconv
    v_lshlrev_b32 v7, 4, v1
    s_lshl_b32 s80, s2, 13
    s_lshr_b32 s40, s2, 5
    s_lshl_b32 s40, s40, 12
    s_add_u32 s40, s40, 7798784
    v_and_b32 v4, 31, v1
    v_lshl_add_u32 v4, v4, 7, s40
    s_mov_b32 s42, 65536
Lpoll_27:
    buffer_load_dwordx2 v[8:9], v4, s[44:47], 0 offen sc1
    s_waitcnt vmcnt(0)
Lpollc_29:
    v_cmp_ne_u64 s[68:69], s[36:37], v[8:9]
    s_cmp_eq_u64 s[68:69], 0
    s_cbranch_scc1 Lpolld_28
    s_sleep 0
    s_sub_u32 s42, s42, 1
    s_cmp_lg_u32 s42, 0
    s_cbranch_scc1 Lpoll_27
Lpolld_28:
    s_mov_b32 m0, 127168
    s_add_u32 s43, s80, 8392704
    buffer_load_dwordx4 v7, s[44:47], s43 offen sc1 lds
    s_mov_b32 m0, 128192
    s_add_u32 s43, s80, 8393728
    buffer_load_dwordx4 v7, s[44:47], s43 offen sc1 lds
    s_mov_b32 m0, 129216
    s_add_u32 s43, s80, 8394752
    buffer_load_dwordx4 v7, s[44:47], s43 offen sc1 lds
    s_mov_b32 m0, 130240
    s_add_u32 s43, s80, 8395776
    buffer_load_dwordx4 v7, s[44:47], s43 offen sc1 lds
    s_mov_b32 m0, 131776
    s_add_u32 s43, s80, 8396800
    buffer_load_dwordx4 v7, s[44:47], s43 offen sc1 lds
    s_mov_b32 m0, 132800
    s_add_u32 s43, s80, 8397824
    buffer_load_dwordx4 v7, s[44:47], s43 offen sc1 lds
    s_mov_b32 m0, 133824
    s_add_u32 s43, s80, 8398848
    buffer_load_dwordx4 v7, s[44:47], s43 offen sc1 lds
    s_mov_b32 m0, 134848
    s_add_u32 s43, s80, 8399872
    buffer_load_dwordx4 v7, s[44:47], s43 offen sc1 lds
    v_mov_b32 v4, 156708
    s_waitcnt vmcnt(0)
    ds_write_b32 v4, v4
    s_branch Lconv
Lsp9:
    s_and_b32 s38, s34, 3
    s_cmp_eq_u32 s38, 3
    s_cselect_b32 s38, 4, 0
    s_xor_b32 s34, s34, s38
    s_mov_b32 s92, s22
    s_mov_b32 s93, s23
    s_mov_b32 s94, 1835008
    s_mov_b32 s95, 0x20000
    s_lshr_b32 s38, s34, 2
    s_add_u32 s38, s38, s79
    s_and_b32 s38, s38, 1
    s_lshl_b32 s66, s38, 10
    s_xor_b32 s67, s66, 1024
    s_lshl_b32 s64, s66, 1
    s_lshl_b32 s65, s67, 1
    v_bfe_u32 v188, v1, 4, 1
    v_lshlrev_b32 v188, 2, v188
    v_and_b32 v12, 7, v1
    v_xor_b32 v188, v188, v12
    v_lshlrev_b32 v188, 4, v188
    v_lshrrev_b32 v12, 3, v1
    v_lshl_add_u32 v188, v12, 10, v188
    s_mul_i32 s38, s74, 458752
    s_lshl_b32 s39, s34, 7
    s_add_u32 s38, s38, s39
    v_add_u32 v188, s38, v188
    s_lshl_b32 s78, s74, 11
    v_lshrrev_b32 v12, 2, v1
    v_lshlrev_b32 v12, 7, v12
    v_bfe_u32 v13, v1, 3, 1
    v_lshl_add_u32 v12, v13, 6, v12
    v_and_b32 v13, 3, v1
    v_lshl_add_u32 v12, v13, 4, v12
    v_add_u32 v184, s78, v12
    v_xor_b32 v185, 64, v184
    v_add_u32 v186, 0x10000, v184
    v_add_u32 v187, 0x10000, v185
    v_add_u32 v68, 98304, v184
    v_add_u32 v69, 98304, v185
    s_add_u32 s38, s78, 98304
    v_lshl_add_u32 v70, v1, 4, s38
    s_mul_i32 s38, s33, 233472
    s_mul_i32 s39, s74, 14336
    s_add_u32 s38, s38, s39
    v_lshl_add_u32 v190, v1, 4, s38
    s_and_b32 s76, s34, 3
    s_xor_b32 s76, s76, s74
    s_mul_i32 s100, s76, 58368
    s_xor_b32 s38, s76, 1
    s_mul_i32 s98, s38, 58368
    s_xor_b32 s38, s76, 2
    s_mul_i32 s97, s38, 58368
    s_xor_b32 s38, s76, 3
    s_mul_i32 s96, s38, 58368
    s_mul_i32 s38, s33, 28
    s_mul_i32 s39, s74, 7
    s_add_u32 s38, s38, s39
    s_lshl_b32 s38, s38, 7
    s_add_u32 s38, s38, 7864320
    v_min_u32 v12, 6, v1
    v_lshl_add_u32 v12, v12, 7, s38
    s_lshl_b32 s41, s33, 10
    s_add_u32 s41, s41, 7733248
    v_and_b32 v13, 7, v1
    v_cmp_gt_u32 vcc, 8, v1
    v_lshl_add_u32 v13, v13, 7, s41
    s_nop 0
    v_cndmask_b32 v189, v13, v12, vcc
    s_lshl_b32 s38, s74, 2
    s_add_u32 s38, s38, 156704
    v_mov_b32 v71, s38
    s_mov_b32 s75, 0
    s_lshl_b32 s38, s64, 5
    s_add_u32 m0, s78, 0
    s_add_u32 s43, s38, 0
    buffer_load_dwordx4 v188, s[92:95], s43 offen lds
    s_add_u32 m0, s78, 1024
    s_add_u32 s43, s38, 8192
    buffer_load_dwordx4 v188, s[92:95], s43 offen lds
    s_lshl_b32 s38, s64, 5
    s_add_u32 m0, s78, 40960
    s_add_u32 s43, s38, 16384
    buffer_load_dwordx4 v188, s[92:95], s43 offen lds
    s_add_u32 m0, s78, 41984
    s_add_u32 s43, s38, 24576
    buffer_load_dwordx4 v188, s[92:95], s43 offen lds
    s_lshl_b32 s38, s65, 5
    s_add_u32 m0, s78, 98304
    s_add_u32 s43, s38, 0
    buffer_load_dwordx4 v188, s[92:95], s43 offen lds
    s_add_u32 m0, s78, 99328
    s_add_u32 s43, s38, 8192
    buffer_load_dwordx4 v188, s[92:95], s43 offen lds
    s_lshl_b32 s38, s65, 5
    s_add_u32 m0, s78, 106496
    s_add_u32 s43, s38, 16384
    buffer_load_dwordx4 v188, s[92:95], s43 offen lds
    s_add_u32 m0, s78, 107520
    s_add_u32 s43, s38, 24576
    buffer_load_dwordx4 v188, s[92:95], s43 offen lds
    s_lshl_b32 s38, s64, 5
    s_add_u32 m0, s78, 8192
    s_add_u32 s43, s38, 131072
    buffer_load_dwordx4 v188, s[92:95], s43 offen lds
    s_add_u32 m0, s78, 9216
    s_add_u32 s43, s38, 139264
    buffer_load_dwordx4 v188, s[92:95], s43 offen lds
    s_lshl_b32 s38, s64, 5
    s_add_u32 m0, s78, 49152
    s_add_u32 s43, s38, 147456
    buffer_load_dwordx4 v188, s[92:95], s43 offen lds
    s_add_u32 m0, s78, 50176
    s_add_u32 s43, s38, 155648
    buffer_load_dwordx4 v188, s[92:95], s43 offen lds
    s_lshl_b32 s38, s65, 5
    s_add_u32 m0, s78, 16384
    s_add_u32 s43, s38, 131072
    buffer_load_dwordx4 v188, s[92:95], s43 offen lds
    s_add_u32 m0, s78, 17408
    s_add_u32 s43, s38, 139264
    buffer_load_dwordx4 v188, s[92:95], s43 offen lds
    s_lshl_b32 s38, s65, 5
    s_add_u32 m0, s78, 57344
    s_add_u32 s43, s38, 147456
    buffer_load_dwordx4 v188, s[92:95], s43 offen lds
    s_add_u32 m0, s78, 58368
    s_add_u32 s43, s38, 155648
    buffer_load_dwordx4 v188, s[92:95], s43 offen lds
    s_lshl_b32 s38, s64, 5
    s_add_u32 m0, s78, 24576
    s_add_u32 s43, s38, 262144
    buffer_load_dwordx4 v188, s[92:95], s43 offen lds
    s_add_u32 m0, s78, 25600
    s_add_u32 s43, s38, 270336
    buffer_load_dwordx4 v188, s[92:95], s43 offen lds
    s_lshl_b32 s38, s64, 5
    s_add_u32 m0, s78, 65536
    s_add_u32 s43, s38, 278528
    buffer_load_dwordx4 v188, s[92:95], s43 offen lds
    s_add_u32 m0, s78, 66560
    s_add_u32 s43, s38, 286720
    buffer_load_dwordx4 v188, s[92:95], s43 offen lds
    s_lshl_b32 s38, s65, 5
    s_add_u32 m0, s78, 81920
    s_add_u32 s43, s38, 262144
    buffer_load_dwordx4 v188, s[92:95], s43 offen lds
    s_add_u32 m0, s78, 82944
    s_add_u32 s43, s38, 270336
    buffer_load_dwordx4 v188, s[92:95], s43 offen lds
    s_lshl_b32 s38, s65, 5
    s_add_u32 m0, s78, 90112
    s_add_u32 s43, s38, 278528
    buffer_load_dwordx4 v188, s[92:95], s43 offen lds
    s_add_u32 m0, s78, 91136
    s_add_u32 s43, s38, 286720
    buffer_load_dwordx4 v188, s[92:95], s43 offen lds
    s_lshl_b32 s38, s66, 5
    s_add_u32 m0, s78, 32768
    s_add_u32 s43, s38, 393216
    buffer_load_dwordx4 v188, s[92:95], s43 offen lds
    s_add_u32 m0, s78, 33792
    s_add_u32 s43, s38, 401408
    buffer_load_dwordx4 v188, s[92:95], s43 offen lds
    s_lshl_b32 s38, s66, 5
    s_add_u32 m0, s78, 73728
    s_add_u32 s43, s38, 409600
    buffer_load_dwordx4 v188, s[92:95], s43 offen lds
    s_add_u32 m0, s78, 74752
    s_add_u32 s43, s38, 417792
    buffer_load_dwordx4 v188, s[92:95], s43 offen lds
    s_waitcnt vmcnt(20)
    ds_read_b64_tr_b16 v[72:73], v184 offset:0
    ds_read_b64_tr_b16 v[76:77], v184 offset:8
    ds_read_b64_tr_b16 v[80:81], v185 offset:0
    ds_read_b64_tr_b16 v[84:85], v185 offset:8
    ds_read_b64_tr_b16 v[74:75], v184 offset:40960
    ds_read_b64_tr_b16 v[78:79], v184 offset:40968
    ds_read_b64_tr_b16 v[82:83], v185 offset:40960
    ds_read_b64_tr_b16 v[86:87], v185 offset:40968
    ds_read_b64_tr_b16 v[88:89], v186 offset:32768
    ds_read_b64_tr_b16 v[92:93], v186 offset:32776
    ds_read_b64_tr_b16 v[96:97], v187 offset:32768
    ds_read_b64_tr_b16 v[100:101], v187 offset:32776
    ds_read_b64_tr_b16 v[90:91], v186 offset:40960
    ds_read_b64_tr_b16 v[94:95], v186 offset:40968
    ds_read_b64_tr_b16 v[98:99], v187 offset:40960
    ds_read_b64_tr_b16 v[102:103], v187 offset:40968
    s_waitcnt lgkmcnt(0)
    v_mov_b32 v71, 156704
    s_branch Lg2
Lexit:

s_endpgm
.section .rodata,"a"
.p2align 6
.amdhsa_kernel parallel_sum__ssm_conv_h3__glu_gated_geglu__prompt_kernel
  .amdhsa_next_free_vgpr 256
  .amdhsa_next_free_sgpr 102
  .amdhsa_accum_offset 256
  .amdhsa_group_segment_fixed_size 0
  .amdhsa_kernarg_size 104
  .amdhsa_user_sgpr_count 2
  .amdhsa_user_sgpr_kernarg_segment_ptr 1
  .amdhsa_system_sgpr_workgroup_id_x 1
  .amdhsa_float_denorm_mode_32 3
  .amdhsa_float_denorm_mode_16_64 3
.end_amdhsa_kernel
```
